```python
import torch

def _softmax(x, axis=-1):
    return torch.softmax(x, dim=axis)

def _gelu(x):
    return torch.nn.functional.gelu(x, approximate='tanh')

def _silu(x):
    return torch.nn.functional.silu(x)

def _sigmoid(x):
    return torch.sigmoid(x)

def _layernorm(x, axis=-1, eps=1e-05):
    m = x.mean(dim=axis, keepdim=True)
    v = x.var(dim=axis, keepdim=True, unbiased=False)
    return (x - m) / torch.sqrt(v + eps)

def _scatter_add(tgt, idx, src, axis=0):
    return tgt.clone().index_add_(axis, idx, src)

def _segment_sum(src, seg, n):
    out = torch.zeros((n,) + src.shape[1:], dtype=src.dtype)
    return out.index_add_(0, seg, src)

def _pad(x, pw):
    flat = tuple((v for pair in reversed(pw) for v in pair))
    return torch.nn.functional.pad(x, flat)
kernel_name = 'sequential_preLN__memory_aug_recurrent_mem_tr__glu_gated_bilinear__prompt'

def setup_inputs():

    _w = lambda a: (lambda t: t.to(torch.bfloat16) if t.is_floating_point() else t)(torch.as_tensor(a))

    def _A_setup():
        B, S, Dm = (1, 2048, 576)
        H, Dh = (32, 128)
        M, seg = (8, 32)
        seg = min(seg, S)
        S = S // seg * seg
        return {'x': _w((lambda *s: torch.randn(*s, dtype=torch.bfloat16) * 0.05)(B, S, Dm)), 'mem0': _w((lambda *s: torch.randn(*s, dtype=torch.bfloat16) * 0.2)(B, M, Dm)), 'Wq': _w((lambda *s: torch.randn(*s, dtype=torch.bfloat16) * 1.6)(Dm, H, Dh) * Dm ** (-0.5)), 'Wk': _w((lambda *s: torch.randn(*s, dtype=torch.bfloat16) * 1.6)(Dm, H, Dh) * Dm ** (-0.5)), 'Wv': _w((lambda *s: torch.randn(*s, dtype=torch.bfloat16) * 0.2)(Dm, H, Dh) * Dm ** (-0.5)), 'Wo': _w((lambda *s: torch.randn(*s, dtype=torch.bfloat16) * 0.2)(H, Dh, Dm) * (H * Dh) ** (-0.5)), 'seg_len': seg}
    _A_in = _A_setup()

    def _B_setup():
        B, S, D, F = (1, 2048, 576, 4608)
        return {'x': _w((lambda *s: torch.randn(*s, dtype=torch.bfloat16) * 0.05)(B, S, D)), 'w_gate': _w((lambda *s: torch.randn(*s, dtype=torch.bfloat16) * 0.2)(D, F) * D ** (-0.5)), 'w_up': _w((lambda *s: torch.randn(*s, dtype=torch.bfloat16) * 0.2)(D, F) * D ** (-0.5)), 'w_down': _w((lambda *s: torch.randn(*s, dtype=torch.bfloat16) * 0.2)(F, D) * F ** (-0.5))}
    _B_in = _B_setup()
    return {'A_x': _A_in['x'], 'A_mem0': _A_in['mem0'], 'A_Wq': _A_in['Wq'], 'A_Wk': _A_in['Wk'], 'A_Wv': _A_in['Wv'], 'A_Wo': _A_in['Wo'], 'A_seg_len': _A_in['seg_len'], 'B_x': _B_in['x'], 'B_w_gate': _B_in['w_gate'], 'B_w_up': _B_in['w_up'], 'B_w_down': _B_in['w_down']}

def reference(A_x, A_mem0, A_Wq, A_Wk, A_Wv, A_Wo, A_seg_len, B_x, B_w_gate, B_w_up, B_w_down):

    def _A_ref(x, mem0, Wq, Wk, Wv, Wo, seg_len):
        B, S, Dm = x.shape
        H, Dh = (Wq.shape[1], Wq.shape[2])
        M = mem0.shape[1]
        scale = Dh ** (-0.5)
        n_seg = S // seg_len
        L = M + seg_len
        idx = torch.arange(L)
        mask = (idx[:, None] < M) | (idx[:, None] >= idx[None, :])
        mem = mem0
        outs = []
        for s in range(n_seg):
            xs = x[:, s * seg_len:(s + 1) * seg_len, :].clone()
            h = torch.concatenate([mem, xs], axis=1)
            q = torch.einsum('btd,dhe->bhte', h, Wq)
            k = torch.einsum('btd,dhe->bhte', h, Wk)
            v = torch.einsum('btd,dhe->bhte', h, Wv)
            scores = torch.einsum('bhqe,bhke->bhqk', q, k) * scale
            scores = torch.where(mask[None, None], scores, -1000000000.0)
            p = _softmax(scores, axis=-1)
            o = torch.einsum('bhqk,bhke->bhqe', p, v)
            o = torch.einsum('bhte,hed->btd', o, Wo)
            mem = o[:, :M, :].clone()
            outs.append(o[:, M:, :])
        return torch.concatenate(outs, axis=1)

    def _B_ref(x, w_gate, w_up, w_down):
        g = torch.einsum('bsd,df->bsf', x, w_gate)
        u = torch.einsum('bsd,df->bsf', x, w_up)
        h = g * u
        return torch.einsum('bsf,fd->bsd', h, w_down)
    x = A_x
    h = x + _A_ref(_layernorm(x, axis=-1), A_mem0, A_Wq, A_Wk, A_Wv, A_Wo, A_seg_len)
    h2 = h + _B_ref(_layernorm(h, axis=-1), B_w_gate, B_w_up, B_w_down)
    return h2
```

```asm
; @launch grid=(256,1,1) block=(256,1,1) lds=163840
.amdgcn_target "amdgcn-amd-amdhsa--gfx950"
.text
.globl sequential_preLN__memory_aug_recurrent_mem_tr__glu_gated_bilinear__prompt_kernel
.p2align 8
.type sequential_preLN__memory_aug_recurrent_mem_tr__glu_gated_bilinear__prompt_kernel,@function
sequential_preLN__memory_aug_recurrent_mem_tr__glu_gated_bilinear__prompt_kernel:
  s_load_dwordx16 s[64:79], s[0:1], 0
  s_load_dwordx8 s[80:87], s[0:1], 64
  s_load_dwordx4 s[88:91], s[0:1], 96
  v_lshrrev_b32 v1, 6, v0
  v_and_b32 v0, 63, v0
  v_readfirstlane_b32 s5, v1
  s_mov_b32 s10, 0x240000
  s_mov_b32 s11, 0x20000
  s_mov_b32 s14, 0x2400
  s_mov_b32 s15, 0x20000
  s_mov_b32 s18, 0x480000
  s_mov_b32 s19, 0x20000
  s_mov_b32 s22, 0x480000
  s_mov_b32 s23, 0x20000
  s_mov_b32 s26, 0x480000
  s_mov_b32 s27, 0x20000
  s_mov_b32 s30, 0x480000
  s_mov_b32 s31, 0x20000
  s_mov_b32 s34, 0x510000
  s_mov_b32 s35, 0x20000
  s_mov_b32 s38, 0x510000
  s_mov_b32 s39, 0x20000
  s_mov_b32 s42, 0x510000
  s_mov_b32 s43, 0x20000
  s_mov_b32 s46, 0x240000
  s_mov_b32 s47, 0x20000
  s_mov_b32 s50, 0x100
  s_mov_b32 s51, 0x20000
  s_mov_b32 s54, 0x10000000
  s_mov_b32 s55, 0x20000
  s_waitcnt lgkmcnt(0)
  s_mov_b32 s8, s64
  s_and_b32 s9, s65, 0xffff
  s_mov_b32 s12, s66
  s_and_b32 s13, s67, 0xffff
  s_mov_b32 s16, s68
  s_and_b32 s17, s69, 0xffff
  s_mov_b32 s20, s70
  s_and_b32 s21, s71, 0xffff
  s_mov_b32 s24, s72
  s_and_b32 s25, s73, 0xffff
  s_mov_b32 s28, s74
  s_and_b32 s29, s75, 0xffff
  s_mov_b32 s32, s80
  s_and_b32 s33, s81, 0xffff
  s_mov_b32 s36, s82
  s_and_b32 s37, s83, 0xffff
  s_mov_b32 s40, s84
  s_and_b32 s41, s85, 0xffff
  s_mov_b32 s44, s86
  s_and_b32 s45, s87, 0xffff
  s_mov_b32 s48, s88
  s_and_b32 s49, s89, 0xffff
  s_mov_b32 s52, s90
  s_and_b32 s53, s91, 0xffff
  s_cmp_ge_u32 s2, 256
  s_cbranch_scc1 EXIT
  s_getreg_b32 s6, hwreg(HW_REG_XCC_ID, 0, 3)
  s_cmp_lg_u32 s5, 0
  s_cbranch_scc1 GOTROLE
  s_lshl_b32 s7, s6, 2
  s_add_u32 s7, s7, 128
  s_cmp_eq_u32 s6, 0
  s_cselect_b32 s7, 0, s7
  s_mov_b64 exec, 1
  v_mov_b32 v1, 1
  buffer_atomic_add v1, off, s[48:51], s7 sc0 sc1
  s_mov_b64 exec, -1
  s_waitcnt vmcnt(0)
  v_readfirstlane_b32 s60, v1
  s_lshl_b32 s61, s6, 5
  s_add_u32 s61, s61, s60
  s_cmp_lt_u32 s60, 32
  s_cbranch_scc1 PUTROLE
  s_mov_b64 exec, 1
  v_mov_b32 v1, 1
  buffer_atomic_add v1, off, s[48:51], 0 offset:68 sc0 sc1
  s_mov_b64 exec, -1
  s_waitcnt vmcnt(0)
  v_readfirstlane_b32 s60, v1
  v_and_b32 v2, 7, v0
  v_lshlrev_b32 v3, 2, v2
  v_add_u32 v3, 128, v3
  v_cmp_eq_u32 vcc, 0, v2
  s_nop 1
  v_cndmask_b32_e64 v3, v3, 0, vcc
  s_mov_b32 s62, 131072
OVP:
  buffer_load_dword v1, v3, s[48:51], 0 offen sc1
  s_waitcnt vmcnt(0)
  s_mov_b32 s63, 0
  v_readlane_b32 s64, v1, 0
  s_add_u32 s63, s63, s64
  v_readlane_b32 s65, v1, 1
  s_add_u32 s63, s63, s65
  v_readlane_b32 s66, v1, 2
  s_add_u32 s63, s63, s66
  v_readlane_b32 s67, v1, 3
  s_add_u32 s63, s63, s67
  v_readlane_b32 s68, v1, 4
  s_add_u32 s63, s63, s68
  v_readlane_b32 s69, v1, 5
  s_add_u32 s63, s63, s69
  v_readlane_b32 s70, v1, 6
  s_add_u32 s63, s63, s70
  v_readlane_b32 s71, v1, 7
  s_add_u32 s63, s63, s71
  s_sub_u32 s62, s62, 1
  s_cbranch_scc1 OVE
  s_cmp_lt_u32 s63, 256
  s_cbranch_scc1 OVP
OVE:
  s_mov_b32 s61, 256
  s_min_u32 s63, s64, 32
  s_add_u32 s62, s63, s60
  s_add_u32 s7, s62, 0
  s_cmp_lt_u32 s62, 32
  s_cselect_b32 s61, s7, s61
  s_sub_u32 s60, s62, 32
  s_cmp_lt_u32 s62, 32
  s_cselect_b32 s60, 0x10000, s60
  s_min_u32 s63, s65, 32
  s_add_u32 s62, s63, s60
  s_add_u32 s7, s62, 32
  s_cmp_lt_u32 s62, 32
  s_cselect_b32 s61, s7, s61
  s_sub_u32 s60, s62, 32
  s_cmp_lt_u32 s62, 32
  s_cselect_b32 s60, 0x10000, s60
  s_min_u32 s63, s66, 32
  s_add_u32 s62, s63, s60
  s_add_u32 s7, s62, 64
  s_cmp_lt_u32 s62, 32
  s_cselect_b32 s61, s7, s61
  s_sub_u32 s60, s62, 32
  s_cmp_lt_u32 s62, 32
  s_cselect_b32 s60, 0x10000, s60
  s_min_u32 s63, s67, 32
  s_add_u32 s62, s63, s60
  s_add_u32 s7, s62, 96
  s_cmp_lt_u32 s62, 32
  s_cselect_b32 s61, s7, s61
  s_sub_u32 s60, s62, 32
  s_cmp_lt_u32 s62, 32
  s_cselect_b32 s60, 0x10000, s60
  s_min_u32 s63, s68, 32
  s_add_u32 s62, s63, s60
  s_add_u32 s7, s62, 128
  s_cmp_lt_u32 s62, 32
  s_cselect_b32 s61, s7, s61
  s_sub_u32 s60, s62, 32
  s_cmp_lt_u32 s62, 32
  s_cselect_b32 s60, 0x10000, s60
  s_min_u32 s63, s69, 32
  s_add_u32 s62, s63, s60
  s_add_u32 s7, s62, 160
  s_cmp_lt_u32 s62, 32
  s_cselect_b32 s61, s7, s61
  s_sub_u32 s60, s62, 32
  s_cmp_lt_u32 s62, 32
  s_cselect_b32 s60, 0x10000, s60
  s_min_u32 s63, s70, 32
  s_add_u32 s62, s63, s60
  s_add_u32 s7, s62, 192
  s_cmp_lt_u32 s62, 32
  s_cselect_b32 s61, s7, s61
  s_sub_u32 s60, s62, 32
  s_cmp_lt_u32 s62, 32
  s_cselect_b32 s60, 0x10000, s60
  s_min_u32 s63, s71, 32
  s_add_u32 s62, s63, s60
  s_add_u32 s7, s62, 224
  s_cmp_lt_u32 s62, 32
  s_cselect_b32 s61, s7, s61
  s_sub_u32 s60, s62, 32
  s_cmp_lt_u32 s62, 32
  s_cselect_b32 s60, 0x10000, s60
PUTROLE:
  v_mov_b32 v1, s61
  v_mov_b32 v2, 0
  ds_write_b32 v2, v1
  s_waitcnt lgkmcnt(0)
GOTROLE:
  s_barrier
  v_mov_b32 v2, 0
  ds_read_b32 v1, v2
  s_waitcnt lgkmcnt(0)
  v_readfirstlane_b32 s4, v1
  s_barrier
  s_cmp_ge_u32 s4, 256
  s_cbranch_scc1 EXIT
  s_lshr_b32 s6, s4, 5
  s_and_b32 s7, s4, 31
  s_cmp_eq_u32 s6, 0
  s_cbranch_scc1 R_C
  s_cmp_ge_u32 s6, 5
  s_cbranch_scc1 R_HIGH
  s_sub_u32 s6, s6, 1
  s_cmp_lt_u32 s7, 24
  s_cbranch_scc1 R_LOW
  s_lshl_b32 s6, s6, 3
  s_add_u32 s7, s7, s6
  s_sub_u32 s7, s7, 24
  s_branch R_A
R_LOW:
  s_mul_i32 s6, s6, 24
  s_add_u32 s7, s7, s6
  s_cmp_lt_u32 s7, 48
  s_cbranch_scc1 R_W
  s_sub_u32 s7, s7, 48
  s_branch R_D
R_HIGH:
  s_sub_u32 s6, s6, 5
  s_lshl_b32 s6, s6, 4
  s_cmp_lt_u32 s7, 16
  s_cselect_b32 s60, 0, 16
  s_add_u32 s7, s7, s6
  s_sub_u32 s7, s7, s60
  s_cmp_eq_u32 s60, 16
  s_cbranch_scc1 R_Q
R_G:
  s_mov_b32 s62, 131072
  s_mov_b32 s66, 0x3f803f80
  s_and_b32 s67, s5, 1
  s_mul_i32 s65, s5, 40960
  s_mul_i32 s60, s7, 1536
  s_add_u32 s60, s60, 68157440
  s_lshl_b32 s58, s5, 8
  s_add_u32 s58, s58, s60
  s_lshr_b32 s59, s5, 1
  s_lshl_b32 s59, s59, 8
  s_add_u32 s59, s59, s60
  s_lshl_b32 s60, s67, 3
  s_add_u32 s59, s59, s60
  s_add_u32 s59, s59, 1024
  v_and_b32 v8, 31, v0
  v_lshrrev_b32 v10, 5, v0
  v_lshrrev_b32 v4, 3, v8
  v_mul_u32_u24 v4, 73728, v4
  v_lshl_add_u32 v4, v10, 7, v4
  v_and_b32 v10, 7, v0
  v_lshl_add_u32 v4, v10, 4, v4
  v_mov_b32 v176, -1
  v_mov_b32 v177, -1
  v_mov_b32 v178, -1
  v_mov_b32 v179, -1
  v_lshrrev_b32 v8, 1, v0
  v_lshlrev_b32 v8, 13, v8
  v_and_b32 v9, 1, v0
  v_lshl_add_u32 v8, v9, 7, v8
  v_lshlrev_b32 v9, 7, v0
  s_and_b32 s63, s7, 15
  s_lshl_b32 s63, s63, 13
  s_cmp_eq_u32 s5, 3
  s_cselect_b32 s63, s63, 0x10000000
  s_lshl_b32 s61, s5, 18
  s_cmp_ge_u32 s7, 32
  s_cbranch_scc1 GV_1
  s_lshl_b32 s60, s7, 8
  s_add_u32 s61, s61, s60
  s_add_u32 s60, s61, 2359296
  buffer_load_dword v180, v8, s[16:19], s60 offen
  s_add_u32 s60, s61, 3407872
  buffer_load_dword v180, v8, s[16:19], s60 offen
  s_add_u32 s60, s61, 4456448
  buffer_load_dword v180, v8, s[16:19], s60 offen
  s_add_u32 s60, s61, 0
  buffer_load_dword v180, v8, s[20:23], s60 offen
  s_add_u32 s60, s61, 1048576
  buffer_load_dword v180, v8, s[20:23], s60 offen
  buffer_load_dword v180, v9, s[8:11], s63 offen
  s_add_u32 s60, s61, 2097152
  buffer_load_dword v180, v8, s[20:23], s60 offen
  s_add_u32 s60, s61, 3145728
  buffer_load_dword v180, v8, s[20:23], s60 offen
  s_add_u32 s60, s61, 4194304
  buffer_load_dword v180, v8, s[20:23], s60 offen
  s_branch GX_2
GV_1:
  s_sub_u32 s60, s7, 32
  s_lshl_b32 s60, s60, 9
  s_add_u32 s61, s61, s60
  s_add_u32 s60, s61, 2359296
  buffer_load_dword v180, v8, s[24:27], s60 offen
  s_add_u32 s60, s61, 3407872
  buffer_load_dword v180, v8, s[24:27], s60 offen
  s_add_u32 s60, s61, 4456448
  buffer_load_dword v180, v8, s[24:27], s60 offen
  s_add_u32 s60, s61, 256
  buffer_load_dword v180, v8, s[24:27], s60 offen
  s_add_u32 s60, s61, 1048832
  buffer_load_dword v180, v8, s[24:27], s60 offen
  buffer_load_dword v180, v9, s[8:11], s63 offen
  s_add_u32 s60, s61, 2097408
  buffer_load_dword v180, v8, s[24:27], s60 offen
  s_add_u32 s60, s61, 3145984
  buffer_load_dword v180, v8, s[24:27], s60 offen
  s_add_u32 s60, s61, 4194560
  buffer_load_dword v180, v8, s[24:27], s60 offen
GX_2:
  s_mov_b32 s60, 1048576
POLLD_3:
  buffer_load_dword v8, off, s[48:51], 0 offset:64 sc1
  s_waitcnt vmcnt(0)
  v_readfirstlane_b32 s61, v8
  s_sub_u32 s60, s60, 1
  s_cbranch_scc1 POLLE_4
  s_cmp_lt_u32 s61, 32
  s_cbranch_scc1 POLLD_3
POLLE_4:
  v_lshrrev_b32 v8, 1, v0
  v_mul_u32_u24 v16, 9216, v8
  v_and_b32 v8, 1, v0
  v_lshl_add_u32 v16, v8, 4, v16
  s_mul_i32 s60, s7, 192
  s_mul_i32 s61, s67, 2654208
  s_add_u32 s63, s60, s61
  s_sub_u32 s64, s60, s61
  s_lshl_b32 s60, s5, 5
  s_add_u32 s60, s60, s63
  s_add_u32 s60, s60, 0
  s_add_u32 m0, s65, 0
  s_nop 0
  buffer_load_dwordx4 v16, s[32:35], s60 offen lds
  s_add_u32 m0, s65, 1024
  s_nop 0
  buffer_load_dwordx4 v16, s[36:39], s60 offen lds
  s_lshl_b32 s60, s5, 5
  s_add_u32 s60, s60, s63
  s_add_u32 s60, s60, 294912
  s_add_u32 m0, s65, 2048
  s_nop 0
  buffer_load_dwordx4 v16, s[32:35], s60 offen lds
  s_add_u32 m0, s65, 3072
  s_nop 0
  buffer_load_dwordx4 v16, s[36:39], s60 offen lds
  s_lshl_b32 s60, s5, 5
  s_add_u32 s60, s60, s63
  s_add_u32 s60, s60, 589824
  s_add_u32 m0, s65, 4096
  s_nop 0
  buffer_load_dwordx4 v16, s[32:35], s60 offen lds
  s_add_u32 m0, s65, 5120
  s_nop 0
  buffer_load_dwordx4 v16, s[36:39], s60 offen lds
  s_lshl_b32 s60, s5, 5
  s_add_u32 s60, s60, s63
  s_add_u32 s60, s60, 884736
  s_add_u32 m0, s65, 6144
  s_nop 0
  buffer_load_dwordx4 v16, s[32:35], s60 offen lds
  s_add_u32 m0, s65, 7168
  s_nop 0
  buffer_load_dwordx4 v16, s[36:39], s60 offen lds
  s_lshl_b32 s60, s5, 5
  s_add_u32 s60, s60, s63
  s_add_u32 s60, s60, 1179648
  s_add_u32 m0, s65, 8192
  s_nop 0
  buffer_load_dwordx4 v16, s[32:35], s60 offen lds
  s_add_u32 m0, s65, 9216
  s_nop 0
  buffer_load_dwordx4 v16, s[36:39], s60 offen lds
  s_lshl_b32 s60, s5, 5
  s_add_u32 s60, s60, s63
  s_add_u32 s60, s60, 1474560
  s_add_u32 m0, s65, 10240
  s_nop 0
  buffer_load_dwordx4 v16, s[32:35], s60 offen lds
  s_add_u32 m0, s65, 11264
  s_nop 0
  buffer_load_dwordx4 v16, s[36:39], s60 offen lds
  s_lshl_b32 s60, s5, 5
  s_add_u32 s60, s60, s63
  s_add_u32 s60, s60, 1769472
  s_add_u32 m0, s65, 12288
  s_nop 0
  buffer_load_dwordx4 v16, s[32:35], s60 offen lds
  s_add_u32 m0, s65, 13312
  s_nop 0
  buffer_load_dwordx4 v16, s[36:39], s60 offen lds
  s_lshl_b32 s60, s5, 5
  s_add_u32 s60, s60, s63
  s_add_u32 s60, s60, 2064384
  s_add_u32 m0, s65, 14336
  s_nop 0
  buffer_load_dwordx4 v16, s[32:35], s60 offen lds
  s_add_u32 m0, s65, 15360
  s_nop 0
  buffer_load_dwordx4 v16, s[36:39], s60 offen lds
  s_lshl_b32 s60, s5, 5
  s_add_u32 s60, s60, s63
  s_add_u32 s60, s60, 2359296
  s_add_u32 m0, s65, 16384
  s_nop 0
  buffer_load_dwordx4 v16, s[32:35], s60 offen lds
  s_add_u32 m0, s65, 17408
  s_nop 0
  buffer_load_dwordx4 v16, s[36:39], s60 offen lds
  s_lshl_b32 s60, s5, 5
  s_add_u32 s60, s60, s64
  s_add_u32 s60, s60, 2654208
  s_add_u32 m0, s65, 18432
  s_nop 0
  buffer_load_dwordx4 v16, s[32:35], s60 offen lds
  s_add_u32 m0, s65, 19456
  s_nop 0
  buffer_load_dwordx4 v16, s[36:39], s60 offen lds
  s_lshl_b32 s60, s5, 5
  s_add_u32 s60, s60, s64
  s_add_u32 s60, s60, 2949120
  s_add_u32 m0, s65, 20480
  s_nop 0
  buffer_load_dwordx4 v16, s[32:35], s60 offen lds
  s_add_u32 m0, s65, 21504
  s_nop 0
  buffer_load_dwordx4 v16, s[36:39], s60 offen lds
  s_lshl_b32 s60, s5, 5
  s_add_u32 s60, s60, s64
  s_add_u32 s60, s60, 3244032
  s_add_u32 m0, s65, 22528
  s_nop 0
  buffer_load_dwordx4 v16, s[32:35], s60 offen lds
  s_add_u32 m0, s65, 23552
  s_nop 0
  buffer_load_dwordx4 v16, s[36:39], s60 offen lds
  v_lshrrev_b32 v8, 5, v0
  v_lshlrev_b32 v17, 8, v8
  v_bfe_u32 v9, v0, 4, 1
  v_lshl_add_u32 v17, v9, 10, v17
  v_and_b32 v10, 15, v0
  v_lshl_add_u32 v17, v10, 3, v17
  v_add_u32 v17, s65, v17
  s_waitcnt vmcnt(22)
  ds_read_b64_tr_b16 a[0:1], v17 offset:0
  ds_read_b64_tr_b16 a[2:3], v17 offset:128
  ds_read_b64_tr_b16 a[4:5], v17 offset:512
  ds_read_b64_tr_b16 a[6:7], v17 offset:640
  s_waitcnt lgkmcnt(0)
  s_lshl_b32 s60, s5, 5
  s_add_u32 s60, s60, s64
  s_add_u32 s60, s60, 3538944
  s_add_u32 m0, s65, 0
  s_nop 0
  buffer_load_dwordx4 v16, s[32:35], s60 offen lds
  s_add_u32 m0, s65, 1024
  s_nop 0
  buffer_load_dwordx4 v16, s[36:39], s60 offen lds
  s_waitcnt vmcnt(22)
  ds_read_b64_tr_b16 a[8:9], v17 offset:2048
  ds_read_b64_tr_b16 a[10:11], v17 offset:2176
  ds_read_b64_tr_b16 a[12:13], v17 offset:2560
  ds_read_b64_tr_b16 a[14:15], v17 offset:2688
  s_waitcnt lgkmcnt(0)
  s_lshl_b32 s60, s5, 5
  s_add_u32 s60, s60, s64
  s_add_u32 s60, s60, 3833856
  s_add_u32 m0, s65, 2048
  s_nop 0
  buffer_load_dwordx4 v16, s[32:35], s60 offen lds
  s_add_u32 m0, s65, 3072
  s_nop 0
  buffer_load_dwordx4 v16, s[36:39], s60 offen lds
  s_waitcnt vmcnt(22)
  ds_read_b64_tr_b16 a[16:17], v17 offset:4096
  ds_read_b64_tr_b16 a[18:19], v17 offset:4224
  ds_read_b64_tr_b16 a[20:21], v17 offset:4608
  ds_read_b64_tr_b16 a[22:23], v17 offset:4736
  s_waitcnt lgkmcnt(0)
  s_lshl_b32 s60, s5, 5
  s_add_u32 s60, s60, s64
  s_add_u32 s60, s60, 4128768
  s_add_u32 m0, s65, 4096
  s_nop 0
  buffer_load_dwordx4 v16, s[32:35], s60 offen lds
  s_add_u32 m0, s65, 5120
  s_nop 0
  buffer_load_dwordx4 v16, s[36:39], s60 offen lds
  s_waitcnt vmcnt(22)
  ds_read_b64_tr_b16 a[24:25], v17 offset:6144
  ds_read_b64_tr_b16 a[26:27], v17 offset:6272
  ds_read_b64_tr_b16 a[28:29], v17 offset:6656
  ds_read_b64_tr_b16 a[30:31], v17 offset:6784
  s_waitcnt lgkmcnt(0)
  s_lshl_b32 s60, s5, 5
  s_add_u32 s60, s60, s64
  s_add_u32 s60, s60, 4423680
  s_add_u32 m0, s65, 6144
  s_nop 0
  buffer_load_dwordx4 v16, s[32:35], s60 offen lds
  s_add_u32 m0, s65, 7168
  s_nop 0
  buffer_load_dwordx4 v16, s[36:39], s60 offen lds
  s_waitcnt vmcnt(22)
  ds_read_b64_tr_b16 a[32:33], v17 offset:8192
  ds_read_b64_tr_b16 a[34:35], v17 offset:8320
  ds_read_b64_tr_b16 a[36:37], v17 offset:8704
  ds_read_b64_tr_b16 a[38:39], v17 offset:8832
  s_waitcnt lgkmcnt(0)
  s_lshl_b32 s60, s5, 5
  s_add_u32 s60, s60, s64
  s_add_u32 s60, s60, 4718592
  s_add_u32 m0, s65, 8192
  s_nop 0
  buffer_load_dwordx4 v16, s[32:35], s60 offen lds
  s_add_u32 m0, s65, 9216
  s_nop 0
  buffer_load_dwordx4 v16, s[36:39], s60 offen lds
  s_waitcnt vmcnt(22)
  ds_read_b64_tr_b16 a[40:41], v17 offset:10240
  ds_read_b64_tr_b16 a[42:43], v17 offset:10368
  ds_read_b64_tr_b16 a[44:45], v17 offset:10752
  ds_read_b64_tr_b16 a[46:47], v17 offset:10880
  s_waitcnt lgkmcnt(0)
  s_lshl_b32 s60, s5, 5
  s_add_u32 s60, s60, s64
  s_add_u32 s60, s60, 5013504
  s_add_u32 m0, s65, 10240
  s_nop 0
  buffer_load_dwordx4 v16, s[32:35], s60 offen lds
  s_add_u32 m0, s65, 11264
  s_nop 0
  buffer_load_dwordx4 v16, s[36:39], s60 offen lds
  s_waitcnt vmcnt(22)
  ds_read_b64_tr_b16 a[48:49], v17 offset:12288
  ds_read_b64_tr_b16 a[50:51], v17 offset:12416
  ds_read_b64_tr_b16 a[52:53], v17 offset:12800
  ds_read_b64_tr_b16 a[54:55], v17 offset:12928
  s_waitcnt lgkmcnt(0)
  s_lshr_b32 s60, s5, 1
  s_lshl_b32 s60, s60, 5
  s_add_u32 s60, s60, s63
  s_add_u32 s60, s60, 128
  s_add_u32 m0, s65, 12288
  s_nop 0
  buffer_load_dwordx4 v16, s[32:35], s60 offen lds
  s_add_u32 m0, s65, 13312
  s_nop 0
  buffer_load_dwordx4 v16, s[36:39], s60 offen lds
  s_waitcnt vmcnt(22)
  ds_read_b64_tr_b16 a[56:57], v17 offset:14336
  ds_read_b64_tr_b16 a[58:59], v17 offset:14464
  ds_read_b64_tr_b16 a[60:61], v17 offset:14848
  ds_read_b64_tr_b16 a[62:63], v17 offset:14976
  s_waitcnt lgkmcnt(0)
  s_lshr_b32 s60, s5, 1
  s_lshl_b32 s60, s60, 5
  s_add_u32 s60, s60, s63
  s_add_u32 s60, s60, 295040
  s_add_u32 m0, s65, 14336
  s_nop 0
  buffer_load_dwordx4 v16, s[32:35], s60 offen lds
  s_add_u32 m0, s65, 15360
  s_nop 0
  buffer_load_dwordx4 v16, s[36:39], s60 offen lds
  s_waitcnt vmcnt(22)
  ds_read_b64_tr_b16 a[64:65], v17 offset:16384
  ds_read_b64_tr_b16 a[66:67], v17 offset:16512
  ds_read_b64_tr_b16 a[68:69], v17 offset:16896
  ds_read_b64_tr_b16 a[70:71], v17 offset:17024
  s_waitcnt lgkmcnt(0)
  s_lshr_b32 s60, s5, 1
  s_lshl_b32 s60, s60, 5
  s_add_u32 s60, s60, s63
  s_add_u32 s60, s60, 589952
  s_add_u32 m0, s65, 16384
  s_nop 0
  buffer_load_dwordx4 v16, s[32:35], s60 offen lds
  s_add_u32 m0, s65, 17408
  s_nop 0
  buffer_load_dwordx4 v16, s[36:39], s60 offen lds
  s_waitcnt vmcnt(22)
  ds_read_b64_tr_b16 a[72:73], v17 offset:18432
  ds_read_b64_tr_b16 a[74:75], v17 offset:18560
  ds_read_b64_tr_b16 a[76:77], v17 offset:18944
  ds_read_b64_tr_b16 a[78:79], v17 offset:19072
  s_waitcnt lgkmcnt(0)
  s_lshr_b32 s60, s5, 1
  s_lshl_b32 s60, s60, 5
  s_add_u32 s60, s60, s63
  s_add_u32 s60, s60, 884864
  s_add_u32 m0, s65, 18432
  s_nop 0
  buffer_load_dwordx4 v16, s[32:35], s60 offen lds
  s_add_u32 m0, s65, 19456
  s_nop 0
  buffer_load_dwordx4 v16, s[36:39], s60 offen lds
  s_waitcnt vmcnt(22)
  ds_read_b64_tr_b16 a[80:81], v17 offset:20480
  ds_read_b64_tr_b16 a[82:83], v17 offset:20608
  ds_read_b64_tr_b16 a[84:85], v17 offset:20992
  ds_read_b64_tr_b16 a[86:87], v17 offset:21120
  s_waitcnt lgkmcnt(0)
  s_lshr_b32 s60, s5, 1
  s_lshl_b32 s60, s60, 5
  s_add_u32 s60, s60, s63
  s_add_u32 s60, s60, 1179776
  s_add_u32 m0, s65, 20480
  s_nop 0
  buffer_load_dwordx4 v16, s[32:35], s60 offen lds
  s_add_u32 m0, s65, 21504
  s_nop 0
  buffer_load_dwordx4 v16, s[36:39], s60 offen lds
  s_waitcnt vmcnt(22)
  ds_read_b64_tr_b16 a[88:89], v17 offset:22528
  ds_read_b64_tr_b16 a[90:91], v17 offset:22656
  ds_read_b64_tr_b16 a[92:93], v17 offset:23040
  ds_read_b64_tr_b16 a[94:95], v17 offset:23168
  s_waitcnt lgkmcnt(0)
  s_lshr_b32 s60, s5, 1
  s_lshl_b32 s60, s60, 5
  s_add_u32 s60, s60, s63
  s_add_u32 s60, s60, 1474688
  s_add_u32 m0, s65, 22528
  s_nop 0
  buffer_load_dwordx4 v16, s[32:35], s60 offen lds
  s_add_u32 m0, s65, 23552
  s_nop 0
  buffer_load_dwordx4 v16, s[36:39], s60 offen lds
  s_waitcnt vmcnt(22)
  ds_read_b64_tr_b16 a[96:97], v17 offset:0
  ds_read_b64_tr_b16 a[98:99], v17 offset:128
  ds_read_b64_tr_b16 a[100:101], v17 offset:512
  ds_read_b64_tr_b16 a[102:103], v17 offset:640
  s_waitcnt lgkmcnt(0)
  s_lshr_b32 s60, s5, 1
  s_lshl_b32 s60, s60, 5
  s_add_u32 s60, s60, s63
  s_add_u32 s60, s60, 1769600
  s_add_u32 m0, s65, 0
  s_nop 0
  buffer_load_dwordx4 v16, s[32:35], s60 offen lds
  s_add_u32 m0, s65, 1024
  s_nop 0
  buffer_load_dwordx4 v16, s[36:39], s60 offen lds
  s_waitcnt vmcnt(22)
  ds_read_b64_tr_b16 a[104:105], v17 offset:2048
  ds_read_b64_tr_b16 a[106:107], v17 offset:2176
  ds_read_b64_tr_b16 a[108:109], v17 offset:2560
  ds_read_b64_tr_b16 a[110:111], v17 offset:2688
  s_waitcnt lgkmcnt(0)
  s_lshr_b32 s60, s5, 1
  s_lshl_b32 s60, s60, 5
  s_add_u32 s60, s60, s63
  s_add_u32 s60, s60, 2064512
  s_add_u32 m0, s65, 2048
  s_nop 0
  buffer_load_dwordx4 v16, s[32:35], s60 offen lds
  s_add_u32 m0, s65, 3072
  s_nop 0
  buffer_load_dwordx4 v16, s[36:39], s60 offen lds
  s_waitcnt vmcnt(22)
  ds_read_b64_tr_b16 a[112:113], v17 offset:4096
  ds_read_b64_tr_b16 a[114:115], v17 offset:4224
  ds_read_b64_tr_b16 a[116:117], v17 offset:4608
  ds_read_b64_tr_b16 a[118:119], v17 offset:4736
  s_waitcnt lgkmcnt(0)
  s_lshr_b32 s60, s5, 1
  s_lshl_b32 s60, s60, 5
  s_add_u32 s60, s60, s63
  s_add_u32 s60, s60, 2359424
  s_add_u32 m0, s65, 4096
  s_nop 0
  buffer_load_dwordx4 v16, s[32:35], s60 offen lds
  s_add_u32 m0, s65, 5120
  s_nop 0
  buffer_load_dwordx4 v16, s[36:39], s60 offen lds
  s_waitcnt vmcnt(22)
  ds_read_b64_tr_b16 a[120:121], v17 offset:6144
  ds_read_b64_tr_b16 a[122:123], v17 offset:6272
  ds_read_b64_tr_b16 a[124:125], v17 offset:6656
  ds_read_b64_tr_b16 a[126:127], v17 offset:6784
  s_waitcnt vmcnt(20)
  ds_read_b64_tr_b16 a[128:129], v17 offset:8192
  ds_read_b64_tr_b16 a[130:131], v17 offset:8320
  ds_read_b64_tr_b16 a[132:133], v17 offset:8704
  ds_read_b64_tr_b16 a[134:135], v17 offset:8832
  s_waitcnt vmcnt(18)
  ds_read_b64_tr_b16 a[136:137], v17 offset:10240
  ds_read_b64_tr_b16 a[138:139], v17 offset:10368
  ds_read_b64_tr_b16 a[140:141], v17 offset:10752
  ds_read_b64_tr_b16 a[142:143], v17 offset:10880
  s_lshl_b32 s60, s67, 4
  v_xor_b32 v17, s60, v17
  s_waitcnt vmcnt(16)
  ds_read_b64_tr_b16 a[144:145], v17 offset:12288
  ds_read_b64_tr_b16 a[146:147], v17 offset:12416
  ds_read_b64_tr_b16 a[148:149], v17 offset:12800
  ds_read_b64_tr_b16 a[150:151], v17 offset:12928
  s_waitcnt vmcnt(14)
  ds_read_b64_tr_b16 a[152:153], v17 offset:14336
  ds_read_b64_tr_b16 a[154:155], v17 offset:14464
  ds_read_b64_tr_b16 a[156:157], v17 offset:14848
  ds_read_b64_tr_b16 a[158:159], v17 offset:14976
  s_waitcnt vmcnt(12)
  ds_read_b64_tr_b16 a[160:161], v17 offset:16384
  ds_read_b64_tr_b16 a[162:163], v17 offset:16512
  ds_read_b64_tr_b16 a[164:165], v17 offset:16896
  ds_read_b64_tr_b16 a[166:167], v17 offset:17024
  s_waitcnt vmcnt(10)
  ds_read_b64_tr_b16 a[168:169], v17 offset:18432
  ds_read_b64_tr_b16 a[170:171], v17 offset:18560
  ds_read_b64_tr_b16 a[172:173], v17 offset:18944
  ds_read_b64_tr_b16 a[174:175], v17 offset:19072
  s_waitcnt vmcnt(8)
  ds_read_b64_tr_b16 a[176:177], v17 offset:20480
  ds_read_b64_tr_b16 a[178:179], v17 offset:20608
  ds_read_b64_tr_b16 a[180:181], v17 offset:20992
  ds_read_b64_tr_b16 a[182:183], v17 offset:21120
  s_waitcnt vmcnt(6)
  ds_read_b64_tr_b16 a[184:185], v17 offset:22528
  ds_read_b64_tr_b16 a[186:187], v17 offset:22656
  ds_read_b64_tr_b16 a[188:189], v17 offset:23040
  ds_read_b64_tr_b16 a[190:191], v17 offset:23168
  s_waitcnt vmcnt(4)
  ds_read_b64_tr_b16 a[192:193], v17 offset:0
  ds_read_b64_tr_b16 a[194:195], v17 offset:128
  ds_read_b64_tr_b16 a[196:197], v17 offset:512
  ds_read_b64_tr_b16 a[198:199], v17 offset:640
  s_waitcnt vmcnt(2)
  ds_read_b64_tr_b16 a[200:201], v17 offset:2048
  ds_read_b64_tr_b16 a[202:203], v17 offset:2176
  ds_read_b64_tr_b16 a[204:205], v17 offset:2560
  ds_read_b64_tr_b16 a[206:207], v17 offset:2688
  s_waitcnt vmcnt(0)
  ds_read_b64_tr_b16 a[208:209], v17 offset:4096
  ds_read_b64_tr_b16 a[210:211], v17 offset:4224
  ds_read_b64_tr_b16 a[212:213], v17 offset:4608
  ds_read_b64_tr_b16 a[214:215], v17 offset:4736
  v_mov_b32 v168, s66
  v_mov_b32 v169, s66
  v_mov_b32 v170, s66
  v_mov_b32 v171, s66
  s_nop 1
  v_mfma_f32_32x32x16_bf16 v[72:87], a[0:3], v[168:171], 0
  s_waitcnt lgkmcnt(15)
  v_mfma_f32_32x32x16_bf16 v[88:103], a[144:147], v[168:171], 0
  v_mfma_f32_32x32x16_bf16 v[72:87], a[4:7], v[168:171], v[72:87]
  v_mfma_f32_32x32x16_bf16 v[88:103], a[148:151], v[168:171], v[88:103]
  v_mfma_f32_32x32x16_bf16 v[72:87], a[8:11], v[168:171], v[72:87]
  v_mfma_f32_32x32x16_bf16 v[88:103], a[152:155], v[168:171], v[88:103]
  v_mfma_f32_32x32x16_bf16 v[72:87], a[12:15], v[168:171], v[72:87]
  v_mfma_f32_32x32x16_bf16 v[88:103], a[156:159], v[168:171], v[88:103]
  v_mfma_f32_32x32x16_bf16 v[72:87], a[16:19], v[168:171], v[72:87]
  v_mfma_f32_32x32x16_bf16 v[88:103], a[160:163], v[168:171], v[88:103]
  v_mfma_f32_32x32x16_bf16 v[72:87], a[20:23], v[168:171], v[72:87]
  v_mfma_f32_32x32x16_bf16 v[88:103], a[164:167], v[168:171], v[88:103]
  v_mfma_f32_32x32x16_bf16 v[72:87], a[24:27], v[168:171], v[72:87]
  v_mfma_f32_32x32x16_bf16 v[88:103], a[168:171], v[168:171], v[88:103]
  v_mfma_f32_32x32x16_bf16 v[72:87], a[28:31], v[168:171], v[72:87]
  v_mfma_f32_32x32x16_bf16 v[88:103], a[172:175], v[168:171], v[88:103]
  v_mfma_f32_32x32x16_bf16 v[72:87], a[32:35], v[168:171], v[72:87]
  v_mfma_f32_32x32x16_bf16 v[88:103], a[176:179], v[168:171], v[88:103]
  v_mfma_f32_32x32x16_bf16 v[72:87], a[36:39], v[168:171], v[72:87]
  v_mfma_f32_32x32x16_bf16 v[88:103], a[180:183], v[168:171], v[88:103]
  v_mfma_f32_32x32x16_bf16 v[72:87], a[40:43], v[168:171], v[72:87]
  s_waitcnt lgkmcnt(14)
  v_mfma_f32_32x32x16_bf16 v[88:103], a[184:187], v[168:171], v[88:103]
  v_mfma_f32_32x32x16_bf16 v[72:87], a[44:47], v[168:171], v[72:87]
  s_waitcnt lgkmcnt(12)
  v_mfma_f32_32x32x16_bf16 v[88:103], a[188:191], v[168:171], v[88:103]
  v_mfma_f32_32x32x16_bf16 v[72:87], a[48:51], v[168:171], v[72:87]
  s_waitcnt lgkmcnt(10)
  v_mfma_f32_32x32x16_bf16 v[88:103], a[192:195], v[168:171], v[88:103]
  v_mfma_f32_32x32x16_bf16 v[72:87], a[52:55], v[168:171], v[72:87]
  s_waitcnt lgkmcnt(8)
  v_mfma_f32_32x32x16_bf16 v[88:103], a[196:199], v[168:171], v[88:103]
  v_mfma_f32_32x32x16_bf16 v[72:87], a[56:59], v[168:171], v[72:87]
  s_waitcnt lgkmcnt(6)
  v_mfma_f32_32x32x16_bf16 v[88:103], a[200:203], v[168:171], v[88:103]
  v_mfma_f32_32x32x16_bf16 v[72:87], a[60:63], v[168:171], v[72:87]
  s_waitcnt lgkmcnt(4)
  v_mfma_f32_32x32x16_bf16 v[88:103], a[204:207], v[168:171], v[88:103]
  v_mfma_f32_32x32x16_bf16 v[72:87], a[64:67], v[168:171], v[72:87]
  s_waitcnt lgkmcnt(2)
  v_mfma_f32_32x32x16_bf16 v[88:103], a[208:211], v[168:171], v[88:103]
  v_mfma_f32_32x32x16_bf16 v[72:87], a[68:71], v[168:171], v[72:87]
  s_waitcnt lgkmcnt(0)
  v_mfma_f32_32x32x16_bf16 v[88:103], a[212:215], v[168:171], v[88:103]
  v_mfma_f32_32x32x16_bf16 v[72:87], a[72:75], v[168:171], v[72:87]
  v_mfma_f32_32x32x16_bf16 v[72:87], a[76:79], v[168:171], v[72:87]
  v_mfma_f32_32x32x16_bf16 v[72:87], a[80:83], v[168:171], v[72:87]
  v_mfma_f32_32x32x16_bf16 v[72:87], a[84:87], v[168:171], v[72:87]
  v_mfma_f32_32x32x16_bf16 v[72:87], a[88:91], v[168:171], v[72:87]
  v_mfma_f32_32x32x16_bf16 v[72:87], a[92:95], v[168:171], v[72:87]
  v_mfma_f32_32x32x16_bf16 v[72:87], a[96:99], v[168:171], v[72:87]
  v_mfma_f32_32x32x16_bf16 v[72:87], a[100:103], v[168:171], v[72:87]
  v_mfma_f32_32x32x16_bf16 v[72:87], a[104:107], v[168:171], v[72:87]
  v_mfma_f32_32x32x16_bf16 v[72:87], a[108:111], v[168:171], v[72:87]
  v_mfma_f32_32x32x16_bf16 v[72:87], a[112:115], v[168:171], v[72:87]
  v_mfma_f32_32x32x16_bf16 v[72:87], a[116:119], v[168:171], v[72:87]
  v_mfma_f32_32x32x16_bf16 v[72:87], a[120:123], v[168:171], v[72:87]
  v_mfma_f32_32x32x16_bf16 v[72:87], a[124:127], v[168:171], v[72:87]
  v_mfma_f32_32x32x16_bf16 v[72:87], a[128:131], v[168:171], v[72:87]
  v_mfma_f32_32x32x16_bf16 v[72:87], a[132:135], v[168:171], v[72:87]
  v_mfma_f32_32x32x16_bf16 v[72:87], a[136:139], v[168:171], v[72:87]
  v_mfma_f32_32x32x16_bf16 v[72:87], a[140:143], v[168:171], v[72:87]
  v_lshlrev_b32 v0, 4, v0
  s_mul_i32 s60, s67, 18432
  v_add_u32 v1, s60, v0
  s_xor_b32 s60, s60, 18432
  v_add_u32 v2, s60, v0
  s_mul_i32 s60, s5, 9216
  v_add_u32 v3, s60, v0
  s_add_u32 s57, s60, 88080384
  s_lshl_b32 s60, s5, 10
  s_add_u32 s60, s60, 36864
  v_add_u32 v13, s60, v0
  s_add_u32 s68, s60, 88080384
  s_cmp_eq_u32 s5, 3
  s_cselect_b32 s68, 0x10000000, s68
  v_mov_b32 v5, v0
  s_mov_b32 s71, 40960
  s_lshl_b32 s60, s5, 11
  s_add_u32 s60, s60, 81920
  v_add_u32 v11, s60, v0
  v_xor_b32 v12, 2048, v11
  s_mov_b32 s56, 0
  s_waitcnt lgkmcnt(0)
  s_barrier
  ds_write_b128 v11, v[92:95] offset:0
  ds_write_b128 v11, v[100:103] offset:1024
  s_waitcnt lgkmcnt(0)
  s_barrier
  ds_read_b128 v[136:139], v12 offset:0
  ds_read_b128 v[140:143], v12 offset:1024
  s_waitcnt lgkmcnt(1)
  v_add_f32 v88, v88, v136
  v_add_f32 v89, v89, v137
  v_add_f32 v90, v90, v138
  v_add_f32 v91, v91, v139
  s_waitcnt lgkmcnt(0)
  v_add_f32 v96, v96, v140
  v_add_f32 v97, v97, v141
  v_add_f32 v98, v98, v142
  v_add_f32 v99, v99, v143
  s_mov_b32 s60, 1048576
POLLD_5:
  buffer_load_dword v8, off, s[48:51], 0 offset:64 sc1
  s_waitcnt vmcnt(0)
  v_readfirstlane_b32 s61, v8
  s_sub_u32 s60, s60, 1
  s_cbranch_scc1 POLLE_6
  s_cmp_lt_u32 s61, 32
  s_cbranch_scc1 POLLD_5
POLLE_6:
  s_waitcnt vmcnt(0) lgkmcnt(0)
  s_mov_b64 vcc, -1
GR_7:
  s_sub_i32 s62, s62, 1
  s_cmp_lt_i32 s62, 0
  s_cbranch_scc1 GK_9
  s_mov_b64 exec, vcc
  s_waitcnt lgkmcnt(0)
  s_add_u32 s69, s57, 4096
  s_add_u32 s70, s57, 8192
  buffer_load_dwordx4 v[32:35], v0, s[52:55], s57 offen offset:0 sc1
  buffer_load_dwordx4 v[36:39], v0, s[52:55], s57 offen offset:1024 sc1
  buffer_load_dwordx4 v[40:43], v0, s[52:55], s57 offen offset:2048 sc1
  buffer_load_dwordx4 v[44:47], v0, s[52:55], s57 offen offset:3072 sc1
  buffer_load_dwordx4 v[48:51], v0, s[52:55], s69 offen offset:0 sc1
  buffer_load_dwordx4 v[52:55], v0, s[52:55], s69 offen offset:1024 sc1
  buffer_load_dwordx4 v[56:59], v0, s[52:55], s69 offen offset:2048 sc1
  buffer_load_dwordx4 v[60:63], v0, s[52:55], s69 offen offset:3072 sc1
  buffer_load_dwordx4 v[64:67], v0, s[52:55], s70 offen offset:0 sc1
  buffer_load_dwordx4 v[68:71], v0, s[52:55], s68 offen sc1
  s_waitcnt vmcnt(9)
  ds_write_b128 v3, v[32:35] offset:0
  v_max3_u32 v7, v32, v33, v34
  v_max_u32 v7, v35, v7
  s_waitcnt vmcnt(8)
  ds_write_b128 v3, v[36:39] offset:1024
  v_max3_u32 v7, v36, v37, v7
  v_max3_u32 v7, v38, v39, v7
  s_waitcnt vmcnt(7)
  ds_write_b128 v3, v[40:43] offset:2048
  v_max3_u32 v7, v40, v41, v7
  v_max3_u32 v7, v42, v43, v7
  s_waitcnt vmcnt(6)
  ds_write_b128 v3, v[44:47] offset:3072
  v_max3_u32 v7, v44, v45, v7
  v_max3_u32 v7, v46, v47, v7
  s_waitcnt vmcnt(5)
  ds_write_b128 v3, v[48:51] offset:4096
  v_max3_u32 v7, v48, v49, v7
  v_max3_u32 v7, v50, v51, v7
  s_waitcnt vmcnt(4)
  ds_write_b128 v3, v[52:55] offset:5120
  v_max3_u32 v7, v52, v53, v7
  v_max3_u32 v7, v54, v55, v7
  s_waitcnt vmcnt(3)
  ds_write_b128 v3, v[56:59] offset:6144
  v_max3_u32 v7, v56, v57, v7
  v_max3_u32 v7, v58, v59, v7
  s_waitcnt vmcnt(2)
  ds_write_b128 v3, v[60:63] offset:7168
  v_max3_u32 v7, v60, v61, v7
  v_max3_u32 v7, v62, v63, v7
  s_waitcnt vmcnt(1)
  ds_write_b128 v3, v[64:67] offset:8192
  v_max3_u32 v7, v64, v65, v7
  v_max3_u32 v7, v66, v67, v7
  s_waitcnt vmcnt(0)
  ds_write_b128 v13, v[68:71] offset:0
  v_max3_u32 v7, v68, v69, v7
  v_max3_u32 v7, v70, v71, v7
  v_cmp_eq_u32 vcc, -1, v7
  s_cbranch_vccnz GR_7
  s_branch GK_9
GT_8:
  s_waitcnt vmcnt(11)
  ds_write_b128 v3, v[32:35] offset:0
  v_max3_u32 v7, v32, v33, v34
  v_max_u32 v7, v35, v7
  s_waitcnt vmcnt(10)
  ds_write_b128 v3, v[36:39] offset:1024
  v_max3_u32 v7, v36, v37, v7
  v_max3_u32 v7, v38, v39, v7
  s_waitcnt vmcnt(9)
  ds_write_b128 v3, v[40:43] offset:2048
  v_max3_u32 v7, v40, v41, v7
  v_max3_u32 v7, v42, v43, v7
  s_waitcnt vmcnt(8)
  ds_write_b128 v3, v[44:47] offset:3072
  v_max3_u32 v7, v44, v45, v7
  v_max3_u32 v7, v46, v47, v7
  s_waitcnt vmcnt(7)
  ds_write_b128 v3, v[48:51] offset:4096
  v_max3_u32 v7, v48, v49, v7
  v_max3_u32 v7, v50, v51, v7
  s_waitcnt vmcnt(6)
  ds_write_b128 v3, v[52:55] offset:5120
  v_max3_u32 v7, v52, v53, v7
  v_max3_u32 v7, v54, v55, v7
  s_waitcnt vmcnt(5)
  ds_write_b128 v3, v[56:59] offset:6144
  v_max3_u32 v7, v56, v57, v7
  v_max3_u32 v7, v58, v59, v7
  s_waitcnt vmcnt(4)
  ds_write_b128 v3, v[60:63] offset:7168
  v_max3_u32 v7, v60, v61, v7
  v_max3_u32 v7, v62, v63, v7
  s_waitcnt vmcnt(3)
  ds_write_b128 v3, v[64:67] offset:8192
  v_max3_u32 v7, v64, v65, v7
  v_max3_u32 v7, v66, v67, v7
  s_waitcnt vmcnt(2)
  ds_write_b128 v13, v[68:71] offset:0
  v_max3_u32 v7, v68, v69, v7
  v_max3_u32 v7, v70, v71, v7
  v_cmp_eq_u32 vcc, -1, v7
  s_cbranch_vccnz GR_7
GK_9:
  s_mov_b64 exec, -1
  s_add_u32 s57, s57, 40960
  s_add_u32 s68, s68, 40960
  s_waitcnt lgkmcnt(0)
  s_barrier
  ds_read_b128 v[144:147], v1 offset:0
  ds_read_b128 v[148:151], v1 offset:1024
  ds_read_b128 v[152:155], v1 offset:2048
  ds_read_b128 v[156:159], v1 offset:3072
  ds_read_b128 v[160:163], v1 offset:4096
  s_waitcnt lgkmcnt(4)
  v_mfma_f32_32x32x16_bf16 v[120:135], a[144:147], v[144:147], 0
  ds_read_b128 v[20:23], v5 offset:36864
  ds_read_b128 v[24:27], v5 offset:37888
  ds_read_b128 v[28:31], v5 offset:38912
  v_mfma_f32_32x32x16_bf16 v[104:119], a[0:3], v[144:147], 0
  ds_read_b128 v[164:167], v1 offset:5120
  v_add_u32 v3, s71, v3
  v_add_u32 v13, s71, v13
  s_waitcnt lgkmcnt(7)
  v_mfma_f32_32x32x16_bf16 v[120:135], a[148:151], v[148:151], v[120:135]
  s_add_u32 s60, s58, 589824
  buffer_store_dwordx4 v[176:179], v4, s[52:55], s60 offen sc1
  v_add_u32 v5, s71, v5
  v_mfma_f32_32x32x16_bf16 v[104:119], a[4:7], v[148:151], v[104:119]
  ds_read_b128 v[144:147], v1 offset:6144
  s_waitcnt lgkmcnt(7)
  v_mfma_f32_32x32x16_bf16 v[120:135], a[152:155], v[152:155], v[120:135]
  s_add_u32 s60, s59, 589824
  buffer_store_dwordx2 v[176:177], v4, s[52:55], s60 offen sc1
  v_mfma_f32_32x32x16_bf16 v[104:119], a[8:11], v[152:155], v[104:119]
  ds_read_b128 v[148:151], v1 offset:7168
  s_waitcnt lgkmcnt(7)
  v_mfma_f32_32x32x16_bf16 v[120:135], a[156:159], v[156:159], v[120:135]
  s_waitcnt lgkmcnt(4)
  v_add_f32 v20, v20, v24
  v_add_f32 v21, v21, v25
  v_mfma_f32_32x32x16_bf16 v[104:119], a[12:15], v[156:159], v[104:119]
  ds_read_b128 v[152:155], v1 offset:8192
  v_add_f32 v22, v22, v26
  v_add_f32 v23, v23, v27
  v_mfma_f32_32x32x16_bf16 v[120:135], a[160:163], v[160:163], v[120:135]
  s_waitcnt lgkmcnt(4)
  v_add_f32 v20, v20, v28
  v_add_f32 v21, v21, v29
  v_mfma_f32_32x32x16_bf16 v[104:119], a[16:19], v[160:163], v[104:119]
  ds_read_b128 v[156:159], v1 offset:9216
  v_add_f32 v22, v22, v30
  v_add_f32 v23, v23, v31
  s_waitcnt lgkmcnt(4)
  v_mfma_f32_32x32x16_bf16 v[120:135], a[164:167], v[164:167], v[120:135]
  v_add_f32 v20, v20, v21
  v_add_f32 v22, v22, v23
  v_mfma_f32_32x32x16_bf16 v[104:119], a[20:23], v[164:167], v[104:119]
  ds_read_b128 v[160:163], v1 offset:10240
  v_add_f32 v20, v20, v22
  v_mov_b32 v21, v20
  s_waitcnt lgkmcnt(4)
  v_mfma_f32_32x32x16_bf16 v[120:135], a[168:171], v[144:147], v[120:135]
  v_permlane32_swap_b32 v20, v21
  v_mul_f32 v14, 0x3ae38e39, v20
  v_mfma_f32_32x32x16_bf16 v[104:119], a[24:27], v[144:147], v[104:119]
  ds_read_b128 v[164:167], v1 offset:11264
  v_mul_f32 v21, 0x3ae38e39, v21
  v_fma_f32 v21, -v14, v14, v21
  s_waitcnt lgkmcnt(4)
  v_mfma_f32_32x32x16_bf16 v[120:135], a[172:175], v[148:151], v[120:135]
  v_max_f32 v21, 0, v21
  v_add_f32 v21, 0x3727c5ac, v21
  v_mfma_f32_32x32x16_bf16 v[104:119], a[28:31], v[148:151], v[104:119]
  ds_read_b128 v[144:147], v1 offset:12288
  v_rcp_f32 v15, v21
  s_nop 0
  v_mul_f32 v20, v14, v15
  s_waitcnt lgkmcnt(4)
  v_mfma_f32_32x32x16_bf16 v[120:135], a[176:179], v[152:155], v[120:135]
  v_mul_f32 v180, -v20, v72
  v_mul_f32 v181, -v20, v73
  v_mfma_f32_32x32x16_bf16 v[104:119], a[32:35], v[152:155], v[104:119]
  ds_read_b128 v[148:151], v1 offset:13312
  v_mul_f32 v182, -v20, v74
  v_mul_f32 v183, -v20, v75
  s_waitcnt lgkmcnt(4)
  v_mfma_f32_32x32x16_bf16 v[120:135], a[180:183], v[156:159], v[120:135]
  v_mul_f32 v184, -v20, v76
  v_mul_f32 v185, -v20, v77
  v_mfma_f32_32x32x16_bf16 v[104:119], a[36:39], v[156:159], v[104:119]
  ds_read_b128 v[152:155], v1 offset:14336
  v_mul_f32 v186, -v20, v78
  v_mul_f32 v187, -v20, v79
  s_waitcnt lgkmcnt(4)
  v_mfma_f32_32x32x16_bf16 v[120:135], a[184:187], v[160:163], v[120:135]
  v_mul_f32 v188, -v14, v80
  v_mul_f32 v189, -v14, v81
  v_mfma_f32_32x32x16_bf16 v[104:119], a[40:43], v[160:163], v[104:119]
  ds_read_b128 v[156:159], v1 offset:15360
  v_mul_f32 v190, -v14, v82
  v_mul_f32 v191, -v14, v83
  s_waitcnt lgkmcnt(4)
  v_mfma_f32_32x32x16_bf16 v[120:135], a[188:191], v[164:167], v[120:135]
  v_mul_f32 v192, -v14, v84
  v_mul_f32 v193, -v14, v85
  v_mfma_f32_32x32x16_bf16 v[104:119], a[44:47], v[164:167], v[104:119]
  ds_read_b128 v[160:163], v1 offset:16384
  v_mul_f32 v194, -v14, v86
  v_mul_f32 v195, -v14, v87
  s_waitcnt lgkmcnt(4)
  v_mfma_f32_32x32x16_bf16 v[120:135], a[192:195], v[144:147], v[120:135]
  v_mfma_f32_32x32x16_bf16 v[104:119], a[48:51], v[144:147], v[104:119]
  ds_read_b128 v[164:167], v1 offset:17408
  s_waitcnt lgkmcnt(4)
  v_mfma_f32_32x32x16_bf16 v[120:135], a[196:199], v[148:151], v[120:135]
  v_mfma_f32_32x32x16_bf16 v[104:119], a[52:55], v[148:151], v[104:119]
  ds_read_b128 v[144:147], v2 offset:0
  s_waitcnt lgkmcnt(4)
  v_mfma_f32_32x32x16_bf16 v[120:135], a[200:203], v[152:155], v[120:135]
  v_mfma_f32_32x32x16_bf16 v[104:119], a[56:59], v[152:155], v[104:119]
  ds_read_b128 v[148:151], v2 offset:1024
  s_waitcnt lgkmcnt(4)
  v_mfma_f32_32x32x16_bf16 v[120:135], a[204:207], v[156:159], v[120:135]
  v_add_u32 v1, s71, v1
  v_mfma_f32_32x32x16_bf16 v[104:119], a[60:63], v[156:159], v[104:119]
  ds_read_b128 v[152:155], v2 offset:2048
  s_waitcnt lgkmcnt(4)
  v_mfma_f32_32x32x16_bf16 v[120:135], a[208:211], v[160:163], v[120:135]
  v_mfma_f32_32x32x16_bf16 v[104:119], a[64:67], v[160:163], v[104:119]
  ds_read_b128 v[156:159], v2 offset:3072
  s_waitcnt lgkmcnt(4)
  v_mfma_f32_32x32x16_bf16 v[120:135], a[212:215], v[164:167], v[120:135]
  v_mfma_f32_32x32x16_bf16 v[104:119], a[68:71], v[164:167], v[104:119]
  ds_read_b128 v[160:163], v2 offset:4096
  s_waitcnt lgkmcnt(4)
  v_mfma_f32_32x32x16_bf16 v[104:119], a[72:75], v[144:147], v[104:119]
  ds_read_b128 v[164:167], v2 offset:5120
  ds_write_b128 v11, v[124:127] offset:0
  ds_write_b128 v11, v[132:135] offset:1024
  s_waitcnt lgkmcnt(6)
  v_mfma_f32_32x32x16_bf16 v[104:119], a[76:79], v[148:151], v[104:119]
  ds_read_b128 v[144:147], v2 offset:6144
  s_waitcnt lgkmcnt(1)
  s_barrier
  v_mfma_f32_32x32x16_bf16 v[104:119], a[80:83], v[152:155], v[104:119]
  ds_read_b128 v[148:151], v2 offset:7168
  ds_read_b128 v[136:139], v12 offset:0
  ds_read_b128 v[140:143], v12 offset:1024
  s_add_u32 s69, s57, 4096
  s_add_u32 s70, s57, 8192
  v_mfma_f32_32x32x16_bf16 v[104:119], a[84:87], v[156:159], v[104:119]
  ds_read_b128 v[152:155], v2 offset:8192
  buffer_load_dwordx4 v[32:35], v0, s[52:55], s57 offen offset:0 sc1
  v_mfma_f32_32x32x16_bf16 v[104:119], a[88:91], v[160:163], v[104:119]
  ds_read_b128 v[156:159], v2 offset:9216
  buffer_load_dwordx4 v[36:39], v0, s[52:55], s57 offen offset:1024 sc1
  s_waitcnt lgkmcnt(3)
  v_add_f32 v120, v120, v136
  v_add_f32 v121, v121, v137
  v_mfma_f32_32x32x16_bf16 v[104:119], a[92:95], v[164:167], v[104:119]
  ds_read_b128 v[160:163], v2 offset:10240
  buffer_load_dwordx4 v[40:43], v0, s[52:55], s57 offen offset:2048 sc1
  v_add_f32 v122, v122, v138
  v_add_f32 v123, v123, v139
  v_mfma_f32_32x32x16_bf16 v[104:119], a[96:99], v[144:147], v[104:119]
  ds_read_b128 v[164:167], v2 offset:11264
  buffer_load_dwordx4 v[44:47], v0, s[52:55], s57 offen offset:3072 sc1
  s_waitcnt lgkmcnt(4)
  v_add_f32 v128, v128, v140
  v_add_f32 v129, v129, v141
  v_mfma_f32_32x32x16_bf16 v[104:119], a[100:103], v[148:151], v[104:119]
  ds_read_b128 v[144:147], v2 offset:12288
  buffer_load_dwordx4 v[48:51], v0, s[52:55], s69 offen offset:0 sc1
  v_add_f32 v130, v130, v142
  v_add_f32 v131, v131, v143
  s_waitcnt lgkmcnt(4)
  v_mfma_f32_32x32x16_bf16 v[104:119], a[104:107], v[152:155], v[104:119]
  ds_read_b128 v[148:151], v2 offset:13312
  buffer_load_dwordx4 v[52:55], v0, s[52:55], s69 offen offset:1024 sc1
  v_fma_f32 v120, -v14, v88, v120
  v_fma_f32 v128, -v14, v96, v128
  s_waitcnt lgkmcnt(4)
  v_mfma_f32_32x32x16_bf16 v[104:119], a[108:111], v[156:159], v[104:119]
  ds_read_b128 v[152:155], v2 offset:14336
  buffer_load_dwordx4 v[56:59], v0, s[52:55], s69 offen offset:2048 sc1
  v_fma_f32 v121, -v14, v89, v121
  v_fma_f32 v129, -v14, v97, v129
  s_waitcnt lgkmcnt(4)
  v_mfma_f32_32x32x16_bf16 v[104:119], a[112:115], v[160:163], v[104:119]
  ds_read_b128 v[156:159], v2 offset:15360
  buffer_load_dwordx4 v[60:63], v0, s[52:55], s69 offen offset:3072 sc1
  v_mul_f32 v120, v15, v120
  v_mul_f32 v121, v15, v121
  s_waitcnt lgkmcnt(4)
  v_mfma_f32_32x32x16_bf16 v[104:119], a[116:119], v[164:167], v[104:119]
  ds_read_b128 v[160:163], v2 offset:16384
  buffer_load_dwordx4 v[64:67], v0, s[52:55], s70 offen offset:0 sc1
  v_mul_f32 v120, v120, v128
  v_mul_f32 v121, v121, v129
  s_waitcnt lgkmcnt(4)
  v_mfma_f32_32x32x16_bf16 v[104:119], a[120:123], v[144:147], v[104:119]
  ds_read_b128 v[164:167], v2 offset:17408
  buffer_load_dwordx4 v[68:71], v0, s[52:55], s68 offen sc1
  v_cvt_pk_bf16_f32 v172, v120, v121
  v_fma_f32 v122, -v14, v90, v122
  s_waitcnt lgkmcnt(4)
  v_mfma_f32_32x32x16_bf16 v[104:119], a[124:127], v[148:151], v[104:119]
  v_fma_f32 v130, -v14, v98, v130
  v_fma_f32 v123, -v14, v91, v123
  s_waitcnt lgkmcnt(3)
  v_mfma_f32_32x32x16_bf16 v[104:119], a[128:131], v[152:155], v[104:119]
  v_fma_f32 v131, -v14, v99, v131
  v_mul_f32 v122, v15, v122
  v_add_u32 v2, s71, v2
  s_sub_u32 s71, 0, s71
  s_waitcnt lgkmcnt(2)
  v_mfma_f32_32x32x16_bf16 v[104:119], a[132:135], v[156:159], v[104:119]
  v_mul_f32 v123, v15, v123
  v_mul_f32 v122, v122, v130
  s_waitcnt lgkmcnt(1)
  v_mfma_f32_32x32x16_bf16 v[104:119], a[136:139], v[160:163], v[104:119]
  v_mul_f32 v123, v123, v131
  v_cvt_pk_bf16_f32 v173, v122, v123
  s_waitcnt lgkmcnt(0)
  v_mfma_f32_32x32x16_bf16 v[104:119], a[140:143], v[164:167], v[104:119]
  buffer_store_dwordx2 v[172:173], v4, s[52:55], s59 offen sc1
  s_add_u32 s59, s59, 294912
  s_nop 9
  v_pk_fma_f32 v[104:105], v[104:105], v[14:15], v[180:181] op_sel:[0,1,0] op_sel_hi:[1,1,1]
  v_pk_add_f32 v[112:113], v[112:113], v[188:189]
  v_pk_fma_f32 v[106:107], v[106:107], v[14:15], v[182:183] op_sel:[0,1,0] op_sel_hi:[1,1,1]
  v_pk_add_f32 v[114:115], v[114:115], v[190:191]
  v_pk_fma_f32 v[108:109], v[108:109], v[14:15], v[184:185] op_sel:[0,1,0] op_sel_hi:[1,1,1]
  v_pk_add_f32 v[116:117], v[116:117], v[192:193]
  v_pk_fma_f32 v[110:111], v[110:111], v[14:15], v[186:187] op_sel:[0,1,0] op_sel_hi:[1,1,1]
  v_pk_add_f32 v[118:119], v[118:119], v[194:195]
  v_pk_mul_f32 v[104:105], v[104:105], v[112:113]
  v_pk_mul_f32 v[106:107], v[106:107], v[114:115]
  v_pk_mul_f32 v[108:109], v[108:109], v[116:117]
  v_pk_mul_f32 v[110:111], v[110:111], v[118:119]
  v_cvt_pk_bf16_f32 v168, v104, v105
  v_cvt_pk_bf16_f32 v169, v106, v107
  v_cvt_pk_bf16_f32 v170, v108, v109
  v_cvt_pk_bf16_f32 v171, v110, v111
  buffer_store_dwordx4 v[168:171], v4, s[52:55], s58 offen sc1
  s_add_u32 s58, s58, 294912
  s_add_u32 s56, s56, 1
  s_cmp_lt_u32 s56, 64
  s_cbranch_scc1 GT_8
  s_waitcnt vmcnt(0)
  s_endpgm
R_D:
  s_mul_i32 s56, s7, 43
  s_lshr_b32 s56, s56, 9
  s_mul_i32 s62, s56, 12
  s_sub_u32 s57, s7, s62
  s_mul_i32 s65, s5, 40960
  s_mov_b32 s64, 131072
  s_mov_b32 s58, 0
  s_mul_i32 s62, s57, 3072
  s_lshl_b32 s63, s56, 7
  s_add_u32 s62, s62, s63
  s_add_u32 s62, s62, 88080384
  s_mul_i32 s63, s56, 9216
  s_mul_i32 s59, s57, 96
  s_add_u32 s63, s63, s59
  s_mov_b32 s60, s62
  s_mov_b32 s61, s63
  s_mul_i32 s59, s56, 73728
  s_mul_i32 s62, s5, 18432
  s_add_u32 s59, s59, s62
  s_add_u32 s59, s59, 68157440
  v_mov_b32 v16, v0
  v_lshrrev_b32 v17, 3, v16
  v_min_u32 v17, 5, v17
  v_and_b32 v18, 7, v16
  v_lshlrev_b32 v5, 9, v17
  v_lshl_add_u32 v5, v18, 4, v5
  v_mul_u32_u24 v6, 1152, v18
  v_lshl_add_u32 v6, v17, 4, v6
  v_mul_u32_u24 v4, 208, v18
  v_lshl_add_u32 v4, v17, 5, v4
  v_add_u32 v4, 36864, v4
  v_add_u32 v17, 0, v16
  v_mul_u32_u24 v18, 43691, v17
  v_lshrrev_b32 v18, 18, v18
  v_mul_u32_u24 v19, 6, v18
  v_sub_u32 v19, v17, v19
  v_mul_u32_u24 v20, 1152, v18
  v_lshl_add_u32 v20, v19, 4, v20
  v_add_u32 v17, 64, v16
  v_mul_u32_u24 v18, 43691, v17
  v_lshrrev_b32 v18, 18, v18
  v_mul_u32_u24 v19, 6, v18
  v_sub_u32 v19, v17, v19
  v_mul_u32_u24 v21, 1152, v18
  v_lshl_add_u32 v21, v19, 4, v21
  v_add_u32 v17, 128, v16
  v_mul_u32_u24 v18, 43691, v17
  v_lshrrev_b32 v18, 18, v18
  v_mul_u32_u24 v19, 6, v18
  v_sub_u32 v19, v17, v19
  v_mul_u32_u24 v22, 1152, v18
  v_lshl_add_u32 v22, v19, 4, v22
  s_mov_b32 s62, 1048576
POLLD_11:
  buffer_load_dword v17, off, s[48:51], 0 offset:64 sc1
  s_waitcnt vmcnt(0)
  v_readfirstlane_b32 s63, v17
  s_sub_u32 s62, s62, 1
  s_cbranch_scc1 POLLE_12
  s_cmp_lt_u32 s63, 32
  s_cbranch_scc1 POLLD_11
POLLE_12:
  s_mul_i32 s62, s5, 1327104
  s_mul_i32 s63, s57, 96
  s_add_u32 s62, s62, s63
  s_add_u32 m0, s65, 0
  s_add_u32 s63, s62, 0
  buffer_load_dwordx4 v20, s[40:43], s63 offen lds
  s_add_u32 m0, s65, 1024
  s_add_u32 s63, s62, 0
  buffer_load_dwordx4 v21, s[40:43], s63 offen lds
  s_add_u32 m0, s65, 2048
  s_add_u32 s63, s62, 0
  buffer_load_dwordx4 v22, s[40:43], s63 offen lds
  s_add_u32 m0, s65, 3072
  s_add_u32 s63, s62, 36864
  buffer_load_dwordx4 v20, s[40:43], s63 offen lds
  s_add_u32 m0, s65, 4096
  s_add_u32 s63, s62, 36864
  buffer_load_dwordx4 v21, s[40:43], s63 offen lds
  s_add_u32 m0, s65, 5120
  s_add_u32 s63, s62, 36864
  buffer_load_dwordx4 v22, s[40:43], s63 offen lds
  s_mul_i32 s62, s5, 1327104
  s_mul_i32 s63, s57, 96
  s_add_u32 s62, s62, s63
  s_add_u32 m0, s65, 6144
  s_add_u32 s63, s62, 73728
  buffer_load_dwordx4 v20, s[40:43], s63 offen lds
  s_add_u32 m0, s65, 7168
  s_add_u32 s63, s62, 73728
  buffer_load_dwordx4 v21, s[40:43], s63 offen lds
  s_add_u32 m0, s65, 8192
  s_add_u32 s63, s62, 73728
  buffer_load_dwordx4 v22, s[40:43], s63 offen lds
  s_add_u32 m0, s65, 9216
  s_add_u32 s63, s62, 110592
  buffer_load_dwordx4 v20, s[40:43], s63 offen lds
  s_add_u32 m0, s65, 10240
  s_add_u32 s63, s62, 110592
  buffer_load_dwordx4 v21, s[40:43], s63 offen lds
  s_add_u32 m0, s65, 11264
  s_add_u32 s63, s62, 110592
  buffer_load_dwordx4 v22, s[40:43], s63 offen lds
  s_mul_i32 s62, s5, 1327104
  s_mul_i32 s63, s57, 96
  s_add_u32 s62, s62, s63
  s_add_u32 m0, s65, 12288
  s_add_u32 s63, s62, 147456
  buffer_load_dwordx4 v20, s[40:43], s63 offen lds
  s_add_u32 m0, s65, 13312
  s_add_u32 s63, s62, 147456
  buffer_load_dwordx4 v21, s[40:43], s63 offen lds
  s_add_u32 m0, s65, 14336
  s_add_u32 s63, s62, 147456
  buffer_load_dwordx4 v22, s[40:43], s63 offen lds
  s_add_u32 m0, s65, 15360
  s_add_u32 s63, s62, 184320
  buffer_load_dwordx4 v20, s[40:43], s63 offen lds
  s_add_u32 m0, s65, 16384
  s_add_u32 s63, s62, 184320
  buffer_load_dwordx4 v21, s[40:43], s63 offen lds
  s_add_u32 m0, s65, 17408
  s_add_u32 s63, s62, 184320
  buffer_load_dwordx4 v22, s[40:43], s63 offen lds
  s_mul_i32 s62, s5, 1327104
  s_mul_i32 s63, s57, 96
  s_add_u32 s62, s62, s63
  s_add_u32 m0, s65, 18432
  s_add_u32 s63, s62, 221184
  buffer_load_dwordx4 v20, s[40:43], s63 offen lds
  s_add_u32 m0, s65, 19456
  s_add_u32 s63, s62, 221184
  buffer_load_dwordx4 v21, s[40:43], s63 offen lds
  s_add_u32 m0, s65, 20480
  s_add_u32 s63, s62, 221184
  buffer_load_dwordx4 v22, s[40:43], s63 offen lds
  s_add_u32 m0, s65, 21504
  s_add_u32 s63, s62, 258048
  buffer_load_dwordx4 v20, s[40:43], s63 offen lds
  s_add_u32 m0, s65, 22528
  s_add_u32 s63, s62, 258048
  buffer_load_dwordx4 v21, s[40:43], s63 offen lds
  s_add_u32 m0, s65, 23552
  s_add_u32 s63, s62, 258048
  buffer_load_dwordx4 v22, s[40:43], s63 offen lds
  s_mul_i32 s62, s5, 1327104
  s_mul_i32 s63, s57, 96
  s_add_u32 s62, s62, s63
  s_add_u32 m0, s65, 24576
  s_add_u32 s63, s62, 294912
  buffer_load_dwordx4 v20, s[40:43], s63 offen lds
  s_add_u32 m0, s65, 25600
  s_add_u32 s63, s62, 294912
  buffer_load_dwordx4 v21, s[40:43], s63 offen lds
  s_add_u32 m0, s65, 26624
  s_add_u32 s63, s62, 294912
  buffer_load_dwordx4 v22, s[40:43], s63 offen lds
  s_add_u32 m0, s65, 27648
  s_add_u32 s63, s62, 331776
  buffer_load_dwordx4 v20, s[40:43], s63 offen lds
  s_add_u32 m0, s65, 28672
  s_add_u32 s63, s62, 331776
  buffer_load_dwordx4 v21, s[40:43], s63 offen lds
  s_add_u32 m0, s65, 29696
  s_add_u32 s63, s62, 331776
  buffer_load_dwordx4 v22, s[40:43], s63 offen lds
  s_mul_i32 s62, s5, 1327104
  s_mul_i32 s63, s57, 96
  s_add_u32 s62, s62, s63
  s_add_u32 m0, s65, 30720
  s_add_u32 s63, s62, 368640
  buffer_load_dwordx4 v20, s[40:43], s63 offen lds
  s_add_u32 m0, s65, 31744
  s_add_u32 s63, s62, 368640
  buffer_load_dwordx4 v21, s[40:43], s63 offen lds
  s_add_u32 m0, s65, 32768
  s_add_u32 s63, s62, 368640
  buffer_load_dwordx4 v22, s[40:43], s63 offen lds
  s_add_u32 m0, s65, 33792
  s_add_u32 s63, s62, 405504
  buffer_load_dwordx4 v20, s[40:43], s63 offen lds
  s_add_u32 m0, s65, 34816
  s_add_u32 s63, s62, 405504
  buffer_load_dwordx4 v21, s[40:43], s63 offen lds
  s_add_u32 m0, s65, 35840
  s_add_u32 s63, s62, 405504
  buffer_load_dwordx4 v22, s[40:43], s63 offen lds
  v_lshrrev_b32 v17, 4, v16
  v_lshlrev_b32 v17, 3, v17
  v_bfe_u32 v18, v16, 3, 1
  v_lshl_add_u32 v17, v18, 2, v17
  v_bfe_u32 v18, v16, 2, 1
  v_add_u32 v17, v17, v18
  v_mul_u32_u24 v23, 96, v17
  v_and_b32 v18, 3, v16
  v_lshl_add_u32 v23, v18, 3, v23
  v_add_u32 v23, s65, v23
  v_bfe_u32 v17, v16, 4, 1
  v_mul_u32_u24 v17, 832, v17
  v_and_b32 v18, 15, v16
  v_lshl_add_u32 v17, v18, 2, v17
  v_add_u32 v17, s65, v17
  v_lshrrev_b32 v18, 5, v16
  v_lshl_add_u32 v2, v18, 6, v17
  v_add_u32 v2, 36864, v2
  v_mul_u32_u24 v18, 208, v18
  v_add_u32 v3, v17, v18
  v_add_u32 v3, 36992, v3
  s_mov_b32 s62, 0xff00ff00
  s_mov_b32 s63, 0xff00ff00
  v_mov_b32 v1, 0x4444
  v_mov_b32 v17, 0xeeee
  v_cndmask_b32 v1, v1, v17, s[62:63]
  v_lshlrev_b32 v0, 4, v16
  s_waitcnt vmcnt(30)
  ds_read_b64_tr_b16 v[152:153], v23 offset:0
  ds_read_b64_tr_b16 v[154:155], v23 offset:192
  ds_read_b64_tr_b16 v[156:157], v23 offset:3072
  ds_read_b64_tr_b16 v[158:159], v23 offset:3264
  ds_read_b64_tr_b16 v[160:161], v23 offset:32
  ds_read_b64_tr_b16 v[162:163], v23 offset:224
  ds_read_b64_tr_b16 v[164:165], v23 offset:3104
  ds_read_b64_tr_b16 v[166:167], v23 offset:3296
  ds_read_b64_tr_b16 v[168:169], v23 offset:64
  ds_read_b64_tr_b16 v[170:171], v23 offset:256
  ds_read_b64_tr_b16 v[172:173], v23 offset:3136
  ds_read_b64_tr_b16 v[174:175], v23 offset:3328
  s_waitcnt lgkmcnt(0)
  s_mul_i32 s62, s5, 1327104
  s_mul_i32 s63, s57, 96
  s_add_u32 s62, s62, s63
  s_add_u32 m0, s65, 0
  s_add_u32 s63, s62, 442368
  buffer_load_dwordx4 v20, s[40:43], s63 offen lds
  s_add_u32 m0, s65, 1024
  s_add_u32 s63, s62, 442368
  buffer_load_dwordx4 v21, s[40:43], s63 offen lds
  s_add_u32 m0, s65, 2048
  s_add_u32 s63, s62, 442368
  buffer_load_dwordx4 v22, s[40:43], s63 offen lds
  s_add_u32 m0, s65, 3072
  s_add_u32 s63, s62, 479232
  buffer_load_dwordx4 v20, s[40:43], s63 offen lds
  s_add_u32 m0, s65, 4096
  s_add_u32 s63, s62, 479232
  buffer_load_dwordx4 v21, s[40:43], s63 offen lds
  s_add_u32 m0, s65, 5120
  s_add_u32 s63, s62, 479232
  buffer_load_dwordx4 v22, s[40:43], s63 offen lds
  s_waitcnt vmcnt(30)
  ds_read_b64_tr_b16 v[176:177], v23 offset:6144
  ds_read_b64_tr_b16 v[178:179], v23 offset:6336
  ds_read_b64_tr_b16 v[180:181], v23 offset:9216
  ds_read_b64_tr_b16 v[182:183], v23 offset:9408
  ds_read_b64_tr_b16 v[184:185], v23 offset:6176
  ds_read_b64_tr_b16 v[186:187], v23 offset:6368
  ds_read_b64_tr_b16 v[188:189], v23 offset:9248
  ds_read_b64_tr_b16 v[190:191], v23 offset:9440
  ds_read_b64_tr_b16 v[192:193], v23 offset:6208
  ds_read_b64_tr_b16 v[194:195], v23 offset:6400
  ds_read_b64_tr_b16 v[196:197], v23 offset:9280
  ds_read_b64_tr_b16 v[198:199], v23 offset:9472
  s_waitcnt lgkmcnt(0)
  s_mul_i32 s62, s5, 1327104
  s_mul_i32 s63, s57, 96
  s_add_u32 s62, s62, s63
  s_add_u32 m0, s65, 6144
  s_add_u32 s63, s62, 516096
  buffer_load_dwordx4 v20, s[40:43], s63 offen lds
  s_add_u32 m0, s65, 7168
  s_add_u32 s63, s62, 516096
  buffer_load_dwordx4 v21, s[40:43], s63 offen lds
  s_add_u32 m0, s65, 8192
  s_add_u32 s63, s62, 516096
  buffer_load_dwordx4 v22, s[40:43], s63 offen lds
  s_add_u32 m0, s65, 9216
  s_add_u32 s63, s62, 552960
  buffer_load_dwordx4 v20, s[40:43], s63 offen lds
  s_add_u32 m0, s65, 10240
  s_add_u32 s63, s62, 552960
  buffer_load_dwordx4 v21, s[40:43], s63 offen lds
  s_add_u32 m0, s65, 11264
  s_add_u32 s63, s62, 552960
  buffer_load_dwordx4 v22, s[40:43], s63 offen lds
  s_waitcnt vmcnt(30)
  ds_read_b64_tr_b16 v[200:201], v23 offset:12288
  ds_read_b64_tr_b16 v[202:203], v23 offset:12480
  ds_read_b64_tr_b16 v[204:205], v23 offset:15360
  ds_read_b64_tr_b16 v[206:207], v23 offset:15552
  ds_read_b64_tr_b16 v[208:209], v23 offset:12320
  ds_read_b64_tr_b16 v[210:211], v23 offset:12512
  ds_read_b64_tr_b16 v[212:213], v23 offset:15392
  ds_read_b64_tr_b16 v[214:215], v23 offset:15584
  ds_read_b64_tr_b16 v[216:217], v23 offset:12352
  ds_read_b64_tr_b16 v[218:219], v23 offset:12544
  ds_read_b64_tr_b16 v[220:221], v23 offset:15424
  ds_read_b64_tr_b16 v[222:223], v23 offset:15616
  s_waitcnt lgkmcnt(0)
  s_mul_i32 s62, s5, 1327104
  s_mul_i32 s63, s57, 96
  s_add_u32 s62, s62, s63
  s_add_u32 m0, s65, 12288
  s_add_u32 s63, s62, 589824
  buffer_load_dwordx4 v20, s[40:43], s63 offen lds
  s_add_u32 m0, s65, 13312
  s_add_u32 s63, s62, 589824
  buffer_load_dwordx4 v21, s[40:43], s63 offen lds
  s_add_u32 m0, s65, 14336
  s_add_u32 s63, s62, 589824
  buffer_load_dwordx4 v22, s[40:43], s63 offen lds
  s_add_u32 m0, s65, 15360
  s_add_u32 s63, s62, 626688
  buffer_load_dwordx4 v20, s[40:43], s63 offen lds
  s_add_u32 m0, s65, 16384
  s_add_u32 s63, s62, 626688
  buffer_load_dwordx4 v21, s[40:43], s63 offen lds
  s_add_u32 m0, s65, 17408
  s_add_u32 s63, s62, 626688
  buffer_load_dwordx4 v22, s[40:43], s63 offen lds
  s_waitcnt vmcnt(30)
  ds_read_b64_tr_b16 v[224:225], v23 offset:18432
  ds_read_b64_tr_b16 v[226:227], v23 offset:18624
  ds_read_b64_tr_b16 v[228:229], v23 offset:21504
  ds_read_b64_tr_b16 v[230:231], v23 offset:21696
  ds_read_b64_tr_b16 v[232:233], v23 offset:18464
  ds_read_b64_tr_b16 v[234:235], v23 offset:18656
  ds_read_b64_tr_b16 v[236:237], v23 offset:21536
  ds_read_b64_tr_b16 v[238:239], v23 offset:21728
  ds_read_b64_tr_b16 v[240:241], v23 offset:18496
  ds_read_b64_tr_b16 v[242:243], v23 offset:18688
  ds_read_b64_tr_b16 v[244:245], v23 offset:21568
  ds_read_b64_tr_b16 v[246:247], v23 offset:21760
  s_waitcnt lgkmcnt(0)
  s_mul_i32 s62, s5, 1327104
  s_mul_i32 s63, s57, 96
  s_add_u32 s62, s62, s63
  s_add_u32 m0, s65, 18432
  s_add_u32 s63, s62, 663552
  buffer_load_dwordx4 v20, s[40:43], s63 offen lds
  s_add_u32 m0, s65, 19456
  s_add_u32 s63, s62, 663552
  buffer_load_dwordx4 v21, s[40:43], s63 offen lds
  s_add_u32 m0, s65, 20480
  s_add_u32 s63, s62, 663552
  buffer_load_dwordx4 v22, s[40:43], s63 offen lds
  s_add_u32 m0, s65, 21504
  s_add_u32 s63, s62, 700416
  buffer_load_dwordx4 v20, s[40:43], s63 offen lds
  s_add_u32 m0, s65, 22528
  s_add_u32 s63, s62, 700416
  buffer_load_dwordx4 v21, s[40:43], s63 offen lds
  s_add_u32 m0, s65, 23552
  s_add_u32 s63, s62, 700416
  buffer_load_dwordx4 v22, s[40:43], s63 offen lds
  s_waitcnt vmcnt(30)
  ds_read_b64_tr_b16 v[248:249], v23 offset:24576
  ds_read_b64_tr_b16 v[250:251], v23 offset:24768
  ds_read_b64_tr_b16 v[252:253], v23 offset:27648
  ds_read_b64_tr_b16 v[254:255], v23 offset:27840
  ds_read_b64_tr_b16 a[0:1], v23 offset:24608
  ds_read_b64_tr_b16 a[2:3], v23 offset:24800
  ds_read_b64_tr_b16 a[4:5], v23 offset:27680
  ds_read_b64_tr_b16 a[6:7], v23 offset:27872
  ds_read_b64_tr_b16 a[8:9], v23 offset:24640
  ds_read_b64_tr_b16 a[10:11], v23 offset:24832
  ds_read_b64_tr_b16 a[12:13], v23 offset:27712
  ds_read_b64_tr_b16 a[14:15], v23 offset:27904
  s_waitcnt lgkmcnt(0)
  s_mul_i32 s62, s5, 1327104
  s_mul_i32 s63, s57, 96
  s_add_u32 s62, s62, s63
  s_add_u32 m0, s65, 24576
  s_add_u32 s63, s62, 737280
  buffer_load_dwordx4 v20, s[40:43], s63 offen lds
  s_add_u32 m0, s65, 25600
  s_add_u32 s63, s62, 737280
  buffer_load_dwordx4 v21, s[40:43], s63 offen lds
  s_add_u32 m0, s65, 26624
  s_add_u32 s63, s62, 737280
  buffer_load_dwordx4 v22, s[40:43], s63 offen lds
  s_add_u32 m0, s65, 27648
  s_add_u32 s63, s62, 774144
  buffer_load_dwordx4 v20, s[40:43], s63 offen lds
  s_add_u32 m0, s65, 28672
  s_add_u32 s63, s62, 774144
  buffer_load_dwordx4 v21, s[40:43], s63 offen lds
  s_add_u32 m0, s65, 29696
  s_add_u32 s63, s62, 774144
  buffer_load_dwordx4 v22, s[40:43], s63 offen lds
  s_waitcnt vmcnt(30)
  ds_read_b64_tr_b16 a[16:17], v23 offset:30720
  ds_read_b64_tr_b16 a[18:19], v23 offset:30912
  ds_read_b64_tr_b16 a[20:21], v23 offset:33792
  ds_read_b64_tr_b16 a[22:23], v23 offset:33984
  ds_read_b64_tr_b16 a[24:25], v23 offset:30752
  ds_read_b64_tr_b16 a[26:27], v23 offset:30944
  ds_read_b64_tr_b16 a[28:29], v23 offset:33824
  ds_read_b64_tr_b16 a[30:31], v23 offset:34016
  ds_read_b64_tr_b16 a[32:33], v23 offset:30784
  ds_read_b64_tr_b16 a[34:35], v23 offset:30976
  ds_read_b64_tr_b16 a[36:37], v23 offset:33856
  ds_read_b64_tr_b16 a[38:39], v23 offset:34048
  s_waitcnt lgkmcnt(0)
  s_mul_i32 s62, s5, 1327104
  s_mul_i32 s63, s57, 96
  s_add_u32 s62, s62, s63
  s_add_u32 m0, s65, 30720
  s_add_u32 s63, s62, 811008
  buffer_load_dwordx4 v20, s[40:43], s63 offen lds
  s_add_u32 m0, s65, 31744
  s_add_u32 s63, s62, 811008
  buffer_load_dwordx4 v21, s[40:43], s63 offen lds
  s_add_u32 m0, s65, 32768
  s_add_u32 s63, s62, 811008
  buffer_load_dwordx4 v22, s[40:43], s63 offen lds
  s_add_u32 m0, s65, 33792
  s_add_u32 s63, s62, 847872
  buffer_load_dwordx4 v20, s[40:43], s63 offen lds
  s_add_u32 m0, s65, 34816
  s_add_u32 s63, s62, 847872
  buffer_load_dwordx4 v21, s[40:43], s63 offen lds
  s_add_u32 m0, s65, 35840
  s_add_u32 s63, s62, 847872
  buffer_load_dwordx4 v22, s[40:43], s63 offen lds
  s_waitcnt vmcnt(30)
  ds_read_b64_tr_b16 a[40:41], v23 offset:0
  ds_read_b64_tr_b16 a[42:43], v23 offset:192
  ds_read_b64_tr_b16 a[44:45], v23 offset:3072
  ds_read_b64_tr_b16 a[46:47], v23 offset:3264
  ds_read_b64_tr_b16 a[48:49], v23 offset:32
  ds_read_b64_tr_b16 a[50:51], v23 offset:224
  ds_read_b64_tr_b16 a[52:53], v23 offset:3104
  ds_read_b64_tr_b16 a[54:55], v23 offset:3296
  ds_read_b64_tr_b16 a[56:57], v23 offset:64
  ds_read_b64_tr_b16 a[58:59], v23 offset:256
  ds_read_b64_tr_b16 a[60:61], v23 offset:3136
  ds_read_b64_tr_b16 a[62:63], v23 offset:3328
  s_waitcnt lgkmcnt(0)
  s_mul_i32 s62, s5, 1327104
  s_mul_i32 s63, s57, 96
  s_add_u32 s62, s62, s63
  s_add_u32 m0, s65, 0
  s_add_u32 s63, s62, 884736
  buffer_load_dwordx4 v20, s[40:43], s63 offen lds
  s_add_u32 m0, s65, 1024
  s_add_u32 s63, s62, 884736
  buffer_load_dwordx4 v21, s[40:43], s63 offen lds
  s_add_u32 m0, s65, 2048
  s_add_u32 s63, s62, 884736
  buffer_load_dwordx4 v22, s[40:43], s63 offen lds
  s_add_u32 m0, s65, 3072
  s_add_u32 s63, s62, 921600
  buffer_load_dwordx4 v20, s[40:43], s63 offen lds
  s_add_u32 m0, s65, 4096
  s_add_u32 s63, s62, 921600
  buffer_load_dwordx4 v21, s[40:43], s63 offen lds
  s_add_u32 m0, s65, 5120
  s_add_u32 s63, s62, 921600
  buffer_load_dwordx4 v22, s[40:43], s63 offen lds
  s_waitcnt vmcnt(30)
  ds_read_b64_tr_b16 a[64:65], v23 offset:6144
  ds_read_b64_tr_b16 a[66:67], v23 offset:6336
  ds_read_b64_tr_b16 a[68:69], v23 offset:9216
  ds_read_b64_tr_b16 a[70:71], v23 offset:9408
  ds_read_b64_tr_b16 a[72:73], v23 offset:6176
  ds_read_b64_tr_b16 a[74:75], v23 offset:6368
  ds_read_b64_tr_b16 a[76:77], v23 offset:9248
  ds_read_b64_tr_b16 a[78:79], v23 offset:9440
  ds_read_b64_tr_b16 a[80:81], v23 offset:6208
  ds_read_b64_tr_b16 a[82:83], v23 offset:6400
  ds_read_b64_tr_b16 a[84:85], v23 offset:9280
  ds_read_b64_tr_b16 a[86:87], v23 offset:9472
  s_waitcnt lgkmcnt(0)
  s_mul_i32 s62, s5, 1327104
  s_mul_i32 s63, s57, 96
  s_add_u32 s62, s62, s63
  s_add_u32 m0, s65, 6144
  s_add_u32 s63, s62, 958464
  buffer_load_dwordx4 v20, s[40:43], s63 offen lds
  s_add_u32 m0, s65, 7168
  s_add_u32 s63, s62, 958464
  buffer_load_dwordx4 v21, s[40:43], s63 offen lds
  s_add_u32 m0, s65, 8192
  s_add_u32 s63, s62, 958464
  buffer_load_dwordx4 v22, s[40:43], s63 offen lds
  s_add_u32 m0, s65, 9216
  s_add_u32 s63, s62, 995328
  buffer_load_dwordx4 v20, s[40:43], s63 offen lds
  s_add_u32 m0, s65, 10240
  s_add_u32 s63, s62, 995328
  buffer_load_dwordx4 v21, s[40:43], s63 offen lds
  s_add_u32 m0, s65, 11264
  s_add_u32 s63, s62, 995328
  buffer_load_dwordx4 v22, s[40:43], s63 offen lds
  s_waitcnt vmcnt(30)
  ds_read_b64_tr_b16 a[88:89], v23 offset:12288
  ds_read_b64_tr_b16 a[90:91], v23 offset:12480
  ds_read_b64_tr_b16 a[92:93], v23 offset:15360
  ds_read_b64_tr_b16 a[94:95], v23 offset:15552
  ds_read_b64_tr_b16 a[96:97], v23 offset:12320
  ds_read_b64_tr_b16 a[98:99], v23 offset:12512
  ds_read_b64_tr_b16 a[100:101], v23 offset:15392
  ds_read_b64_tr_b16 a[102:103], v23 offset:15584
  ds_read_b64_tr_b16 a[104:105], v23 offset:12352
  ds_read_b64_tr_b16 a[106:107], v23 offset:12544
  ds_read_b64_tr_b16 a[108:109], v23 offset:15424
  ds_read_b64_tr_b16 a[110:111], v23 offset:15616
  s_waitcnt lgkmcnt(0)
  s_mul_i32 s62, s5, 1327104
  s_mul_i32 s63, s57, 96
  s_add_u32 s62, s62, s63
  s_add_u32 m0, s65, 12288
  s_add_u32 s63, s62, 1032192
  buffer_load_dwordx4 v20, s[40:43], s63 offen lds
  s_add_u32 m0, s65, 13312
  s_add_u32 s63, s62, 1032192
  buffer_load_dwordx4 v21, s[40:43], s63 offen lds
  s_add_u32 m0, s65, 14336
  s_add_u32 s63, s62, 1032192
  buffer_load_dwordx4 v22, s[40:43], s63 offen lds
  s_add_u32 m0, s65, 15360
  s_add_u32 s63, s62, 1069056
  buffer_load_dwordx4 v20, s[40:43], s63 offen lds
  s_add_u32 m0, s65, 16384
  s_add_u32 s63, s62, 1069056
  buffer_load_dwordx4 v21, s[40:43], s63 offen lds
  s_add_u32 m0, s65, 17408
  s_add_u32 s63, s62, 1069056
  buffer_load_dwordx4 v22, s[40:43], s63 offen lds
  s_waitcnt vmcnt(30)
  ds_read_b64_tr_b16 a[112:113], v23 offset:18432
  ds_read_b64_tr_b16 a[114:115], v23 offset:18624
  ds_read_b64_tr_b16 a[116:117], v23 offset:21504
  ds_read_b64_tr_b16 a[118:119], v23 offset:21696
  ds_read_b64_tr_b16 a[120:121], v23 offset:18464
  ds_read_b64_tr_b16 a[122:123], v23 offset:18656
  ds_read_b64_tr_b16 a[124:125], v23 offset:21536
  ds_read_b64_tr_b16 a[126:127], v23 offset:21728
  ds_read_b64_tr_b16 a[128:129], v23 offset:18496
  ds_read_b64_tr_b16 a[130:131], v23 offset:18688
  ds_read_b64_tr_b16 a[132:133], v23 offset:21568
  ds_read_b64_tr_b16 a[134:135], v23 offset:21760
  s_waitcnt lgkmcnt(0)
  s_mul_i32 s62, s5, 1327104
  s_mul_i32 s63, s57, 96
  s_add_u32 s62, s62, s63
  s_add_u32 m0, s65, 18432
  s_add_u32 s63, s62, 1105920
  buffer_load_dwordx4 v20, s[40:43], s63 offen lds
  s_add_u32 m0, s65, 19456
  s_add_u32 s63, s62, 1105920
  buffer_load_dwordx4 v21, s[40:43], s63 offen lds
  s_add_u32 m0, s65, 20480
  s_add_u32 s63, s62, 1105920
  buffer_load_dwordx4 v22, s[40:43], s63 offen lds
  s_add_u32 m0, s65, 21504
  s_add_u32 s63, s62, 1142784
  buffer_load_dwordx4 v20, s[40:43], s63 offen lds
  s_add_u32 m0, s65, 22528
  s_add_u32 s63, s62, 1142784
  buffer_load_dwordx4 v21, s[40:43], s63 offen lds
  s_add_u32 m0, s65, 23552
  s_add_u32 s63, s62, 1142784
  buffer_load_dwordx4 v22, s[40:43], s63 offen lds
  s_waitcnt vmcnt(30)
  ds_read_b64_tr_b16 a[136:137], v23 offset:24576
  ds_read_b64_tr_b16 a[138:139], v23 offset:24768
  ds_read_b64_tr_b16 a[140:141], v23 offset:27648
  ds_read_b64_tr_b16 a[142:143], v23 offset:27840
  ds_read_b64_tr_b16 a[144:145], v23 offset:24608
  ds_read_b64_tr_b16 a[146:147], v23 offset:24800
  ds_read_b64_tr_b16 a[148:149], v23 offset:27680
  ds_read_b64_tr_b16 a[150:151], v23 offset:27872
  ds_read_b64_tr_b16 a[152:153], v23 offset:24640
  ds_read_b64_tr_b16 a[154:155], v23 offset:24832
  ds_read_b64_tr_b16 a[156:157], v23 offset:27712
  ds_read_b64_tr_b16 a[158:159], v23 offset:27904
  s_waitcnt lgkmcnt(0)
  s_mul_i32 s62, s5, 1327104
  s_mul_i32 s63, s57, 96
  s_add_u32 s62, s62, s63
  s_add_u32 m0, s65, 24576
  s_add_u32 s63, s62, 1179648
  buffer_load_dwordx4 v20, s[40:43], s63 offen lds
  s_add_u32 m0, s65, 25600
  s_add_u32 s63, s62, 1179648
  buffer_load_dwordx4 v21, s[40:43], s63 offen lds
  s_add_u32 m0, s65, 26624
  s_add_u32 s63, s62, 1179648
  buffer_load_dwordx4 v22, s[40:43], s63 offen lds
  s_add_u32 m0, s65, 27648
  s_add_u32 s63, s62, 1216512
  buffer_load_dwordx4 v20, s[40:43], s63 offen lds
  s_add_u32 m0, s65, 28672
  s_add_u32 s63, s62, 1216512
  buffer_load_dwordx4 v21, s[40:43], s63 offen lds
  s_add_u32 m0, s65, 29696
  s_add_u32 s63, s62, 1216512
  buffer_load_dwordx4 v22, s[40:43], s63 offen lds
  s_waitcnt vmcnt(30)
  ds_read_b64_tr_b16 a[160:161], v23 offset:30720
  ds_read_b64_tr_b16 a[162:163], v23 offset:30912
  ds_read_b64_tr_b16 a[164:165], v23 offset:33792
  ds_read_b64_tr_b16 a[166:167], v23 offset:33984
  ds_read_b64_tr_b16 a[168:169], v23 offset:30752
  ds_read_b64_tr_b16 a[170:171], v23 offset:30944
  ds_read_b64_tr_b16 a[172:173], v23 offset:33824
  ds_read_b64_tr_b16 a[174:175], v23 offset:34016
  ds_read_b64_tr_b16 a[176:177], v23 offset:30784
  ds_read_b64_tr_b16 a[178:179], v23 offset:30976
  ds_read_b64_tr_b16 a[180:181], v23 offset:33856
  ds_read_b64_tr_b16 a[182:183], v23 offset:34048
  s_waitcnt lgkmcnt(0)
  s_mul_i32 s62, s5, 1327104
  s_mul_i32 s63, s57, 96
  s_add_u32 s62, s62, s63
  s_add_u32 m0, s65, 30720
  s_add_u32 s63, s62, 1253376
  buffer_load_dwordx4 v20, s[40:43], s63 offen lds
  s_add_u32 m0, s65, 31744
  s_add_u32 s63, s62, 1253376
  buffer_load_dwordx4 v21, s[40:43], s63 offen lds
  s_add_u32 m0, s65, 32768
  s_add_u32 s63, s62, 1253376
  buffer_load_dwordx4 v22, s[40:43], s63 offen lds
  s_add_u32 m0, s65, 33792
  s_add_u32 s63, s62, 1290240
  buffer_load_dwordx4 v20, s[40:43], s63 offen lds
  s_add_u32 m0, s65, 34816
  s_add_u32 s63, s62, 1290240
  buffer_load_dwordx4 v21, s[40:43], s63 offen lds
  s_add_u32 m0, s65, 35840
  s_add_u32 s63, s62, 1290240
  buffer_load_dwordx4 v22, s[40:43], s63 offen lds
  s_waitcnt vmcnt(30)
  ds_read_b64_tr_b16 a[184:185], v23 offset:0
  ds_read_b64_tr_b16 a[186:187], v23 offset:192
  ds_read_b64_tr_b16 a[188:189], v23 offset:3072
  ds_read_b64_tr_b16 a[190:191], v23 offset:3264
  ds_read_b64_tr_b16 a[192:193], v23 offset:32
  ds_read_b64_tr_b16 a[194:195], v23 offset:224
  ds_read_b64_tr_b16 a[196:197], v23 offset:3104
  ds_read_b64_tr_b16 a[198:199], v23 offset:3296
  ds_read_b64_tr_b16 a[200:201], v23 offset:64
  ds_read_b64_tr_b16 a[202:203], v23 offset:256
  ds_read_b64_tr_b16 a[204:205], v23 offset:3136
  ds_read_b64_tr_b16 a[206:207], v23 offset:3328
  s_waitcnt vmcnt(24)
  ds_read_b64_tr_b16 a[208:209], v23 offset:6144
  ds_read_b64_tr_b16 a[210:211], v23 offset:6336
  ds_read_b64_tr_b16 a[212:213], v23 offset:9216
  ds_read_b64_tr_b16 a[214:215], v23 offset:9408
  ds_read_b64_tr_b16 a[216:217], v23 offset:6176
  ds_read_b64_tr_b16 a[218:219], v23 offset:6368
  ds_read_b64_tr_b16 a[220:221], v23 offset:9248
  ds_read_b64_tr_b16 a[222:223], v23 offset:9440
  ds_read_b64_tr_b16 a[224:225], v23 offset:6208
  ds_read_b64_tr_b16 a[226:227], v23 offset:6400
  ds_read_b64_tr_b16 a[228:229], v23 offset:9280
  ds_read_b64_tr_b16 a[230:231], v23 offset:9472
  s_waitcnt vmcnt(18)
  ds_read_b64_tr_b16 a[232:233], v23 offset:12288
  ds_read_b64_tr_b16 a[234:235], v23 offset:12480
  ds_read_b64_tr_b16 a[236:237], v23 offset:15360
  ds_read_b64_tr_b16 a[238:239], v23 offset:15552
  ds_read_b64_tr_b16 a[240:241], v23 offset:12320
  ds_read_b64_tr_b16 a[242:243], v23 offset:12512
  ds_read_b64_tr_b16 a[244:245], v23 offset:15392
  ds_read_b64_tr_b16 a[246:247], v23 offset:15584
  ds_read_b64_tr_b16 a[248:249], v23 offset:12352
  ds_read_b64_tr_b16 a[250:251], v23 offset:12544
  ds_read_b64_tr_b16 a[252:253], v23 offset:15424
  ds_read_b64_tr_b16 a[254:255], v23 offset:15616
  s_waitcnt vmcnt(12)
  ds_read_b64_tr_b16 v[120:121], v23 offset:18432
  ds_read_b64_tr_b16 v[122:123], v23 offset:18624
  ds_read_b64_tr_b16 v[124:125], v23 offset:21504
  ds_read_b64_tr_b16 v[126:127], v23 offset:21696
  ds_read_b64_tr_b16 v[128:129], v23 offset:18464
  ds_read_b64_tr_b16 v[130:131], v23 offset:18656
  ds_read_b64_tr_b16 v[132:133], v23 offset:21536
  ds_read_b64_tr_b16 v[134:135], v23 offset:21728
  ds_read_b64_tr_b16 v[136:137], v23 offset:18496
  ds_read_b64_tr_b16 v[138:139], v23 offset:18688
  ds_read_b64_tr_b16 v[140:141], v23 offset:21568
  ds_read_b64_tr_b16 v[142:143], v23 offset:21760
  v_add_u32 v17, s65, v0
  s_waitcnt lgkmcnt(10)
  ds_write_b128 v17, v[120:123] offset:18432
  s_waitcnt lgkmcnt(9)
  ds_write_b128 v17, v[124:127] offset:19456
  s_waitcnt lgkmcnt(8)
  ds_write_b128 v17, v[128:131] offset:20480
  s_waitcnt lgkmcnt(7)
  ds_write_b128 v17, v[132:135] offset:21504
  s_waitcnt lgkmcnt(6)
  ds_write_b128 v17, v[136:139] offset:22528
  s_waitcnt lgkmcnt(5)
  ds_write_b128 v17, v[140:143] offset:23552
  s_waitcnt vmcnt(6)
  ds_read_b64_tr_b16 v[120:121], v23 offset:24576
  ds_read_b64_tr_b16 v[122:123], v23 offset:24768
  ds_read_b64_tr_b16 v[124:125], v23 offset:27648
  ds_read_b64_tr_b16 v[126:127], v23 offset:27840
  ds_read_b64_tr_b16 v[128:129], v23 offset:24608
  ds_read_b64_tr_b16 v[130:131], v23 offset:24800
  ds_read_b64_tr_b16 v[132:133], v23 offset:27680
  ds_read_b64_tr_b16 v[134:135], v23 offset:27872
  ds_read_b64_tr_b16 v[136:137], v23 offset:24640
  ds_read_b64_tr_b16 v[138:139], v23 offset:24832
  ds_read_b64_tr_b16 v[140:141], v23 offset:27712
  ds_read_b64_tr_b16 v[142:143], v23 offset:27904
  v_add_u32 v17, s65, v0
  s_waitcnt lgkmcnt(10)
  ds_write_b128 v17, v[120:123] offset:24576
  s_waitcnt lgkmcnt(9)
  ds_write_b128 v17, v[124:127] offset:25600
  s_waitcnt lgkmcnt(8)
  ds_write_b128 v17, v[128:131] offset:26624
  s_waitcnt lgkmcnt(7)
  ds_write_b128 v17, v[132:135] offset:27648
  s_waitcnt lgkmcnt(6)
  ds_write_b128 v17, v[136:139] offset:28672
  s_waitcnt lgkmcnt(5)
  ds_write_b128 v17, v[140:143] offset:29696
  s_waitcnt vmcnt(0)
  ds_read_b64_tr_b16 v[120:121], v23 offset:30720
  ds_read_b64_tr_b16 v[122:123], v23 offset:30912
  ds_read_b64_tr_b16 v[124:125], v23 offset:33792
  ds_read_b64_tr_b16 v[126:127], v23 offset:33984
  ds_read_b64_tr_b16 v[128:129], v23 offset:30752
  ds_read_b64_tr_b16 v[130:131], v23 offset:30944
  ds_read_b64_tr_b16 v[132:133], v23 offset:33824
  ds_read_b64_tr_b16 v[134:135], v23 offset:34016
  ds_read_b64_tr_b16 v[136:137], v23 offset:30784
  ds_read_b64_tr_b16 v[138:139], v23 offset:30976
  ds_read_b64_tr_b16 v[140:141], v23 offset:33856
  ds_read_b64_tr_b16 v[142:143], v23 offset:34048
  v_add_u32 v17, s65, v0
  s_waitcnt lgkmcnt(10)
  ds_write_b128 v17, v[120:123] offset:30720
  s_waitcnt lgkmcnt(9)
  ds_write_b128 v17, v[124:127] offset:31744
  s_waitcnt lgkmcnt(8)
  ds_write_b128 v17, v[128:131] offset:32768
  s_waitcnt lgkmcnt(7)
  ds_write_b128 v17, v[132:135] offset:33792
  s_waitcnt lgkmcnt(6)
  ds_write_b128 v17, v[136:139] offset:34816
  s_waitcnt lgkmcnt(5)
  ds_write_b128 v17, v[140:143] offset:35840
  s_waitcnt lgkmcnt(0)
  s_mov_b32 s62, 1048576
POLLD_13:
  buffer_load_dword v17, off, s[48:51], 0 offset:64 sc1
  s_waitcnt vmcnt(0)
  v_readfirstlane_b32 s63, v17
  s_sub_u32 s62, s62, 1
  s_cbranch_scc1 POLLE_14
  s_cmp_lt_u32 s63, 32
  s_cbranch_scc1 POLLD_13
POLLE_14:
  s_mov_b32 s66, 0
WI_15:
  s_add_u32 s68, s59, 0
  s_add_u32 s69, s59, 4096
  s_add_u32 s70, s59, 8192
  s_add_u32 s71, s59, 12288
  s_add_u32 s72, s59, 16384
  buffer_load_dwordx4 v[8:11], v5, s[52:55], s60 offen sc1
  buffer_load_dwordx4 v[108:111], v0, s[52:55], s71 offen offset:3072 sc1
  buffer_load_dwordx4 v[48:51], v0, s[52:55], s68 offen offset:0 sc1
  buffer_load_dwordx4 v[52:55], v0, s[52:55], s68 offen offset:1024 sc1
  buffer_load_dwordx4 v[56:59], v0, s[52:55], s68 offen offset:2048 sc1
  buffer_load_dwordx4 v[60:63], v0, s[52:55], s68 offen offset:3072 sc1
  buffer_load_dwordx4 v[64:67], v0, s[52:55], s69 offen offset:0 sc1
  buffer_load_dwordx4 v[68:71], v0, s[52:55], s69 offen offset:1024 sc1
  buffer_load_dwordx4 v[72:75], v0, s[52:55], s69 offen offset:2048 sc1
  buffer_load_dwordx4 v[112:115], v0, s[52:55], s72 offen offset:0 sc1
  buffer_load_dwordx4 v[76:79], v0, s[52:55], s69 offen offset:3072 sc1
  buffer_load_dwordx4 v[80:83], v0, s[52:55], s70 offen offset:0 sc1
  buffer_load_dwordx4 v[84:87], v0, s[52:55], s70 offen offset:1024 sc1
  buffer_load_dwordx4 v[88:91], v0, s[52:55], s70 offen offset:2048 sc1
  buffer_load_dwordx4 v[92:95], v0, s[52:55], s70 offen offset:3072 sc1
  buffer_load_dwordx4 v[96:99], v0, s[52:55], s71 offen offset:0 sc1
  buffer_load_dwordx4 v[100:103], v0, s[52:55], s71 offen offset:1024 sc1
  buffer_load_dwordx4 v[104:107], v0, s[52:55], s71 offen offset:2048 sc1
  buffer_load_dwordx4 v[116:119], v0, s[52:55], s72 offen offset:1024 sc1
WR_16:
  v_add_u32 v46, s65, v0
  ds_read_b128 v[120:123], v46 offset:18432
  ds_read_b128 v[124:127], v46 offset:19456
  ds_read_b128 v[128:131], v46 offset:20480
  ds_read_b128 v[132:135], v46 offset:21504
  ds_read_b128 v[136:139], v46 offset:22528
  ds_read_b128 v[140:143], v46 offset:23552
  v_mov_b64 v[16:17], 0
  v_mov_b64 v[18:19], 0
  v_mov_b64 v[20:21], 0
  v_mov_b64 v[22:23], 0
  v_mov_b64 v[24:25], 0
  v_mov_b64 v[26:27], 0
  s_waitcnt vmcnt(18)
  v_max3_u32 v7, v8, v9, v10
  v_max_u32 v7, v11, v7
  s_waitcnt vmcnt(17) lgkmcnt(4)
  v_smfmac_f32_16x16x64_bf16 v[16:19], v[108:111], v[120:127], v1
  v_max3_u32 v7, v108, v109, v7
  s_waitcnt lgkmcnt(2)
  v_smfmac_f32_16x16x64_bf16 v[20:23], v[108:111], v[128:135], v1
  v_max3_u32 v7, v110, v111, v7
  s_waitcnt lgkmcnt(0)
  v_smfmac_f32_16x16x64_bf16 v[24:27], v[108:111], v[136:143], v1
  ds_read_b128 v[120:123], v46 offset:24576
  ds_read_b128 v[124:127], v46 offset:25600
  ds_read_b128 v[128:131], v46 offset:26624
  ds_read_b128 v[132:135], v46 offset:27648
  ds_read_b128 v[136:139], v46 offset:28672
  ds_read_b128 v[140:143], v46 offset:29696
  s_waitcnt vmcnt(16)
  v_smfmac_f32_16x16x64_bf16 v[16:19], v[48:51], v[152:159], v1
  v_max3_u32 v7, v48, v49, v7
  v_smfmac_f32_16x16x64_bf16 v[20:23], v[48:51], v[160:167], v1
  v_max3_u32 v7, v50, v51, v7
  v_smfmac_f32_16x16x64_bf16 v[24:27], v[48:51], v[168:175], v1
  s_waitcnt vmcnt(15)
  v_smfmac_f32_16x16x64_bf16 v[16:19], v[52:55], v[176:183], v1
  v_max3_u32 v7, v52, v53, v7
  v_smfmac_f32_16x16x64_bf16 v[20:23], v[52:55], v[184:191], v1
  v_max3_u32 v7, v54, v55, v7
  v_smfmac_f32_16x16x64_bf16 v[24:27], v[52:55], v[192:199], v1
  s_waitcnt vmcnt(14)
  v_smfmac_f32_16x16x64_bf16 v[16:19], v[56:59], v[200:207], v1
  v_max3_u32 v7, v56, v57, v7
  v_smfmac_f32_16x16x64_bf16 v[20:23], v[56:59], v[208:215], v1
  v_max3_u32 v7, v58, v59, v7
  v_smfmac_f32_16x16x64_bf16 v[24:27], v[56:59], v[216:223], v1
  s_waitcnt vmcnt(13)
  v_smfmac_f32_16x16x64_bf16 v[16:19], v[60:63], v[224:231], v1
  v_max3_u32 v7, v60, v61, v7
  v_smfmac_f32_16x16x64_bf16 v[20:23], v[60:63], v[232:239], v1
  v_max3_u32 v7, v62, v63, v7
  v_smfmac_f32_16x16x64_bf16 v[24:27], v[60:63], v[240:247], v1
  s_waitcnt vmcnt(12)
  v_smfmac_f32_16x16x64_bf16 v[16:19], v[64:67], v[248:255], v1
  v_max3_u32 v7, v64, v65, v7
  v_smfmac_f32_16x16x64_bf16 v[20:23], v[64:67], a[0:7], v1
  v_max3_u32 v7, v66, v67, v7
  v_smfmac_f32_16x16x64_bf16 v[24:27], v[64:67], a[8:15], v1
  s_waitcnt vmcnt(11)
  v_smfmac_f32_16x16x64_bf16 v[16:19], v[68:71], a[16:23], v1
  v_max3_u32 v7, v68, v69, v7
  v_smfmac_f32_16x16x64_bf16 v[20:23], v[68:71], a[24:31], v1
  v_max3_u32 v7, v70, v71, v7
  v_smfmac_f32_16x16x64_bf16 v[24:27], v[68:71], a[32:39], v1
  s_waitcnt vmcnt(10)
  v_smfmac_f32_16x16x64_bf16 v[16:19], v[72:75], a[40:47], v1
  v_max3_u32 v7, v72, v73, v7
  v_smfmac_f32_16x16x64_bf16 v[20:23], v[72:75], a[48:55], v1
  v_max3_u32 v7, v74, v75, v7
  v_smfmac_f32_16x16x64_bf16 v[24:27], v[72:75], a[56:63], v1
  s_waitcnt vmcnt(9) lgkmcnt(4)
  v_smfmac_f32_16x16x64_bf16 v[16:19], v[112:115], v[120:127], v1
  v_max3_u32 v7, v112, v113, v7
  s_waitcnt lgkmcnt(2)
  v_smfmac_f32_16x16x64_bf16 v[20:23], v[112:115], v[128:135], v1
  v_max3_u32 v7, v114, v115, v7
  s_waitcnt lgkmcnt(0)
  v_smfmac_f32_16x16x64_bf16 v[24:27], v[112:115], v[136:143], v1
  ds_read_b128 v[120:123], v46 offset:30720
  ds_read_b128 v[124:127], v46 offset:31744
  ds_read_b128 v[128:131], v46 offset:32768
  ds_read_b128 v[132:135], v46 offset:33792
  ds_read_b128 v[136:139], v46 offset:34816
  ds_read_b128 v[140:143], v46 offset:35840
  s_waitcnt vmcnt(8)
  v_smfmac_f32_16x16x64_bf16 v[16:19], v[76:79], a[64:71], v1
  v_max3_u32 v7, v76, v77, v7
  v_smfmac_f32_16x16x64_bf16 v[20:23], v[76:79], a[72:79], v1
  v_max3_u32 v7, v78, v79, v7
  v_smfmac_f32_16x16x64_bf16 v[24:27], v[76:79], a[80:87], v1
  s_waitcnt vmcnt(7)
  v_smfmac_f32_16x16x64_bf16 v[16:19], v[80:83], a[88:95], v1
  v_max3_u32 v7, v80, v81, v7
  v_smfmac_f32_16x16x64_bf16 v[20:23], v[80:83], a[96:103], v1
  v_max3_u32 v7, v82, v83, v7
  v_smfmac_f32_16x16x64_bf16 v[24:27], v[80:83], a[104:111], v1
  s_waitcnt vmcnt(6)
  v_smfmac_f32_16x16x64_bf16 v[16:19], v[84:87], a[112:119], v1
  v_max3_u32 v7, v84, v85, v7
  v_smfmac_f32_16x16x64_bf16 v[20:23], v[84:87], a[120:127], v1
  v_max3_u32 v7, v86, v87, v7
  v_smfmac_f32_16x16x64_bf16 v[24:27], v[84:87], a[128:135], v1
  s_waitcnt vmcnt(5)
  v_smfmac_f32_16x16x64_bf16 v[16:19], v[88:91], a[136:143], v1
  v_max3_u32 v7, v88, v89, v7
  v_smfmac_f32_16x16x64_bf16 v[20:23], v[88:91], a[144:151], v1
  v_max3_u32 v7, v90, v91, v7
  v_smfmac_f32_16x16x64_bf16 v[24:27], v[88:91], a[152:159], v1
  s_waitcnt vmcnt(4)
  v_smfmac_f32_16x16x64_bf16 v[16:19], v[92:95], a[160:167], v1
  v_max3_u32 v7, v92, v93, v7
  v_smfmac_f32_16x16x64_bf16 v[20:23], v[92:95], a[168:175], v1
  v_max3_u32 v7, v94, v95, v7
  v_smfmac_f32_16x16x64_bf16 v[24:27], v[92:95], a[176:183], v1
  s_waitcnt vmcnt(3)
  v_smfmac_f32_16x16x64_bf16 v[16:19], v[96:99], a[184:191], v1
  v_max3_u32 v7, v96, v97, v7
  v_smfmac_f32_16x16x64_bf16 v[20:23], v[96:99], a[192:199], v1
  v_max3_u32 v7, v98, v99, v7
  v_smfmac_f32_16x16x64_bf16 v[24:27], v[96:99], a[200:207], v1
  s_waitcnt vmcnt(2)
  v_smfmac_f32_16x16x64_bf16 v[16:19], v[100:103], a[208:215], v1
  v_max3_u32 v7, v100, v101, v7
  v_smfmac_f32_16x16x64_bf16 v[20:23], v[100:103], a[216:223], v1
  v_max3_u32 v7, v102, v103, v7
  v_smfmac_f32_16x16x64_bf16 v[24:27], v[100:103], a[224:231], v1
  s_waitcnt vmcnt(1)
  v_smfmac_f32_16x16x64_bf16 v[16:19], v[104:107], a[232:239], v1
  v_max3_u32 v7, v104, v105, v7
  v_smfmac_f32_16x16x64_bf16 v[20:23], v[104:107], a[240:247], v1
  v_max3_u32 v7, v106, v107, v7
  v_smfmac_f32_16x16x64_bf16 v[24:27], v[104:107], a[248:255], v1
  s_waitcnt vmcnt(0) lgkmcnt(4)
  v_smfmac_f32_16x16x64_bf16 v[16:19], v[116:119], v[120:127], v1
  v_max3_u32 v7, v116, v117, v7
  s_waitcnt lgkmcnt(2)
  v_smfmac_f32_16x16x64_bf16 v[20:23], v[116:119], v[128:135], v1
  v_max3_u32 v7, v118, v119, v7
  s_waitcnt lgkmcnt(0)
  v_smfmac_f32_16x16x64_bf16 v[24:27], v[116:119], v[136:143], v1
  v_cmp_eq_u32 vcc, -1, v7
  s_sub_i32 s64, s64, 1
  s_cmp_lt_i32 s64, 0
  s_cbranch_scc1 WK_17
  s_cbranch_vccnz WI_15
WK_17:
  v_mov_b64 v[12:13], v[8:9]
  v_mov_b64 v[14:15], v[10:11]
  s_add_u32 s59, s59, 294912
  s_add_u32 s60, s60, 40960
  s_add_u32 s68, s59, 0
  s_add_u32 s69, s59, 4096
  s_add_u32 s70, s59, 8192
  s_add_u32 s71, s59, 12288
  s_add_u32 s72, s59, 16384
  buffer_load_dwordx4 v[8:11], v5, s[52:55], s60 offen sc1
  buffer_load_dwordx4 v[108:111], v0, s[52:55], s71 offen offset:3072 sc1
  buffer_load_dwordx4 v[48:51], v0, s[52:55], s68 offen offset:0 sc1
  buffer_load_dwordx4 v[52:55], v0, s[52:55], s68 offen offset:1024 sc1
  buffer_load_dwordx4 v[56:59], v0, s[52:55], s68 offen offset:2048 sc1
  buffer_load_dwordx4 v[60:63], v0, s[52:55], s68 offen offset:3072 sc1
  buffer_load_dwordx4 v[64:67], v0, s[52:55], s69 offen offset:0 sc1
  buffer_load_dwordx4 v[68:71], v0, s[52:55], s69 offen offset:1024 sc1
  buffer_load_dwordx4 v[72:75], v0, s[52:55], s69 offen offset:2048 sc1
  buffer_load_dwordx4 v[112:115], v0, s[52:55], s72 offen offset:0 sc1
  buffer_load_dwordx4 v[76:79], v0, s[52:55], s69 offen offset:3072 sc1
  buffer_load_dwordx4 v[80:83], v0, s[52:55], s70 offen offset:0 sc1
  buffer_load_dwordx4 v[84:87], v0, s[52:55], s70 offen offset:1024 sc1
  buffer_load_dwordx4 v[88:91], v0, s[52:55], s70 offen offset:2048 sc1
  buffer_load_dwordx4 v[92:95], v0, s[52:55], s70 offen offset:3072 sc1
  buffer_load_dwordx4 v[96:99], v0, s[52:55], s71 offen offset:0 sc1
  buffer_load_dwordx4 v[100:103], v0, s[52:55], s71 offen offset:1024 sc1
  buffer_load_dwordx4 v[104:107], v0, s[52:55], s71 offen offset:2048 sc1
  buffer_load_dwordx4 v[116:119], v0, s[52:55], s72 offen offset:1024 sc1
  v_permlane32_swap_b32 v16, v20
  v_permlane32_swap_b32 v17, v21
  v_permlane32_swap_b32 v18, v22
  v_permlane32_swap_b32 v19, v23
  v_permlane32_swap_b32 v24, v25
  v_permlane32_swap_b32 v26, v27
  v_add_u32 v28, s66, v2
  v_add_u32 v29, s66, v3
  v_add_f32 v16, v16, v20
  v_add_f32 v17, v17, v21
  v_add_f32 v18, v18, v22
  v_add_f32 v19, v19, v23
  v_add_f32 v24, v24, v25
  v_add_f32 v26, v26, v27
  ds_write2_b32 v28, v16, v17 offset0:0 offset1:52
  ds_write2_b32 v28, v18, v19 offset0:104 offset1:156
  ds_write2_b32 v29, v24, v26 offset0:0 offset1:104
  s_waitcnt lgkmcnt(0)
  s_barrier
  s_cmp_lg_u32 s5, 0
  s_cbranch_scc1 WN_18
  v_add_u32 v7, s66, v4
  ds_read_b128 v[16:19], v7
  ds_read_b128 v[20:23], v7 offset:16
  ds_read_b128 v[24:27], v7 offset:40960
  ds_read_b128 v[28:31], v7 offset:40976
  v_add_u32 v7, 81920, v7
  ds_read_b128 v[32:35], v7
  ds_read_b128 v[36:39], v7 offset:16
  ds_read_b128 v[40:43], v7 offset:40960
  ds_read_b128 v[44:47], v7 offset:40976
  s_waitcnt lgkmcnt(5)
  v_pk_add_f32 v[16:17], v[16:17], v[24:25]
  v_pk_add_f32 v[18:19], v[18:19], v[26:27]
  s_waitcnt lgkmcnt(4)
  v_pk_add_f32 v[20:21], v[20:21], v[28:29]
  v_pk_add_f32 v[22:23], v[22:23], v[30:31]
  v_lshlrev_b32 v24, 16, v12
  v_and_b32 v25, 0xffff0000, v12
  v_lshlrev_b32 v26, 16, v13
  v_and_b32 v27, 0xffff0000, v13
  v_lshlrev_b32 v28, 16, v14
  v_and_b32 v29, 0xffff0000, v14
  v_lshlrev_b32 v30, 16, v15
  v_and_b32 v31, 0xffff0000, v15
  v_pk_add_f32 v[16:17], v[16:17], v[24:25]
  v_pk_add_f32 v[18:19], v[18:19], v[26:27]
  v_pk_add_f32 v[20:21], v[20:21], v[28:29]
  v_pk_add_f32 v[22:23], v[22:23], v[30:31]
  s_waitcnt lgkmcnt(1)
  v_pk_add_f32 v[32:33], v[32:33], v[40:41]
  v_pk_add_f32 v[34:35], v[34:35], v[42:43]
  s_waitcnt lgkmcnt(0)
  v_pk_add_f32 v[36:37], v[36:37], v[44:45]
  v_pk_add_f32 v[38:39], v[38:39], v[46:47]
  v_pk_add_f32 v[16:17], v[16:17], v[32:33]
  v_cvt_pk_bf16_f32 v12, v16, v17
  v_pk_add_f32 v[18:19], v[18:19], v[34:35]
  v_cvt_pk_bf16_f32 v13, v18, v19
  v_pk_add_f32 v[20:21], v[20:21], v[36:37]
  v_cvt_pk_bf16_f32 v14, v20, v21
  v_pk_add_f32 v[22:23], v[22:23], v[38:39]
  v_cvt_pk_bf16_f32 v15, v22, v23
  buffer_store_dwordx4 v[12:15], v6, s[44:47], s61 offen
WN_18:
  s_add_u32 s61, s61, 36864
  s_xor_b32 s66, s66, 2048
  s_add_u32 s58, s58, 1
  s_cmp_lt_u32 s58, 64
  s_cbranch_scc1 WR_16
  s_waitcnt vmcnt(0)
  s_endpgm
R_W:
  s_mul_i32 s56, s7, 43
  s_lshr_b32 s56, s56, 9
  s_mul_i32 s62, s56, 12
  s_sub_u32 s57, s7, s62
  s_mul_i32 s65, s5, 40960
  s_mov_b32 s64, 131072
  s_mov_b32 s58, 0
  s_mul_i32 s62, s57, 3072
  s_lshl_b32 s63, s56, 7
  s_add_u32 s62, s62, s63
  s_add_u32 s62, s62, 88080384
  s_mul_i32 s63, s56, 9216
  s_mul_i32 s59, s57, 96
  s_add_u32 s63, s63, s59
  s_mov_b32 s61, s62
  s_mov_b32 s60, s63
  s_mul_i32 s59, s56, 65536
  s_mul_i32 s62, s5, 16384
  s_add_u32 s59, s59, s62
  s_add_u32 s59, s59, 50331648
  v_mov_b32 v16, v0
  v_lshrrev_b32 v17, 3, v16
  v_min_u32 v17, 5, v17
  v_and_b32 v18, 7, v16
  v_lshlrev_b32 v6, 9, v17
  v_lshl_add_u32 v6, v18, 4, v6
  v_mul_u32_u24 v5, 1152, v18
  v_lshl_add_u32 v5, v17, 4, v5
  v_mul_u32_u24 v4, 208, v18
  v_lshl_add_u32 v4, v17, 5, v4
  v_add_u32 v4, 36864, v4
  v_lshrrev_b32 v112, 5, v16
  v_lshlrev_b32 v112, 9, v112
  v_lshl_add_u32 v112, v18, 4, v112
  s_lshr_b32 s62, s57, 2
  s_lshl_b32 s73, s62, 10
  s_and_b32 s62, s57, 3
  s_lshl_b32 s62, s62, 2
  s_add_u32 s73, s73, s62
  s_lshl_b32 s62, s56, 7
  s_add_u32 s73, s73, s62
  s_add_u32 s73, s73, 88117248
  s_mov_b32 s74, 0x3f803f80
  v_add_u32 v17, 0, v16
  v_mul_u32_u24 v18, 43691, v17
  v_lshrrev_b32 v18, 18, v18
  v_mul_u32_u24 v19, 6, v18
  v_sub_u32 v19, v17, v19
  v_mul_u32_u24 v20, 1152, v18
  v_lshl_add_u32 v20, v19, 4, v20
  v_add_u32 v17, 64, v16
  v_mul_u32_u24 v18, 43691, v17
  v_lshrrev_b32 v18, 18, v18
  v_mul_u32_u24 v19, 6, v18
  v_sub_u32 v19, v17, v19
  v_mul_u32_u24 v21, 1152, v18
  v_lshl_add_u32 v21, v19, 4, v21
  v_add_u32 v17, 128, v16
  v_mul_u32_u24 v18, 43691, v17
  v_lshrrev_b32 v18, 18, v18
  v_mul_u32_u24 v19, 6, v18
  v_sub_u32 v19, v17, v19
  v_mul_u32_u24 v22, 1152, v18
  v_lshl_add_u32 v22, v19, 4, v22
  s_mul_i32 s62, s5, 1179648
  s_mul_i32 s63, s57, 96
  s_add_u32 s62, s62, s63
  s_add_u32 m0, s65, 0
  s_add_u32 s63, s62, 0
  buffer_load_dwordx4 v20, s[28:31], s63 offen lds
  s_add_u32 m0, s65, 1024
  s_add_u32 s63, s62, 0
  buffer_load_dwordx4 v21, s[28:31], s63 offen lds
  s_add_u32 m0, s65, 2048
  s_add_u32 s63, s62, 0
  buffer_load_dwordx4 v22, s[28:31], s63 offen lds
  s_add_u32 m0, s65, 3072
  s_add_u32 s63, s62, 36864
  buffer_load_dwordx4 v20, s[28:31], s63 offen lds
  s_add_u32 m0, s65, 4096
  s_add_u32 s63, s62, 36864
  buffer_load_dwordx4 v21, s[28:31], s63 offen lds
  s_add_u32 m0, s65, 5120
  s_add_u32 s63, s62, 36864
  buffer_load_dwordx4 v22, s[28:31], s63 offen lds
  s_mul_i32 s62, s5, 1179648
  s_mul_i32 s63, s57, 96
  s_add_u32 s62, s62, s63
  s_add_u32 m0, s65, 6144
  s_add_u32 s63, s62, 73728
  buffer_load_dwordx4 v20, s[28:31], s63 offen lds
  s_add_u32 m0, s65, 7168
  s_add_u32 s63, s62, 73728
  buffer_load_dwordx4 v21, s[28:31], s63 offen lds
  s_add_u32 m0, s65, 8192
  s_add_u32 s63, s62, 73728
  buffer_load_dwordx4 v22, s[28:31], s63 offen lds
  s_add_u32 m0, s65, 9216
  s_add_u32 s63, s62, 110592
  buffer_load_dwordx4 v20, s[28:31], s63 offen lds
  s_add_u32 m0, s65, 10240
  s_add_u32 s63, s62, 110592
  buffer_load_dwordx4 v21, s[28:31], s63 offen lds
  s_add_u32 m0, s65, 11264
  s_add_u32 s63, s62, 110592
  buffer_load_dwordx4 v22, s[28:31], s63 offen lds
  s_mul_i32 s62, s5, 1179648
  s_mul_i32 s63, s57, 96
  s_add_u32 s62, s62, s63
  s_add_u32 m0, s65, 12288
  s_add_u32 s63, s62, 147456
  buffer_load_dwordx4 v20, s[28:31], s63 offen lds
  s_add_u32 m0, s65, 13312
  s_add_u32 s63, s62, 147456
  buffer_load_dwordx4 v21, s[28:31], s63 offen lds
  s_add_u32 m0, s65, 14336
  s_add_u32 s63, s62, 147456
  buffer_load_dwordx4 v22, s[28:31], s63 offen lds
  s_add_u32 m0, s65, 15360
  s_add_u32 s63, s62, 184320
  buffer_load_dwordx4 v20, s[28:31], s63 offen lds
  s_add_u32 m0, s65, 16384
  s_add_u32 s63, s62, 184320
  buffer_load_dwordx4 v21, s[28:31], s63 offen lds
  s_add_u32 m0, s65, 17408
  s_add_u32 s63, s62, 184320
  buffer_load_dwordx4 v22, s[28:31], s63 offen lds
  s_mul_i32 s62, s5, 1179648
  s_mul_i32 s63, s57, 96
  s_add_u32 s62, s62, s63
  s_add_u32 m0, s65, 18432
  s_add_u32 s63, s62, 221184
  buffer_load_dwordx4 v20, s[28:31], s63 offen lds
  s_add_u32 m0, s65, 19456
  s_add_u32 s63, s62, 221184
  buffer_load_dwordx4 v21, s[28:31], s63 offen lds
  s_add_u32 m0, s65, 20480
  s_add_u32 s63, s62, 221184
  buffer_load_dwordx4 v22, s[28:31], s63 offen lds
  s_add_u32 m0, s65, 21504
  s_add_u32 s63, s62, 258048
  buffer_load_dwordx4 v20, s[28:31], s63 offen lds
  s_add_u32 m0, s65, 22528
  s_add_u32 s63, s62, 258048
  buffer_load_dwordx4 v21, s[28:31], s63 offen lds
  s_add_u32 m0, s65, 23552
  s_add_u32 s63, s62, 258048
  buffer_load_dwordx4 v22, s[28:31], s63 offen lds
  s_mul_i32 s62, s5, 1179648
  s_mul_i32 s63, s57, 96
  s_add_u32 s62, s62, s63
  s_add_u32 m0, s65, 24576
  s_add_u32 s63, s62, 294912
  buffer_load_dwordx4 v20, s[28:31], s63 offen lds
  s_add_u32 m0, s65, 25600
  s_add_u32 s63, s62, 294912
  buffer_load_dwordx4 v21, s[28:31], s63 offen lds
  s_add_u32 m0, s65, 26624
  s_add_u32 s63, s62, 294912
  buffer_load_dwordx4 v22, s[28:31], s63 offen lds
  s_add_u32 m0, s65, 27648
  s_add_u32 s63, s62, 331776
  buffer_load_dwordx4 v20, s[28:31], s63 offen lds
  s_add_u32 m0, s65, 28672
  s_add_u32 s63, s62, 331776
  buffer_load_dwordx4 v21, s[28:31], s63 offen lds
  s_add_u32 m0, s65, 29696
  s_add_u32 s63, s62, 331776
  buffer_load_dwordx4 v22, s[28:31], s63 offen lds
  s_mul_i32 s62, s5, 1179648
  s_mul_i32 s63, s57, 96
  s_add_u32 s62, s62, s63
  s_add_u32 m0, s65, 30720
  s_add_u32 s63, s62, 368640
  buffer_load_dwordx4 v20, s[28:31], s63 offen lds
  s_add_u32 m0, s65, 31744
  s_add_u32 s63, s62, 368640
  buffer_load_dwordx4 v21, s[28:31], s63 offen lds
  s_add_u32 m0, s65, 32768
  s_add_u32 s63, s62, 368640
  buffer_load_dwordx4 v22, s[28:31], s63 offen lds
  s_add_u32 m0, s65, 33792
  s_add_u32 s63, s62, 405504
  buffer_load_dwordx4 v20, s[28:31], s63 offen lds
  s_add_u32 m0, s65, 34816
  s_add_u32 s63, s62, 405504
  buffer_load_dwordx4 v21, s[28:31], s63 offen lds
  s_add_u32 m0, s65, 35840
  s_add_u32 s63, s62, 405504
  buffer_load_dwordx4 v22, s[28:31], s63 offen lds
  v_lshrrev_b32 v17, 4, v16
  v_lshlrev_b32 v17, 3, v17
  v_bfe_u32 v18, v16, 3, 1
  v_lshl_add_u32 v17, v18, 2, v17
  v_bfe_u32 v18, v16, 2, 1
  v_add_u32 v17, v17, v18
  v_mul_u32_u24 v23, 96, v17
  v_and_b32 v18, 3, v16
  v_lshl_add_u32 v23, v18, 3, v23
  v_add_u32 v23, s65, v23
  v_bfe_u32 v17, v16, 4, 1
  v_mul_u32_u24 v17, 832, v17
  v_and_b32 v18, 15, v16
  v_lshl_add_u32 v17, v18, 2, v17
  v_add_u32 v17, s65, v17
  v_lshrrev_b32 v18, 5, v16
  v_lshl_add_u32 v2, v18, 6, v17
  v_add_u32 v2, 36864, v2
  v_mul_u32_u24 v18, 208, v18
  v_add_u32 v3, v17, v18
  v_add_u32 v3, 36992, v3
  s_mov_b32 s62, 0xff00ff00
  s_mov_b32 s63, 0xff00ff00
  v_mov_b32 v1, 0x4444
  v_mov_b32 v17, 0xeeee
  v_cndmask_b32 v1, v1, v17, s[62:63]
  v_lshlrev_b32 v0, 4, v16
  s_waitcnt vmcnt(30)
  ds_read_b64_tr_b16 v[128:129], v23 offset:0
  ds_read_b64_tr_b16 v[130:131], v23 offset:192
  ds_read_b64_tr_b16 v[132:133], v23 offset:3072
  ds_read_b64_tr_b16 v[134:135], v23 offset:3264
  ds_read_b64_tr_b16 v[136:137], v23 offset:32
  ds_read_b64_tr_b16 v[138:139], v23 offset:224
  ds_read_b64_tr_b16 v[140:141], v23 offset:3104
  ds_read_b64_tr_b16 v[142:143], v23 offset:3296
  ds_read_b64_tr_b16 v[144:145], v23 offset:64
  ds_read_b64_tr_b16 v[146:147], v23 offset:256
  ds_read_b64_tr_b16 v[148:149], v23 offset:3136
  ds_read_b64_tr_b16 v[150:151], v23 offset:3328
  s_waitcnt lgkmcnt(0)
  s_mul_i32 s62, s5, 1179648
  s_mul_i32 s63, s57, 96
  s_add_u32 s62, s62, s63
  s_add_u32 m0, s65, 0
  s_add_u32 s63, s62, 442368
  buffer_load_dwordx4 v20, s[28:31], s63 offen lds
  s_add_u32 m0, s65, 1024
  s_add_u32 s63, s62, 442368
  buffer_load_dwordx4 v21, s[28:31], s63 offen lds
  s_add_u32 m0, s65, 2048
  s_add_u32 s63, s62, 442368
  buffer_load_dwordx4 v22, s[28:31], s63 offen lds
  s_add_u32 m0, s65, 3072
  s_add_u32 s63, s62, 479232
  buffer_load_dwordx4 v20, s[28:31], s63 offen lds
  s_add_u32 m0, s65, 4096
  s_add_u32 s63, s62, 479232
  buffer_load_dwordx4 v21, s[28:31], s63 offen lds
  s_add_u32 m0, s65, 5120
  s_add_u32 s63, s62, 479232
  buffer_load_dwordx4 v22, s[28:31], s63 offen lds
  s_waitcnt vmcnt(30)
  ds_read_b64_tr_b16 v[152:153], v23 offset:6144
  ds_read_b64_tr_b16 v[154:155], v23 offset:6336
  ds_read_b64_tr_b16 v[156:157], v23 offset:9216
  ds_read_b64_tr_b16 v[158:159], v23 offset:9408
  ds_read_b64_tr_b16 v[160:161], v23 offset:6176
  ds_read_b64_tr_b16 v[162:163], v23 offset:6368
  ds_read_b64_tr_b16 v[164:165], v23 offset:9248
  ds_read_b64_tr_b16 v[166:167], v23 offset:9440
  ds_read_b64_tr_b16 v[168:169], v23 offset:6208
  ds_read_b64_tr_b16 v[170:171], v23 offset:6400
  ds_read_b64_tr_b16 v[172:173], v23 offset:9280
  ds_read_b64_tr_b16 v[174:175], v23 offset:9472
  s_waitcnt lgkmcnt(0)
  s_mul_i32 s62, s5, 1179648
  s_mul_i32 s63, s57, 96
  s_add_u32 s62, s62, s63
  s_add_u32 m0, s65, 6144
  s_add_u32 s63, s62, 516096
  buffer_load_dwordx4 v20, s[28:31], s63 offen lds
  s_add_u32 m0, s65, 7168
  s_add_u32 s63, s62, 516096
  buffer_load_dwordx4 v21, s[28:31], s63 offen lds
  s_add_u32 m0, s65, 8192
  s_add_u32 s63, s62, 516096
  buffer_load_dwordx4 v22, s[28:31], s63 offen lds
  s_add_u32 m0, s65, 9216
  s_add_u32 s63, s62, 552960
  buffer_load_dwordx4 v20, s[28:31], s63 offen lds
  s_add_u32 m0, s65, 10240
  s_add_u32 s63, s62, 552960
  buffer_load_dwordx4 v21, s[28:31], s63 offen lds
  s_add_u32 m0, s65, 11264
  s_add_u32 s63, s62, 552960
  buffer_load_dwordx4 v22, s[28:31], s63 offen lds
  s_waitcnt vmcnt(30)
  ds_read_b64_tr_b16 v[176:177], v23 offset:12288
  ds_read_b64_tr_b16 v[178:179], v23 offset:12480
  ds_read_b64_tr_b16 v[180:181], v23 offset:15360
  ds_read_b64_tr_b16 v[182:183], v23 offset:15552
  ds_read_b64_tr_b16 v[184:185], v23 offset:12320
  ds_read_b64_tr_b16 v[186:187], v23 offset:12512
  ds_read_b64_tr_b16 v[188:189], v23 offset:15392
  ds_read_b64_tr_b16 v[190:191], v23 offset:15584
  ds_read_b64_tr_b16 v[192:193], v23 offset:12352
  ds_read_b64_tr_b16 v[194:195], v23 offset:12544
  ds_read_b64_tr_b16 v[196:197], v23 offset:15424
  ds_read_b64_tr_b16 v[198:199], v23 offset:15616
  s_waitcnt lgkmcnt(0)
  s_mul_i32 s62, s5, 1179648
  s_mul_i32 s63, s57, 96
  s_add_u32 s62, s62, s63
  s_add_u32 m0, s65, 12288
  s_add_u32 s63, s62, 589824
  buffer_load_dwordx4 v20, s[28:31], s63 offen lds
  s_add_u32 m0, s65, 13312
  s_add_u32 s63, s62, 589824
  buffer_load_dwordx4 v21, s[28:31], s63 offen lds
  s_add_u32 m0, s65, 14336
  s_add_u32 s63, s62, 589824
  buffer_load_dwordx4 v22, s[28:31], s63 offen lds
  s_add_u32 m0, s65, 15360
  s_add_u32 s63, s62, 626688
  buffer_load_dwordx4 v20, s[28:31], s63 offen lds
  s_add_u32 m0, s65, 16384
  s_add_u32 s63, s62, 626688
  buffer_load_dwordx4 v21, s[28:31], s63 offen lds
  s_add_u32 m0, s65, 17408
  s_add_u32 s63, s62, 626688
  buffer_load_dwordx4 v22, s[28:31], s63 offen lds
  s_waitcnt vmcnt(30)
  ds_read_b64_tr_b16 v[200:201], v23 offset:18432
  ds_read_b64_tr_b16 v[202:203], v23 offset:18624
  ds_read_b64_tr_b16 v[204:205], v23 offset:21504
  ds_read_b64_tr_b16 v[206:207], v23 offset:21696
  ds_read_b64_tr_b16 v[208:209], v23 offset:18464
  ds_read_b64_tr_b16 v[210:211], v23 offset:18656
  ds_read_b64_tr_b16 v[212:213], v23 offset:21536
  ds_read_b64_tr_b16 v[214:215], v23 offset:21728
  ds_read_b64_tr_b16 v[216:217], v23 offset:18496
  ds_read_b64_tr_b16 v[218:219], v23 offset:18688
  ds_read_b64_tr_b16 v[220:221], v23 offset:21568
  ds_read_b64_tr_b16 v[222:223], v23 offset:21760
  s_waitcnt lgkmcnt(0)
  s_mul_i32 s62, s5, 1179648
  s_mul_i32 s63, s57, 96
  s_add_u32 s62, s62, s63
  s_add_u32 m0, s65, 18432
  s_add_u32 s63, s62, 663552
  buffer_load_dwordx4 v20, s[28:31], s63 offen lds
  s_add_u32 m0, s65, 19456
  s_add_u32 s63, s62, 663552
  buffer_load_dwordx4 v21, s[28:31], s63 offen lds
  s_add_u32 m0, s65, 20480
  s_add_u32 s63, s62, 663552
  buffer_load_dwordx4 v22, s[28:31], s63 offen lds
  s_add_u32 m0, s65, 21504
  s_add_u32 s63, s62, 700416
  buffer_load_dwordx4 v20, s[28:31], s63 offen lds
  s_add_u32 m0, s65, 22528
  s_add_u32 s63, s62, 700416
  buffer_load_dwordx4 v21, s[28:31], s63 offen lds
  s_add_u32 m0, s65, 23552
  s_add_u32 s63, s62, 700416
  buffer_load_dwordx4 v22, s[28:31], s63 offen lds
  s_waitcnt vmcnt(30)
  ds_read_b64_tr_b16 v[224:225], v23 offset:24576
  ds_read_b64_tr_b16 v[226:227], v23 offset:24768
  ds_read_b64_tr_b16 v[228:229], v23 offset:27648
  ds_read_b64_tr_b16 v[230:231], v23 offset:27840
  ds_read_b64_tr_b16 v[232:233], v23 offset:24608
  ds_read_b64_tr_b16 v[234:235], v23 offset:24800
  ds_read_b64_tr_b16 v[236:237], v23 offset:27680
  ds_read_b64_tr_b16 v[238:239], v23 offset:27872
  ds_read_b64_tr_b16 v[240:241], v23 offset:24640
  ds_read_b64_tr_b16 v[242:243], v23 offset:24832
  ds_read_b64_tr_b16 v[244:245], v23 offset:27712
  ds_read_b64_tr_b16 v[246:247], v23 offset:27904
  s_waitcnt lgkmcnt(0)
  s_mul_i32 s62, s5, 1179648
  s_mul_i32 s63, s57, 96
  s_add_u32 s62, s62, s63
  s_add_u32 m0, s65, 24576
  s_add_u32 s63, s62, 737280
  buffer_load_dwordx4 v20, s[28:31], s63 offen lds
  s_add_u32 m0, s65, 25600
  s_add_u32 s63, s62, 737280
  buffer_load_dwordx4 v21, s[28:31], s63 offen lds
  s_add_u32 m0, s65, 26624
  s_add_u32 s63, s62, 737280
  buffer_load_dwordx4 v22, s[28:31], s63 offen lds
  s_add_u32 m0, s65, 27648
  s_add_u32 s63, s62, 774144
  buffer_load_dwordx4 v20, s[28:31], s63 offen lds
  s_add_u32 m0, s65, 28672
  s_add_u32 s63, s62, 774144
  buffer_load_dwordx4 v21, s[28:31], s63 offen lds
  s_add_u32 m0, s65, 29696
  s_add_u32 s63, s62, 774144
  buffer_load_dwordx4 v22, s[28:31], s63 offen lds
  s_waitcnt vmcnt(30)
  ds_read_b64_tr_b16 v[248:249], v23 offset:30720
  ds_read_b64_tr_b16 v[250:251], v23 offset:30912
  ds_read_b64_tr_b16 v[252:253], v23 offset:33792
  ds_read_b64_tr_b16 v[254:255], v23 offset:33984
  ds_read_b64_tr_b16 a[0:1], v23 offset:30752
  ds_read_b64_tr_b16 a[2:3], v23 offset:30944
  ds_read_b64_tr_b16 a[4:5], v23 offset:33824
  ds_read_b64_tr_b16 a[6:7], v23 offset:34016
  ds_read_b64_tr_b16 a[8:9], v23 offset:30784
  ds_read_b64_tr_b16 a[10:11], v23 offset:30976
  ds_read_b64_tr_b16 a[12:13], v23 offset:33856
  ds_read_b64_tr_b16 a[14:15], v23 offset:34048
  s_waitcnt lgkmcnt(0)
  s_mul_i32 s62, s5, 1179648
  s_mul_i32 s63, s57, 96
  s_add_u32 s62, s62, s63
  s_add_u32 m0, s65, 30720
  s_add_u32 s63, s62, 811008
  buffer_load_dwordx4 v20, s[28:31], s63 offen lds
  s_add_u32 m0, s65, 31744
  s_add_u32 s63, s62, 811008
  buffer_load_dwordx4 v21, s[28:31], s63 offen lds
  s_add_u32 m0, s65, 32768
  s_add_u32 s63, s62, 811008
  buffer_load_dwordx4 v22, s[28:31], s63 offen lds
  s_add_u32 m0, s65, 33792
  s_add_u32 s63, s62, 847872
  buffer_load_dwordx4 v20, s[28:31], s63 offen lds
  s_add_u32 m0, s65, 34816
  s_add_u32 s63, s62, 847872
  buffer_load_dwordx4 v21, s[28:31], s63 offen lds
  s_add_u32 m0, s65, 35840
  s_add_u32 s63, s62, 847872
  buffer_load_dwordx4 v22, s[28:31], s63 offen lds
  s_waitcnt vmcnt(30)
  ds_read_b64_tr_b16 a[16:17], v23 offset:0
  ds_read_b64_tr_b16 a[18:19], v23 offset:192
  ds_read_b64_tr_b16 a[20:21], v23 offset:3072
  ds_read_b64_tr_b16 a[22:23], v23 offset:3264
  ds_read_b64_tr_b16 a[24:25], v23 offset:32
  ds_read_b64_tr_b16 a[26:27], v23 offset:224
  ds_read_b64_tr_b16 a[28:29], v23 offset:3104
  ds_read_b64_tr_b16 a[30:31], v23 offset:3296
  ds_read_b64_tr_b16 a[32:33], v23 offset:64
  ds_read_b64_tr_b16 a[34:35], v23 offset:256
  ds_read_b64_tr_b16 a[36:37], v23 offset:3136
  ds_read_b64_tr_b16 a[38:39], v23 offset:3328
  s_waitcnt lgkmcnt(0)
  s_mul_i32 s62, s5, 1179648
  s_mul_i32 s63, s57, 96
  s_add_u32 s62, s62, s63
  s_add_u32 m0, s65, 0
  s_add_u32 s63, s62, 884736
  buffer_load_dwordx4 v20, s[28:31], s63 offen lds
  s_add_u32 m0, s65, 1024
  s_add_u32 s63, s62, 884736
  buffer_load_dwordx4 v21, s[28:31], s63 offen lds
  s_add_u32 m0, s65, 2048
  s_add_u32 s63, s62, 884736
  buffer_load_dwordx4 v22, s[28:31], s63 offen lds
  s_add_u32 m0, s65, 3072
  s_add_u32 s63, s62, 921600
  buffer_load_dwordx4 v20, s[28:31], s63 offen lds
  s_add_u32 m0, s65, 4096
  s_add_u32 s63, s62, 921600
  buffer_load_dwordx4 v21, s[28:31], s63 offen lds
  s_add_u32 m0, s65, 5120
  s_add_u32 s63, s62, 921600
  buffer_load_dwordx4 v22, s[28:31], s63 offen lds
  s_waitcnt vmcnt(30)
  ds_read_b64_tr_b16 a[40:41], v23 offset:6144
  ds_read_b64_tr_b16 a[42:43], v23 offset:6336
  ds_read_b64_tr_b16 a[44:45], v23 offset:9216
  ds_read_b64_tr_b16 a[46:47], v23 offset:9408
  ds_read_b64_tr_b16 a[48:49], v23 offset:6176
  ds_read_b64_tr_b16 a[50:51], v23 offset:6368
  ds_read_b64_tr_b16 a[52:53], v23 offset:9248
  ds_read_b64_tr_b16 a[54:55], v23 offset:9440
  ds_read_b64_tr_b16 a[56:57], v23 offset:6208
  ds_read_b64_tr_b16 a[58:59], v23 offset:6400
  ds_read_b64_tr_b16 a[60:61], v23 offset:9280
  ds_read_b64_tr_b16 a[62:63], v23 offset:9472
  s_waitcnt lgkmcnt(0)
  s_mul_i32 s62, s5, 1179648
  s_mul_i32 s63, s57, 96
  s_add_u32 s62, s62, s63
  s_add_u32 m0, s65, 6144
  s_add_u32 s63, s62, 958464
  buffer_load_dwordx4 v20, s[28:31], s63 offen lds
  s_add_u32 m0, s65, 7168
  s_add_u32 s63, s62, 958464
  buffer_load_dwordx4 v21, s[28:31], s63 offen lds
  s_add_u32 m0, s65, 8192
  s_add_u32 s63, s62, 958464
  buffer_load_dwordx4 v22, s[28:31], s63 offen lds
  s_add_u32 m0, s65, 9216
  s_add_u32 s63, s62, 995328
  buffer_load_dwordx4 v20, s[28:31], s63 offen lds
  s_add_u32 m0, s65, 10240
  s_add_u32 s63, s62, 995328
  buffer_load_dwordx4 v21, s[28:31], s63 offen lds
  s_add_u32 m0, s65, 11264
  s_add_u32 s63, s62, 995328
  buffer_load_dwordx4 v22, s[28:31], s63 offen lds
  s_waitcnt vmcnt(30)
  ds_read_b64_tr_b16 a[64:65], v23 offset:12288
  ds_read_b64_tr_b16 a[66:67], v23 offset:12480
  ds_read_b64_tr_b16 a[68:69], v23 offset:15360
  ds_read_b64_tr_b16 a[70:71], v23 offset:15552
  ds_read_b64_tr_b16 a[72:73], v23 offset:12320
  ds_read_b64_tr_b16 a[74:75], v23 offset:12512
  ds_read_b64_tr_b16 a[76:77], v23 offset:15392
  ds_read_b64_tr_b16 a[78:79], v23 offset:15584
  ds_read_b64_tr_b16 a[80:81], v23 offset:12352
  ds_read_b64_tr_b16 a[82:83], v23 offset:12544
  ds_read_b64_tr_b16 a[84:85], v23 offset:15424
  ds_read_b64_tr_b16 a[86:87], v23 offset:15616
  s_waitcnt lgkmcnt(0)
  s_mul_i32 s62, s5, 1179648
  s_mul_i32 s63, s57, 96
  s_add_u32 s62, s62, s63
  s_add_u32 m0, s65, 12288
  s_add_u32 s63, s62, 1032192
  buffer_load_dwordx4 v20, s[28:31], s63 offen lds
  s_add_u32 m0, s65, 13312
  s_add_u32 s63, s62, 1032192
  buffer_load_dwordx4 v21, s[28:31], s63 offen lds
  s_add_u32 m0, s65, 14336
  s_add_u32 s63, s62, 1032192
  buffer_load_dwordx4 v22, s[28:31], s63 offen lds
  s_add_u32 m0, s65, 15360
  s_add_u32 s63, s62, 1069056
  buffer_load_dwordx4 v20, s[28:31], s63 offen lds
  s_add_u32 m0, s65, 16384
  s_add_u32 s63, s62, 1069056
  buffer_load_dwordx4 v21, s[28:31], s63 offen lds
  s_add_u32 m0, s65, 17408
  s_add_u32 s63, s62, 1069056
  buffer_load_dwordx4 v22, s[28:31], s63 offen lds
  s_waitcnt vmcnt(30)
  ds_read_b64_tr_b16 a[88:89], v23 offset:18432
  ds_read_b64_tr_b16 a[90:91], v23 offset:18624
  ds_read_b64_tr_b16 a[92:93], v23 offset:21504
  ds_read_b64_tr_b16 a[94:95], v23 offset:21696
  ds_read_b64_tr_b16 a[96:97], v23 offset:18464
  ds_read_b64_tr_b16 a[98:99], v23 offset:18656
  ds_read_b64_tr_b16 a[100:101], v23 offset:21536
  ds_read_b64_tr_b16 a[102:103], v23 offset:21728
  ds_read_b64_tr_b16 a[104:105], v23 offset:18496
  ds_read_b64_tr_b16 a[106:107], v23 offset:18688
  ds_read_b64_tr_b16 a[108:109], v23 offset:21568
  ds_read_b64_tr_b16 a[110:111], v23 offset:21760
  s_waitcnt lgkmcnt(0)
  s_mul_i32 s62, s5, 1179648
  s_mul_i32 s63, s57, 96
  s_add_u32 s62, s62, s63
  s_add_u32 m0, s65, 18432
  s_add_u32 s63, s62, 1105920
  buffer_load_dwordx4 v20, s[28:31], s63 offen lds
  s_add_u32 m0, s65, 19456
  s_add_u32 s63, s62, 1105920
  buffer_load_dwordx4 v21, s[28:31], s63 offen lds
  s_add_u32 m0, s65, 20480
  s_add_u32 s63, s62, 1105920
  buffer_load_dwordx4 v22, s[28:31], s63 offen lds
  s_add_u32 m0, s65, 21504
  s_add_u32 s63, s62, 1142784
  buffer_load_dwordx4 v20, s[28:31], s63 offen lds
  s_add_u32 m0, s65, 22528
  s_add_u32 s63, s62, 1142784
  buffer_load_dwordx4 v21, s[28:31], s63 offen lds
  s_add_u32 m0, s65, 23552
  s_add_u32 s63, s62, 1142784
  buffer_load_dwordx4 v22, s[28:31], s63 offen lds
  s_waitcnt vmcnt(30)
  ds_read_b64_tr_b16 a[112:113], v23 offset:24576
  ds_read_b64_tr_b16 a[114:115], v23 offset:24768
  ds_read_b64_tr_b16 a[116:117], v23 offset:27648
  ds_read_b64_tr_b16 a[118:119], v23 offset:27840
  ds_read_b64_tr_b16 a[120:121], v23 offset:24608
  ds_read_b64_tr_b16 a[122:123], v23 offset:24800
  ds_read_b64_tr_b16 a[124:125], v23 offset:27680
  ds_read_b64_tr_b16 a[126:127], v23 offset:27872
  ds_read_b64_tr_b16 a[128:129], v23 offset:24640
  ds_read_b64_tr_b16 a[130:131], v23 offset:24832
  ds_read_b64_tr_b16 a[132:133], v23 offset:27712
  ds_read_b64_tr_b16 a[134:135], v23 offset:27904
  s_waitcnt vmcnt(24)
  ds_read_b64_tr_b16 a[136:137], v23 offset:30720
  ds_read_b64_tr_b16 a[138:139], v23 offset:30912
  ds_read_b64_tr_b16 a[140:141], v23 offset:33792
  ds_read_b64_tr_b16 a[142:143], v23 offset:33984
  ds_read_b64_tr_b16 a[144:145], v23 offset:30752
  ds_read_b64_tr_b16 a[146:147], v23 offset:30944
  ds_read_b64_tr_b16 a[148:149], v23 offset:33824
  ds_read_b64_tr_b16 a[150:151], v23 offset:34016
  ds_read_b64_tr_b16 a[152:153], v23 offset:30784
  ds_read_b64_tr_b16 a[154:155], v23 offset:30976
  ds_read_b64_tr_b16 a[156:157], v23 offset:33856
  ds_read_b64_tr_b16 a[158:159], v23 offset:34048
  s_waitcnt vmcnt(18)
  ds_read_b64_tr_b16 a[160:161], v23 offset:0
  ds_read_b64_tr_b16 a[162:163], v23 offset:192
  ds_read_b64_tr_b16 a[164:165], v23 offset:3072
  ds_read_b64_tr_b16 a[166:167], v23 offset:3264
  ds_read_b64_tr_b16 a[168:169], v23 offset:32
  ds_read_b64_tr_b16 a[170:171], v23 offset:224
  ds_read_b64_tr_b16 a[172:173], v23 offset:3104
  ds_read_b64_tr_b16 a[174:175], v23 offset:3296
  ds_read_b64_tr_b16 a[176:177], v23 offset:64
  ds_read_b64_tr_b16 a[178:179], v23 offset:256
  ds_read_b64_tr_b16 a[180:181], v23 offset:3136
  ds_read_b64_tr_b16 a[182:183], v23 offset:3328
  s_waitcnt vmcnt(12)
  ds_read_b64_tr_b16 a[184:185], v23 offset:6144
  ds_read_b64_tr_b16 a[186:187], v23 offset:6336
  ds_read_b64_tr_b16 a[188:189], v23 offset:9216
  ds_read_b64_tr_b16 a[190:191], v23 offset:9408
  ds_read_b64_tr_b16 a[192:193], v23 offset:6176
  ds_read_b64_tr_b16 a[194:195], v23 offset:6368
  ds_read_b64_tr_b16 a[196:197], v23 offset:9248
  ds_read_b64_tr_b16 a[198:199], v23 offset:9440
  ds_read_b64_tr_b16 a[200:201], v23 offset:6208
  ds_read_b64_tr_b16 a[202:203], v23 offset:6400
  ds_read_b64_tr_b16 a[204:205], v23 offset:9280
  ds_read_b64_tr_b16 a[206:207], v23 offset:9472
  s_waitcnt vmcnt(6)
  ds_read_b64_tr_b16 a[208:209], v23 offset:12288
  ds_read_b64_tr_b16 a[210:211], v23 offset:12480
  ds_read_b64_tr_b16 a[212:213], v23 offset:15360
  ds_read_b64_tr_b16 a[214:215], v23 offset:15552
  ds_read_b64_tr_b16 a[216:217], v23 offset:12320
  ds_read_b64_tr_b16 a[218:219], v23 offset:12512
  ds_read_b64_tr_b16 a[220:221], v23 offset:15392
  ds_read_b64_tr_b16 a[222:223], v23 offset:15584
  ds_read_b64_tr_b16 a[224:225], v23 offset:12352
  ds_read_b64_tr_b16 a[226:227], v23 offset:12544
  ds_read_b64_tr_b16 a[228:229], v23 offset:15424
  ds_read_b64_tr_b16 a[230:231], v23 offset:15616
  s_waitcnt vmcnt(0)
  ds_read_b64_tr_b16 a[232:233], v23 offset:18432
  ds_read_b64_tr_b16 a[234:235], v23 offset:18624
  ds_read_b64_tr_b16 a[236:237], v23 offset:21504
  ds_read_b64_tr_b16 a[238:239], v23 offset:21696
  ds_read_b64_tr_b16 a[240:241], v23 offset:18464
  ds_read_b64_tr_b16 a[242:243], v23 offset:18656
  ds_read_b64_tr_b16 a[244:245], v23 offset:21536
  ds_read_b64_tr_b16 a[246:247], v23 offset:21728
  ds_read_b64_tr_b16 a[248:249], v23 offset:18496
  ds_read_b64_tr_b16 a[250:251], v23 offset:18688
  ds_read_b64_tr_b16 a[252:253], v23 offset:21568
  ds_read_b64_tr_b16 a[254:255], v23 offset:21760
  s_waitcnt lgkmcnt(0)
  s_mov_b32 s62, 1048576
POLLD_19:
  buffer_load_dword v17, off, s[48:51], 0 offset:64 sc1
  s_waitcnt vmcnt(0)
  v_readfirstlane_b32 s63, v17
  s_sub_u32 s62, s62, 1
  s_cbranch_scc1 POLLE_20
  s_cmp_lt_u32 s63, 32
  s_cbranch_scc1 POLLD_19
POLLE_20:
  s_mov_b32 s66, 0
WI_21:
  s_add_u32 s68, s59, 0
  s_add_u32 s69, s59, 4096
  s_add_u32 s70, s59, 8192
  s_add_u32 s71, s59, 12288
  buffer_load_dwordx4 v[8:11], v5, s[8:11], s60 offen
  buffer_load_dwordx4 v[48:51], v0, s[52:55], s68 offen offset:0 sc1
  buffer_load_dwordx4 v[52:55], v0, s[52:55], s68 offen offset:1024 sc1
  buffer_load_dwordx4 v[56:59], v0, s[52:55], s68 offen offset:2048 sc1
  buffer_load_dwordx4 v[60:63], v0, s[52:55], s68 offen offset:3072 sc1
  buffer_load_dwordx4 v[64:67], v0, s[52:55], s69 offen offset:0 sc1
  buffer_load_dwordx4 v[68:71], v0, s[52:55], s69 offen offset:1024 sc1
  buffer_load_dwordx4 v[72:75], v0, s[52:55], s69 offen offset:2048 sc1
  buffer_load_dwordx4 v[76:79], v0, s[52:55], s69 offen offset:3072 sc1
  buffer_load_dwordx4 v[80:83], v0, s[52:55], s70 offen offset:0 sc1
  buffer_load_dwordx4 v[84:87], v0, s[52:55], s70 offen offset:1024 sc1
  buffer_load_dwordx4 v[88:91], v0, s[52:55], s70 offen offset:2048 sc1
  buffer_load_dwordx4 v[92:95], v0, s[52:55], s70 offen offset:3072 sc1
  buffer_load_dwordx4 v[96:99], v0, s[52:55], s71 offen offset:0 sc1
  buffer_load_dwordx4 v[100:103], v0, s[52:55], s71 offen offset:1024 sc1
  buffer_load_dwordx4 v[104:107], v0, s[52:55], s71 offen offset:2048 sc1
  buffer_load_dwordx4 v[108:111], v0, s[52:55], s71 offen offset:3072 sc1
WR_22:
  v_mov_b64 v[16:17], 0
  v_mov_b64 v[18:19], 0
  v_mov_b64 v[20:21], 0
  v_mov_b64 v[22:23], 0
  v_mov_b64 v[24:25], 0
  v_mov_b64 v[26:27], 0
  v_mov_b32 v7, 0
  s_waitcnt vmcnt(15)
  v_smfmac_f32_16x16x64_bf16 v[16:19], v[48:51], v[128:135], v1
  v_max3_u32 v7, v48, v49, v7
  v_smfmac_f32_16x16x64_bf16 v[20:23], v[48:51], v[136:143], v1
  v_max3_u32 v7, v50, v51, v7
  v_smfmac_f32_16x16x64_bf16 v[24:27], v[48:51], v[144:151], v1
  s_waitcnt vmcnt(14)
  v_smfmac_f32_16x16x64_bf16 v[16:19], v[52:55], v[152:159], v1
  v_max3_u32 v7, v52, v53, v7
  v_smfmac_f32_16x16x64_bf16 v[20:23], v[52:55], v[160:167], v1
  v_max3_u32 v7, v54, v55, v7
  v_smfmac_f32_16x16x64_bf16 v[24:27], v[52:55], v[168:175], v1
  s_waitcnt vmcnt(13)
  v_smfmac_f32_16x16x64_bf16 v[16:19], v[56:59], v[176:183], v1
  v_max3_u32 v7, v56, v57, v7
  v_smfmac_f32_16x16x64_bf16 v[20:23], v[56:59], v[184:191], v1
  v_max3_u32 v7, v58, v59, v7
  v_smfmac_f32_16x16x64_bf16 v[24:27], v[56:59], v[192:199], v1
  s_waitcnt vmcnt(12)
  v_smfmac_f32_16x16x64_bf16 v[16:19], v[60:63], v[200:207], v1
  v_max3_u32 v7, v60, v61, v7
  v_smfmac_f32_16x16x64_bf16 v[20:23], v[60:63], v[208:215], v1
  v_max3_u32 v7, v62, v63, v7
  v_smfmac_f32_16x16x64_bf16 v[24:27], v[60:63], v[216:223], v1
  s_waitcnt vmcnt(11)
  v_smfmac_f32_16x16x64_bf16 v[16:19], v[64:67], v[224:231], v1
  v_max3_u32 v7, v64, v65, v7
  v_smfmac_f32_16x16x64_bf16 v[20:23], v[64:67], v[232:239], v1
  v_max3_u32 v7, v66, v67, v7
  v_smfmac_f32_16x16x64_bf16 v[24:27], v[64:67], v[240:247], v1
  s_waitcnt vmcnt(10)
  v_smfmac_f32_16x16x64_bf16 v[16:19], v[68:71], v[248:255], v1
  v_max3_u32 v7, v68, v69, v7
  v_smfmac_f32_16x16x64_bf16 v[20:23], v[68:71], a[0:7], v1
  v_max3_u32 v7, v70, v71, v7
  v_smfmac_f32_16x16x64_bf16 v[24:27], v[68:71], a[8:15], v1
  s_waitcnt vmcnt(9)
  v_smfmac_f32_16x16x64_bf16 v[16:19], v[72:75], a[16:23], v1
  v_max3_u32 v7, v72, v73, v7
  v_smfmac_f32_16x16x64_bf16 v[20:23], v[72:75], a[24:31], v1
  v_max3_u32 v7, v74, v75, v7
  v_smfmac_f32_16x16x64_bf16 v[24:27], v[72:75], a[32:39], v1
  s_waitcnt vmcnt(8)
  v_smfmac_f32_16x16x64_bf16 v[16:19], v[76:79], a[40:47], v1
  v_max3_u32 v7, v76, v77, v7
  v_smfmac_f32_16x16x64_bf16 v[20:23], v[76:79], a[48:55], v1
  v_max3_u32 v7, v78, v79, v7
  v_smfmac_f32_16x16x64_bf16 v[24:27], v[76:79], a[56:63], v1
  s_waitcnt vmcnt(7)
  v_smfmac_f32_16x16x64_bf16 v[16:19], v[80:83], a[64:71], v1
  v_max3_u32 v7, v80, v81, v7
  v_smfmac_f32_16x16x64_bf16 v[20:23], v[80:83], a[72:79], v1
  v_max3_u32 v7, v82, v83, v7
  v_smfmac_f32_16x16x64_bf16 v[24:27], v[80:83], a[80:87], v1
  s_waitcnt vmcnt(6)
  v_smfmac_f32_16x16x64_bf16 v[16:19], v[84:87], a[88:95], v1
  v_max3_u32 v7, v84, v85, v7
  v_smfmac_f32_16x16x64_bf16 v[20:23], v[84:87], a[96:103], v1
  v_max3_u32 v7, v86, v87, v7
  v_smfmac_f32_16x16x64_bf16 v[24:27], v[84:87], a[104:111], v1
  s_waitcnt vmcnt(5)
  v_smfmac_f32_16x16x64_bf16 v[16:19], v[88:91], a[112:119], v1
  v_max3_u32 v7, v88, v89, v7
  v_smfmac_f32_16x16x64_bf16 v[20:23], v[88:91], a[120:127], v1
  v_max3_u32 v7, v90, v91, v7
  v_smfmac_f32_16x16x64_bf16 v[24:27], v[88:91], a[128:135], v1
  s_waitcnt vmcnt(4)
  v_smfmac_f32_16x16x64_bf16 v[16:19], v[92:95], a[136:143], v1
  v_max3_u32 v7, v92, v93, v7
  v_smfmac_f32_16x16x64_bf16 v[20:23], v[92:95], a[144:151], v1
  v_max3_u32 v7, v94, v95, v7
  v_smfmac_f32_16x16x64_bf16 v[24:27], v[92:95], a[152:159], v1
  s_waitcnt vmcnt(3)
  v_smfmac_f32_16x16x64_bf16 v[16:19], v[96:99], a[160:167], v1
  v_max3_u32 v7, v96, v97, v7
  v_smfmac_f32_16x16x64_bf16 v[20:23], v[96:99], a[168:175], v1
  v_max3_u32 v7, v98, v99, v7
  v_smfmac_f32_16x16x64_bf16 v[24:27], v[96:99], a[176:183], v1
  s_waitcnt vmcnt(2)
  v_smfmac_f32_16x16x64_bf16 v[16:19], v[100:103], a[184:191], v1
  v_max3_u32 v7, v100, v101, v7
  v_smfmac_f32_16x16x64_bf16 v[20:23], v[100:103], a[192:199], v1
  v_max3_u32 v7, v102, v103, v7
  v_smfmac_f32_16x16x64_bf16 v[24:27], v[100:103], a[200:207], v1
  s_waitcnt vmcnt(1)
  v_smfmac_f32_16x16x64_bf16 v[16:19], v[104:107], a[208:215], v1
  v_max3_u32 v7, v104, v105, v7
  v_smfmac_f32_16x16x64_bf16 v[20:23], v[104:107], a[216:223], v1
  v_max3_u32 v7, v106, v107, v7
  v_smfmac_f32_16x16x64_bf16 v[24:27], v[104:107], a[224:231], v1
  s_waitcnt vmcnt(0)
  v_smfmac_f32_16x16x64_bf16 v[16:19], v[108:111], a[232:239], v1
  v_max3_u32 v7, v108, v109, v7
  v_smfmac_f32_16x16x64_bf16 v[20:23], v[108:111], a[240:247], v1
  v_max3_u32 v7, v110, v111, v7
  v_smfmac_f32_16x16x64_bf16 v[24:27], v[108:111], a[248:255], v1
  v_cmp_eq_u32 vcc, -1, v7
  s_sub_i32 s64, s64, 1
  s_cmp_lt_i32 s64, 0
  s_cbranch_scc1 WK_23
  s_cbranch_vccnz WI_21
WK_23:
  v_mov_b64 v[12:13], v[8:9]
  v_mov_b64 v[14:15], v[10:11]
  s_add_u32 s59, s59, 262144
  s_add_u32 s60, s60, 36864
  s_add_u32 s68, s59, 0
  s_add_u32 s69, s59, 4096
  s_add_u32 s70, s59, 8192
  s_add_u32 s71, s59, 12288
  buffer_load_dwordx4 v[8:11], v5, s[8:11], s60 offen
  buffer_load_dwordx4 v[48:51], v0, s[52:55], s68 offen offset:0 sc1
  buffer_load_dwordx4 v[52:55], v0, s[52:55], s68 offen offset:1024 sc1
  buffer_load_dwordx4 v[56:59], v0, s[52:55], s68 offen offset:2048 sc1
  buffer_load_dwordx4 v[60:63], v0, s[52:55], s68 offen offset:3072 sc1
  buffer_load_dwordx4 v[64:67], v0, s[52:55], s69 offen offset:0 sc1
  buffer_load_dwordx4 v[68:71], v0, s[52:55], s69 offen offset:1024 sc1
  buffer_load_dwordx4 v[72:75], v0, s[52:55], s69 offen offset:2048 sc1
  buffer_load_dwordx4 v[76:79], v0, s[52:55], s69 offen offset:3072 sc1
  buffer_load_dwordx4 v[80:83], v0, s[52:55], s70 offen offset:0 sc1
  buffer_load_dwordx4 v[84:87], v0, s[52:55], s70 offen offset:1024 sc1
  buffer_load_dwordx4 v[88:91], v0, s[52:55], s70 offen offset:2048 sc1
  buffer_load_dwordx4 v[92:95], v0, s[52:55], s70 offen offset:3072 sc1
  buffer_load_dwordx4 v[96:99], v0, s[52:55], s71 offen offset:0 sc1
  buffer_load_dwordx4 v[100:103], v0, s[52:55], s71 offen offset:1024 sc1
  buffer_load_dwordx4 v[104:107], v0, s[52:55], s71 offen offset:2048 sc1
  buffer_load_dwordx4 v[108:111], v0, s[52:55], s71 offen offset:3072 sc1
  v_permlane32_swap_b32 v16, v20
  v_permlane32_swap_b32 v17, v21
  v_permlane32_swap_b32 v18, v22
  v_permlane32_swap_b32 v19, v23
  v_permlane32_swap_b32 v24, v25
  v_permlane32_swap_b32 v26, v27
  v_add_u32 v28, s66, v2
  v_add_u32 v29, s66, v3
  v_add_f32 v16, v16, v20
  v_add_f32 v17, v17, v21
  v_add_f32 v18, v18, v22
  v_add_f32 v19, v19, v23
  v_add_f32 v24, v24, v25
  v_add_f32 v26, v26, v27
  ds_write2_b32 v28, v16, v17 offset0:0 offset1:52
  ds_write2_b32 v28, v18, v19 offset0:104 offset1:156
  ds_write2_b32 v29, v24, v26 offset0:0 offset1:104
  s_waitcnt lgkmcnt(0)
  s_barrier
  s_cmp_lg_u32 s5, 0
  s_cbranch_scc1 WN_24
  v_add_u32 v7, s66, v4
  ds_read_b128 v[16:19], v7
  ds_read_b128 v[20:23], v7 offset:16
  ds_read_b128 v[24:27], v7 offset:40960
  ds_read_b128 v[28:31], v7 offset:40976
  v_add_u32 v7, 81920, v7
  ds_read_b128 v[32:35], v7
  ds_read_b128 v[36:39], v7 offset:16
  ds_read_b128 v[40:43], v7 offset:40960
  ds_read_b128 v[44:47], v7 offset:40976
  s_waitcnt lgkmcnt(5)
  v_pk_add_f32 v[16:17], v[16:17], v[24:25]
  v_pk_add_f32 v[18:19], v[18:19], v[26:27]
  s_waitcnt lgkmcnt(4)
  v_pk_add_f32 v[20:21], v[20:21], v[28:29]
  v_pk_add_f32 v[22:23], v[22:23], v[30:31]
  v_lshlrev_b32 v24, 16, v12
  v_and_b32 v25, 0xffff0000, v12
  v_lshlrev_b32 v26, 16, v13
  v_and_b32 v27, 0xffff0000, v13
  v_lshlrev_b32 v28, 16, v14
  v_and_b32 v29, 0xffff0000, v14
  v_lshlrev_b32 v30, 16, v15
  v_and_b32 v31, 0xffff0000, v15
  v_pk_add_f32 v[16:17], v[16:17], v[24:25]
  v_pk_add_f32 v[18:19], v[18:19], v[26:27]
  v_pk_add_f32 v[20:21], v[20:21], v[28:29]
  v_pk_add_f32 v[22:23], v[22:23], v[30:31]
  s_waitcnt lgkmcnt(1)
  v_pk_add_f32 v[32:33], v[32:33], v[40:41]
  v_pk_add_f32 v[34:35], v[34:35], v[42:43]
  s_waitcnt lgkmcnt(0)
  v_pk_add_f32 v[36:37], v[36:37], v[44:45]
  v_pk_add_f32 v[38:39], v[38:39], v[46:47]
  v_pk_add_f32 v[16:17], v[16:17], v[32:33]
  v_cvt_pk_bf16_f32 v12, v16, v17
  v_pk_add_f32 v[18:19], v[18:19], v[34:35]
  v_cvt_pk_bf16_f32 v13, v18, v19
  v_pk_add_f32 v[20:21], v[20:21], v[36:37]
  v_cvt_pk_bf16_f32 v14, v20, v21
  v_pk_add_f32 v[22:23], v[22:23], v[38:39]
  v_cvt_pk_bf16_f32 v15, v22, v23
  s_waitcnt vmcnt(17)
  buffer_store_dwordx4 v[12:15], v6, s[52:55], s61 offen sc1
  v_mov_b64 v[32:33], 0
  s_mov_b32 exec_hi, 0xffff
  v_dot2_f32_bf16 v32, v12, s74, v32
  v_dot2_f32_bf16 v33, v12, v12, v33
  v_dot2_f32_bf16 v32, v13, s74, v32
  v_dot2_f32_bf16 v33, v13, v13, v33
  v_dot2_f32_bf16 v32, v14, s74, v32
  v_dot2_f32_bf16 v33, v14, v14, v33
  v_dot2_f32_bf16 v32, v15, s74, v32
  v_dot2_f32_bf16 v33, v15, v15, v33
  s_mov_b32 exec_hi, -1
  v_mov_b64 v[24:25], -1
  v_mov_b64 v[26:27], -1
  v_permlane32_swap_b32 v32, v33
  v_add_f32 v32, v32, v33
  s_add_u32 s62, s61, 81920
  v_mov_b32 v33, v32
  s_nop 1
  v_permlane16_swap_b32 v32, v33
  v_add_f32 v32, v32, v33
  s_add_u32 s63, s73, 81920
  s_nop 0
  v_add_f32_dpp v32, v32, v32 row_ror:8 row_mask:0xf bank_mask:0xf
  buffer_store_dword v32, v112, s[52:55], s73 offen sc1
  buffer_store_dwordx4 v[24:27], v6, s[52:55], s62 offen sc1
  buffer_store_dword v24, v112, s[52:55], s63 offen sc1
  s_add_u32 s73, s73, 40960
WN_24:
  s_add_u32 s61, s61, 40960
  s_xor_b32 s66, s66, 2048
  s_add_u32 s58, s58, 1
  s_cmp_lt_u32 s58, 64
  s_cbranch_scc1 WR_22
  s_waitcnt vmcnt(0)
  s_endpgm
R_A:
  s_mov_b32 s56, s7
  s_lshl_b32 s66, s5, 18
  s_lshl_b32 s58, s56, 13
  s_add_u32 s58, s58, s66
  s_add_u32 s59, s58, 92274688
  s_add_u32 s58, s58, 0
  s_lshl_b32 s60, s56, 11
  s_add_u32 s60, s60, s66
  s_add_u32 s60, s60, 50331648
  s_lshl_b32 s61, s56, 7
  s_add_u32 s61, s61, 112197632
  s_mov_b32 s65, 0x3e0293ee
  s_mov_b32 s68, 131072
  s_mov_b32 s57, s5
  s_mov_b32 s62, 0
  s_mov_b32 s63, 0
  v_lshrrev_b32 v7, 5, v0
  v_bfe_u32 v8, v0, 3, 2
  v_lshlrev_b32 v5, 16, v8
  v_lshl_add_u32 v5, v7, 7, v5
  v_and_b32 v8, 7, v0
  v_lshl_add_u32 v5, v8, 4, v5
  v_mov_b32 v200, -1
  v_mov_b32 v201, -1
  v_mov_b32 v202, -1
  v_mov_b32 v203, -1
  v_lshrrev_b32 v9, 3, v0
  v_mul_u32_u24 v9, 1152, v9
  v_lshl_add_u32 v9, v8, 4, v9
  s_lshl_b32 s64, s56, 2
  s_add_u32 s64, s64, s5
  s_mul_i32 s66, s64, 18432
  s_add_u32 s67, s66, 9216
  buffer_load_dwordx4 v[32:35], v9, s[8:11], s66 offen offset:0
  buffer_load_dwordx4 v[36:39], v9, s[8:11], s66 offen offset:128
  buffer_load_dwordx4 v[40:43], v9, s[8:11], s66 offen offset:256
  buffer_load_dwordx4 v[44:47], v9, s[8:11], s66 offen offset:384
  buffer_load_dwordx4 v[48:51], v9, s[8:11], s66 offen offset:512
  buffer_load_dwordx4 v[52:55], v9, s[8:11], s66 offen offset:640
  buffer_load_dwordx4 v[56:59], v9, s[8:11], s66 offen offset:768
  buffer_load_dwordx4 v[60:63], v9, s[8:11], s66 offen offset:896
  buffer_load_dwordx4 v[64:67], v9, s[8:11], s66 offen offset:1024
  buffer_load_dwordx4 v[68:71], v9, s[8:11], s67 offen offset:0
  buffer_load_dwordx4 v[72:75], v9, s[8:11], s67 offen offset:128
  buffer_load_dwordx4 v[76:79], v9, s[8:11], s67 offen offset:256
  buffer_load_dwordx4 v[80:83], v9, s[8:11], s67 offen offset:384
  buffer_load_dwordx4 v[84:87], v9, s[8:11], s67 offen offset:512
  buffer_load_dwordx4 v[88:91], v9, s[8:11], s67 offen offset:640
  buffer_load_dwordx4 v[92:95], v9, s[8:11], s67 offen offset:768
  buffer_load_dwordx4 v[96:99], v9, s[8:11], s67 offen offset:896
  buffer_load_dwordx4 v[100:103], v9, s[8:11], s67 offen offset:1024
  v_mov_b64 v[104:105], 0
  v_mov_b64 v[106:107], 0
  buffer_store_dwordx4 v[104:107], off, s[52:55], s61 sc1
  v_lshlrev_b32 v9, 4, v0
  s_lshl_b32 s67, s64, 10
  s_add_u32 s66, s67, 110100480
  buffer_store_dwordx4 v[200:203], v9, s[52:55], s66 offen sc1
  s_add_u32 s66, s67, 110231552
  buffer_store_dwordx4 v[200:203], v9, s[52:55], s66 offen sc1
  s_add_u32 s66, s67, 110362624
  buffer_store_dwordx4 v[200:203], v9, s[52:55], s66 offen sc1
  s_add_u32 s66, s67, 110624768
  buffer_store_dwordx4 v[200:203], v9, s[52:55], s66 offen sc1
  s_add_u32 s66, s67, 110755840
  buffer_store_dwordx4 v[200:203], v9, s[52:55], s66 offen sc1
  s_add_u32 s66, s67, 110886912
  buffer_store_dwordx4 v[200:203], v9, s[52:55], s66 offen sc1
  s_add_u32 s66, s67, 109051904
  buffer_store_dwordx4 v[200:203], v9, s[52:55], s66 offen sc1
  s_add_u32 s66, s67, 88080384
  buffer_store_dwordx4 v[200:203], v9, s[52:55], s66 offen sc1
  s_add_u32 s66, s67, 68157440
  buffer_store_dwordx4 v[200:203], v9, s[52:55], s66 offen sc1
  s_add_u32 s66, s67, 68288512
  buffer_store_dwordx4 v[200:203], v9, s[52:55], s66 offen sc1
  s_add_u32 s66, s67, 68419584
  buffer_store_dwordx4 v[200:203], v9, s[52:55], s66 offen sc1
  s_add_u32 s66, s67, 68550656
  buffer_store_dwordx4 v[200:203], v9, s[52:55], s66 offen sc1
  s_add_u32 s66, s67, 68681728
  buffer_store_dwordx4 v[200:203], v9, s[52:55], s66 offen sc1
  buffer_store_dwordx4 v[200:203], v5, s[52:55], s60 offen offset:0 sc1
  buffer_store_dwordx4 v[200:203], v5, s[52:55], s60 offen offset:256 sc1
  buffer_store_dwordx4 v[200:203], v5, s[52:55], s60 offen offset:512 sc1
  buffer_store_dwordx4 v[200:203], v5, s[52:55], s60 offen offset:768 sc1
  buffer_store_dwordx4 v[200:203], v5, s[52:55], s60 offen offset:1024 sc1
  buffer_store_dwordx4 v[200:203], v5, s[52:55], s60 offen offset:1280 sc1
  buffer_store_dwordx4 v[200:203], v5, s[52:55], s60 offen offset:1536 sc1
  buffer_store_dwordx4 v[200:203], v5, s[52:55], s60 offen offset:1792 sc1
  s_lshl_b32 s66, s56, 13
  s_lshl_b32 s67, s5, 11
  s_add_u32 s66, s66, s67
  s_add_u32 s67, s66, 107479040
  buffer_store_dwordx4 v[200:203], v9, s[52:55], s67 offen offset:0 sc1
  buffer_store_dwordx4 v[200:203], v9, s[52:55], s67 offen offset:1024 sc1
  s_add_u32 s67, s66, 107741184
  buffer_store_dwordx4 v[200:203], v9, s[52:55], s67 offen offset:0 sc1
  buffer_store_dwordx4 v[200:203], v9, s[52:55], s67 offen offset:1024 sc1
  s_add_u32 s67, s66, 108003328
  buffer_store_dwordx4 v[200:203], v9, s[52:55], s67 offen offset:0 sc1
  buffer_store_dwordx4 v[200:203], v9, s[52:55], s67 offen offset:1024 sc1
  s_add_u32 s67, s66, 108265472
  buffer_store_dwordx4 v[200:203], v9, s[52:55], s67 offen offset:0 sc1
  buffer_store_dwordx4 v[200:203], v9, s[52:55], s67 offen offset:1024 sc1
  s_add_u32 s67, s66, 108527616
  buffer_store_dwordx4 v[200:203], v9, s[52:55], s67 offen offset:0 sc1
  buffer_store_dwordx4 v[200:203], v9, s[52:55], s67 offen offset:1024 sc1
  s_add_u32 s67, s66, 108789760
  buffer_store_dwordx4 v[200:203], v9, s[52:55], s67 offen offset:0 sc1
  buffer_store_dwordx4 v[200:203], v9, s[52:55], s67 offen offset:1024 sc1
  s_mov_b32 s66, 0x3f803f80
  s_waitcnt vmcnt(51)
  v_dot2_f32_bf16 v104, v32, s66, v104
  v_dot2_f32_bf16 v105, v32, v32, v105
  s_waitcnt vmcnt(42)
  v_dot2_f32_bf16 v106, v68, s66, v106
  v_dot2_f32_bf16 v107, v68, v68, v107
  v_dot2_f32_bf16 v104, v33, s66, v104
  v_dot2_f32_bf16 v105, v33, v33, v105
  v_dot2_f32_bf16 v106, v69, s66, v106
  v_dot2_f32_bf16 v107, v69, v69, v107
  v_dot2_f32_bf16 v104, v34, s66, v104
  v_dot2_f32_bf16 v105, v34, v34, v105
  v_dot2_f32_bf16 v106, v70, s66, v106
  v_dot2_f32_bf16 v107, v70, v70, v107
  v_dot2_f32_bf16 v104, v35, s66, v104
  v_dot2_f32_bf16 v105, v35, v35, v105
  v_dot2_f32_bf16 v106, v71, s66, v106
  v_dot2_f32_bf16 v107, v71, v71, v107
  v_dot2_f32_bf16 v104, v36, s66, v104
  v_dot2_f32_bf16 v105, v36, v36, v105
  s_waitcnt vmcnt(41)
  v_dot2_f32_bf16 v106, v72, s66, v106
  v_dot2_f32_bf16 v107, v72, v72, v107
  v_dot2_f32_bf16 v104, v37, s66, v104
  v_dot2_f32_bf16 v105, v37, v37, v105
  v_dot2_f32_bf16 v106, v73, s66, v106
  v_dot2_f32_bf16 v107, v73, v73, v107
  v_dot2_f32_bf16 v104, v38, s66, v104
  v_dot2_f32_bf16 v105, v38, v38, v105
  v_dot2_f32_bf16 v106, v74, s66, v106
  v_dot2_f32_bf16 v107, v74, v74, v107
  v_dot2_f32_bf16 v104, v39, s66, v104
  v_dot2_f32_bf16 v105, v39, v39, v105
  v_dot2_f32_bf16 v106, v75, s66, v106
  v_dot2_f32_bf16 v107, v75, v75, v107
  v_dot2_f32_bf16 v104, v40, s66, v104
  v_dot2_f32_bf16 v105, v40, v40, v105
  s_waitcnt vmcnt(40)
  v_dot2_f32_bf16 v106, v76, s66, v106
  v_dot2_f32_bf16 v107, v76, v76, v107
  v_dot2_f32_bf16 v104, v41, s66, v104
  v_dot2_f32_bf16 v105, v41, v41, v105
  v_dot2_f32_bf16 v106, v77, s66, v106
  v_dot2_f32_bf16 v107, v77, v77, v107
  v_dot2_f32_bf16 v104, v42, s66, v104
  v_dot2_f32_bf16 v105, v42, v42, v105
  v_dot2_f32_bf16 v106, v78, s66, v106
  v_dot2_f32_bf16 v107, v78, v78, v107
  v_dot2_f32_bf16 v104, v43, s66, v104
  v_dot2_f32_bf16 v105, v43, v43, v105
  v_dot2_f32_bf16 v106, v79, s66, v106
  v_dot2_f32_bf16 v107, v79, v79, v107
  v_dot2_f32_bf16 v104, v44, s66, v104
  v_dot2_f32_bf16 v105, v44, v44, v105
  s_waitcnt vmcnt(39)
  v_dot2_f32_bf16 v106, v80, s66, v106
  v_dot2_f32_bf16 v107, v80, v80, v107
  v_dot2_f32_bf16 v104, v45, s66, v104
  v_dot2_f32_bf16 v105, v45, v45, v105
  v_dot2_f32_bf16 v106, v81, s66, v106
  v_dot2_f32_bf16 v107, v81, v81, v107
  v_dot2_f32_bf16 v104, v46, s66, v104
  v_dot2_f32_bf16 v105, v46, v46, v105
  v_dot2_f32_bf16 v106, v82, s66, v106
  v_dot2_f32_bf16 v107, v82, v82, v107
  v_dot2_f32_bf16 v104, v47, s66, v104
  v_dot2_f32_bf16 v105, v47, v47, v105
  v_dot2_f32_bf16 v106, v83, s66, v106
  v_dot2_f32_bf16 v107, v83, v83, v107
  v_dot2_f32_bf16 v104, v48, s66, v104
  v_dot2_f32_bf16 v105, v48, v48, v105
  s_waitcnt vmcnt(38)
  v_dot2_f32_bf16 v106, v84, s66, v106
  v_dot2_f32_bf16 v107, v84, v84, v107
  v_dot2_f32_bf16 v104, v49, s66, v104
  v_dot2_f32_bf16 v105, v49, v49, v105
  v_dot2_f32_bf16 v106, v85, s66, v106
  v_dot2_f32_bf16 v107, v85, v85, v107
  v_dot2_f32_bf16 v104, v50, s66, v104
  v_dot2_f32_bf16 v105, v50, v50, v105
  v_dot2_f32_bf16 v106, v86, s66, v106
  v_dot2_f32_bf16 v107, v86, v86, v107
  v_dot2_f32_bf16 v104, v51, s66, v104
  v_dot2_f32_bf16 v105, v51, v51, v105
  v_dot2_f32_bf16 v106, v87, s66, v106
  v_dot2_f32_bf16 v107, v87, v87, v107
  v_dot2_f32_bf16 v104, v52, s66, v104
  v_dot2_f32_bf16 v105, v52, v52, v105
  s_waitcnt vmcnt(37)
  v_dot2_f32_bf16 v106, v88, s66, v106
  v_dot2_f32_bf16 v107, v88, v88, v107
  v_dot2_f32_bf16 v104, v53, s66, v104
  v_dot2_f32_bf16 v105, v53, v53, v105
  v_dot2_f32_bf16 v106, v89, s66, v106
  v_dot2_f32_bf16 v107, v89, v89, v107
  v_dot2_f32_bf16 v104, v54, s66, v104
  v_dot2_f32_bf16 v105, v54, v54, v105
  v_dot2_f32_bf16 v106, v90, s66, v106
  v_dot2_f32_bf16 v107, v90, v90, v107
  v_dot2_f32_bf16 v104, v55, s66, v104
  v_dot2_f32_bf16 v105, v55, v55, v105
  v_dot2_f32_bf16 v106, v91, s66, v106
  v_dot2_f32_bf16 v107, v91, v91, v107
  v_dot2_f32_bf16 v104, v56, s66, v104
  v_dot2_f32_bf16 v105, v56, v56, v105
  s_waitcnt vmcnt(36)
  v_dot2_f32_bf16 v106, v92, s66, v106
  v_dot2_f32_bf16 v107, v92, v92, v107
  v_dot2_f32_bf16 v104, v57, s66, v104
  v_dot2_f32_bf16 v105, v57, v57, v105
  v_dot2_f32_bf16 v106, v93, s66, v106
  v_dot2_f32_bf16 v107, v93, v93, v107
  v_dot2_f32_bf16 v104, v58, s66, v104
  v_dot2_f32_bf16 v105, v58, v58, v105
  v_dot2_f32_bf16 v106, v94, s66, v106
  v_dot2_f32_bf16 v107, v94, v94, v107
  v_dot2_f32_bf16 v104, v59, s66, v104
  v_dot2_f32_bf16 v105, v59, v59, v105
  v_dot2_f32_bf16 v106, v95, s66, v106
  v_dot2_f32_bf16 v107, v95, v95, v107
  v_dot2_f32_bf16 v104, v60, s66, v104
  v_dot2_f32_bf16 v105, v60, v60, v105
  s_waitcnt vmcnt(35)
  v_dot2_f32_bf16 v106, v96, s66, v106
  v_dot2_f32_bf16 v107, v96, v96, v107
  v_dot2_f32_bf16 v104, v61, s66, v104
  v_dot2_f32_bf16 v105, v61, v61, v105
  v_dot2_f32_bf16 v106, v97, s66, v106
  v_dot2_f32_bf16 v107, v97, v97, v107
  v_dot2_f32_bf16 v104, v62, s66, v104
  v_dot2_f32_bf16 v105, v62, v62, v105
  v_dot2_f32_bf16 v106, v98, s66, v106
  v_dot2_f32_bf16 v107, v98, v98, v107
  v_dot2_f32_bf16 v104, v63, s66, v104
  v_dot2_f32_bf16 v105, v63, v63, v105
  v_dot2_f32_bf16 v106, v99, s66, v106
  v_dot2_f32_bf16 v107, v99, v99, v107
  v_dot2_f32_bf16 v104, v64, s66, v104
  v_dot2_f32_bf16 v105, v64, v64, v105
  s_waitcnt vmcnt(34)
  v_dot2_f32_bf16 v106, v100, s66, v106
  v_dot2_f32_bf16 v107, v100, v100, v107
  v_dot2_f32_bf16 v104, v65, s66, v104
  v_dot2_f32_bf16 v105, v65, v65, v105
  v_dot2_f32_bf16 v106, v101, s66, v106
  v_dot2_f32_bf16 v107, v101, v101, v107
  v_dot2_f32_bf16 v104, v66, s66, v104
  v_dot2_f32_bf16 v105, v66, v66, v105
  v_dot2_f32_bf16 v106, v102, s66, v106
  v_dot2_f32_bf16 v107, v102, v102, v107
  v_dot2_f32_bf16 v104, v67, s66, v104
  v_dot2_f32_bf16 v105, v67, v67, v105
  v_dot2_f32_bf16 v106, v103, s66, v106
  v_dot2_f32_bf16 v107, v103, v103, v107
  v_add_f32_dpp v104, v104, v104 quad_perm:[1,0,3,2] row_mask:0xf bank_mask:0xf
  v_add_f32_dpp v105, v105, v105 quad_perm:[1,0,3,2] row_mask:0xf bank_mask:0xf
  v_add_f32_dpp v106, v106, v106 quad_perm:[1,0,3,2] row_mask:0xf bank_mask:0xf
  v_add_f32_dpp v107, v107, v107 quad_perm:[1,0,3,2] row_mask:0xf bank_mask:0xf
  v_add_f32_dpp v104, v104, v104 quad_perm:[2,3,0,1] row_mask:0xf bank_mask:0xf
  v_add_f32_dpp v105, v105, v105 quad_perm:[2,3,0,1] row_mask:0xf bank_mask:0xf
  v_add_f32_dpp v106, v106, v106 quad_perm:[2,3,0,1] row_mask:0xf bank_mask:0xf
  v_add_f32_dpp v107, v107, v107 quad_perm:[2,3,0,1] row_mask:0xf bank_mask:0xf
  v_add_f32_dpp v104, v104, v104 row_half_mirror row_mask:0xf bank_mask:0xf
  v_add_f32_dpp v105, v105, v105 row_half_mirror row_mask:0xf bank_mask:0xf
  v_add_f32_dpp v106, v106, v106 row_half_mirror row_mask:0xf bank_mask:0xf
  v_add_f32_dpp v107, v107, v107 row_half_mirror row_mask:0xf bank_mask:0xf
  v_and_b32 v9, 2, v0
  v_cmp_eq_u32 vcc, 0, v9
  s_nop 1
  v_cndmask_b32 v104, v106, v104, vcc
  v_cndmask_b32 v105, v107, v105, vcc
  v_mul_f32 v104, 0x3ae38e39, v104
  v_mul_f32 v105, 0x3ae38e39, v105
  v_fma_f32 v105, -v104, v104, v105
  v_max_f32 v105, 0, v105
  v_add_f32 v105, 0x3727c5ac, v105
  v_rsq_f32 v105, v105
  v_lshlrev_b32 v106, 4, v9
  v_lshrrev_b32 v9, 3, v0
  v_lshl_add_u32 v106, v9, 2, v106
  v_and_b32 v9, 1, v0
  v_cmp_eq_u32 vcc, 0, v9
  s_nop 1
  v_cndmask_b32 v104, v105, v104, vcc
  v_lshl_add_u32 v106, v9, 7, v106
  s_lshr_b32 s66, s64, 1
  s_lshl_b32 s66, s66, 8
  s_and_b32 s67, s64, 1
  s_lshl_b32 s67, s67, 6
  s_add_u32 s66, s66, s67
  s_add_u32 s66, s66, 113246208
  buffer_store_dword v104, v106, s[52:55], s66 offen sc1
  v_lshlrev_b32 v3, 8, v7
  v_lshl_add_u32 v3, v8, 4, v3
  v_bfe_u32 v9, v0, 3, 1
  v_lshl_add_u32 v1, v9, 10, v3
  v_bfe_u32 v9, v0, 4, 1
  v_lshl_add_u32 v1, v9, 7, v1
  v_bfe_u32 v8, v0, 3, 2
  v_and_b32 v9, 3, v0
  v_lshl_add_u32 v8, v8, 2, v9
  v_lshlrev_b32 v8, 4, v8
  v_lshl_add_u32 v8, v7, 8, v8
  v_bfe_u32 v9, v0, 2, 1
  v_lshl_add_u32 v2, v9, 10, v8
  v_lshl_add_u32 v4, v9, 3, v8
  v_and_b32 v8, 31, v0
  v_lshlrev_b32 v9, 2, v7
  v_sub_u32 v8, v8, v9
  v_mov_b32 v9, 0xf149f2ca
  v_cmp_le_i32 vcc, 0, v8
  s_nop 1
  v_cndmask_b32_e64 v64, v9, 0, vcc
  v_cmp_le_i32 vcc, 1, v8
  s_nop 1
  v_cndmask_b32_e64 v65, v9, 0, vcc
  v_cmp_le_i32 vcc, 2, v8
  s_nop 1
  v_cndmask_b32_e64 v66, v9, 0, vcc
  v_cmp_le_i32 vcc, 3, v8
  s_nop 1
  v_cndmask_b32_e64 v67, v9, 0, vcc
  v_cmp_le_i32 vcc, 8, v8
  s_nop 1
  v_cndmask_b32_e64 v68, v9, 0, vcc
  v_cmp_le_i32 vcc, 9, v8
  s_nop 1
  v_cndmask_b32_e64 v69, v9, 0, vcc
  v_cmp_le_i32 vcc, 10, v8
  s_nop 1
  v_cndmask_b32_e64 v70, v9, 0, vcc
  v_cmp_le_i32 vcc, 11, v8
  s_nop 1
  v_cndmask_b32_e64 v71, v9, 0, vcc
  v_cmp_le_i32 vcc, 16, v8
  s_nop 1
  v_cndmask_b32_e64 v72, v9, 0, vcc
  v_cmp_le_i32 vcc, 17, v8
  s_nop 1
  v_cndmask_b32_e64 v73, v9, 0, vcc
  v_cmp_le_i32 vcc, 18, v8
  s_nop 1
  v_cndmask_b32_e64 v74, v9, 0, vcc
  v_cmp_le_i32 vcc, 19, v8
  s_nop 1
  v_cndmask_b32_e64 v75, v9, 0, vcc
  v_cmp_le_i32 vcc, 24, v8
  s_nop 1
  v_cndmask_b32_e64 v76, v9, 0, vcc
  v_cmp_le_i32 vcc, 25, v8
  s_nop 1
  v_cndmask_b32_e64 v77, v9, 0, vcc
  v_cmp_le_i32 vcc, 26, v8
  s_nop 1
  v_cndmask_b32_e64 v78, v9, 0, vcc
  v_cmp_le_i32 vcc, 27, v8
  s_nop 1
  v_cndmask_b32_e64 v79, v9, 0, vcc
  s_waitcnt vmcnt(0)
  s_barrier
  s_cmp_lg_u32 s5, 0
  s_cbranch_scc1 ID_25
  s_mov_b64 exec, 1
  v_mov_b32 v7, 1
  buffer_atomic_add v7, off, s[48:51], 0 offset:64 sc1
  s_mov_b64 exec, -1
ID_25:
  s_mov_b32 s66, 1048576
POLLD_26:
  buffer_load_dword v7, off, s[48:51], 0 offset:64 sc1
  s_waitcnt vmcnt(0)
  v_readfirstlane_b32 s67, v7
  s_sub_u32 s66, s66, 1
  s_cbranch_scc1 POLLE_27
  s_cmp_lt_u32 s67, 32
  s_cbranch_scc1 POLLD_26
POLLE_27:
AT_28:
  s_add_u32 s69, s60, 0x100000
  s_cmp_lt_u32 s57, 60
  s_cselect_b32 s69, s69, 0x10000000
  buffer_store_dwordx4 v[200:203], v5, s[52:55], s69 offen offset:0 sc1
  buffer_store_dwordx4 v[200:203], v5, s[52:55], s69 offen offset:256 sc1
  buffer_store_dwordx4 v[200:203], v5, s[52:55], s69 offen offset:512 sc1
  buffer_store_dwordx4 v[200:203], v5, s[52:55], s69 offen offset:768 sc1
  buffer_store_dwordx4 v[200:203], v5, s[52:55], s69 offen offset:1024 sc1
  buffer_store_dwordx4 v[200:203], v5, s[52:55], s69 offen offset:1280 sc1
  buffer_store_dwordx4 v[200:203], v5, s[52:55], s69 offen offset:1536 sc1
  buffer_store_dwordx4 v[200:203], v5, s[52:55], s69 offen offset:1792 sc1
  s_add_u32 s66, s57, 1
  s_min_u32 s66, s66, 64
AP_31:
  s_cmp_ge_u32 s62, s66
  s_cbranch_scc1 AO_32
  buffer_load_dwordx4 v[16:19], off, s[52:55], s61 sc1
  s_waitcnt vmcnt(0)
  v_min_u32 v16, v16, v17
  v_readfirstlane_b32 s63, v18
  v_readfirstlane_b32 s62, v16
  s_sub_i32 s68, s68, 1
  s_cmp_ge_i32 s68, 0
  s_cbranch_scc1 AP_31
AO_32:
  s_add_u32 s66, s58, 16777216
  s_add_u32 s67, s58, 16781312
  buffer_load_dwordx4 a[32:35], v1, s[52:55], s66 offen offset:0 sc1
  buffer_load_dwordx4 a[36:39], v1, s[52:55], s66 offen offset:512 sc1
  buffer_load_dwordx4 a[40:43], v1, s[52:55], s66 offen offset:2048 sc1
  buffer_load_dwordx4 a[44:47], v1, s[52:55], s66 offen offset:2560 sc1
  buffer_load_dwordx4 a[48:51], v1, s[52:55], s67 offen offset:0 sc1
  buffer_load_dwordx4 a[52:55], v1, s[52:55], s67 offen offset:512 sc1
  buffer_load_dwordx4 a[56:59], v1, s[52:55], s67 offen offset:2048 sc1
  buffer_load_dwordx4 a[60:63], v1, s[52:55], s67 offen offset:2560 sc1
  s_add_u32 s66, s58, 0
  s_add_u32 s67, s58, 4096
  buffer_load_dwordx4 a[0:3], v1, s[52:55], s66 offen offset:0 sc1
  buffer_load_dwordx4 a[4:7], v1, s[52:55], s66 offen offset:512 sc1
  buffer_load_dwordx4 a[8:11], v1, s[52:55], s66 offen offset:2048 sc1
  buffer_load_dwordx4 a[12:15], v1, s[52:55], s66 offen offset:2560 sc1
  buffer_load_dwordx4 a[16:19], v1, s[52:55], s67 offen offset:0 sc1
  buffer_load_dwordx4 a[20:23], v1, s[52:55], s67 offen offset:512 sc1
  buffer_load_dwordx4 a[24:27], v1, s[52:55], s67 offen offset:2048 sc1
  buffer_load_dwordx4 a[28:31], v1, s[52:55], s67 offen offset:2560 sc1
  s_add_u32 s66, s58, 33554432
  s_add_u32 s67, s58, 33558528
  buffer_load_dwordx4 a[64:67], v2, s[52:55], s66 offen offset:0 sc1
  buffer_load_dwordx4 a[68:71], v2, s[52:55], s66 offen offset:512 sc1
  buffer_load_dwordx4 a[72:75], v2, s[52:55], s66 offen offset:2048 sc1
  buffer_load_dwordx4 a[76:79], v2, s[52:55], s66 offen offset:2560 sc1
  buffer_load_dwordx4 a[80:83], v2, s[52:55], s67 offen offset:0 sc1
  buffer_load_dwordx4 a[84:87], v2, s[52:55], s67 offen offset:512 sc1
  buffer_load_dwordx4 a[88:91], v2, s[52:55], s67 offen offset:2048 sc1
  buffer_load_dwordx4 a[92:95], v2, s[52:55], s67 offen offset:2560 sc1
  s_add_u32 s58, s58, 0x100000
  s_waitcnt vmcnt(15)
  v_mfma_f32_32x32x16_bf16 v[32:47], a[32:35], a[0:3], v[64:79]
  s_waitcnt vmcnt(14)
  v_mfma_f32_32x32x16_bf16 v[32:47], a[36:39], a[4:7], v[32:47]
  s_waitcnt vmcnt(13)
  v_mfma_f32_32x32x16_bf16 v[32:47], a[40:43], a[8:11], v[32:47]
  s_waitcnt vmcnt(12)
  v_mfma_f32_32x32x16_bf16 v[32:47], a[44:47], a[12:15], v[32:47]
  s_waitcnt vmcnt(11)
  v_mfma_f32_32x32x16_bf16 v[32:47], a[48:51], a[16:19], v[32:47]
  s_waitcnt vmcnt(10)
  v_mfma_f32_32x32x16_bf16 v[32:47], a[52:55], a[20:23], v[32:47]
  s_waitcnt vmcnt(9)
  v_mfma_f32_32x32x16_bf16 v[32:47], a[56:59], a[24:27], v[32:47]
  s_waitcnt vmcnt(8)
  v_mfma_f32_32x32x16_bf16 v[32:47], a[60:63], a[28:31], v[32:47]
  s_nop 11
  v_max3_f32 v10, v32, v33, v34
  v_max3_f32 v7, v35, v36, v37
  v_max3_f32 v10, v38, v39, v10
  v_max3_f32 v7, v40, v41, v7
  v_max3_f32 v10, v42, v43, v10
  v_max3_f32 v7, v44, v45, v7
  v_max3_f32 v10, v46, v47, v10
  v_max_f32 v10, v10, v7
  v_mov_b32 v7, v10
  s_nop 1
  v_permlane32_swap_b32 v10, v7
  v_max_f32 v10, v10, v7
  v_mul_f32 v11, s65, v10
  v_fma_f32 v32, v32, s65, -v11
  v_fma_f32 v33, v33, s65, -v11
  v_fma_f32 v34, v34, s65, -v11
  v_fma_f32 v35, v35, s65, -v11
  v_fma_f32 v36, v36, s65, -v11
  v_fma_f32 v37, v37, s65, -v11
  v_fma_f32 v38, v38, s65, -v11
  v_fma_f32 v39, v39, s65, -v11
  v_fma_f32 v40, v40, s65, -v11
  v_fma_f32 v41, v41, s65, -v11
  v_fma_f32 v42, v42, s65, -v11
  v_fma_f32 v43, v43, s65, -v11
  v_fma_f32 v44, v44, s65, -v11
  v_fma_f32 v45, v45, s65, -v11
  v_fma_f32 v46, v46, s65, -v11
  v_fma_f32 v47, v47, s65, -v11
  v_exp_f32 v32, v32
  v_exp_f32 v33, v33
  v_exp_f32 v34, v34
  v_exp_f32 v35, v35
  v_exp_f32 v36, v36
  v_exp_f32 v37, v37
  v_exp_f32 v38, v38
  v_exp_f32 v39, v39
  v_exp_f32 v40, v40
  v_exp_f32 v41, v41
  v_exp_f32 v42, v42
  v_exp_f32 v43, v43
  v_exp_f32 v44, v44
  v_exp_f32 v45, v45
  v_exp_f32 v46, v46
  v_exp_f32 v47, v47
  v_cvt_pk_bf16_f32 v20, v32, v33
  v_cvt_pk_bf16_f32 v21, v34, v35
  v_cvt_pk_bf16_f32 v22, v36, v37
  v_cvt_pk_bf16_f32 v23, v38, v39
  v_cvt_pk_bf16_f32 v24, v40, v41
  v_cvt_pk_bf16_f32 v25, v42, v43
  v_cvt_pk_bf16_f32 v26, v44, v45
  v_cvt_pk_bf16_f32 v27, v46, v47
  s_waitcnt vmcnt(7)
  v_mfma_f32_32x32x16_bf16 v[128:143], a[64:67], v[20:23], 0
  v_add_f32 v32, v32, v40
  v_add_f32 v33, v33, v41
  s_waitcnt vmcnt(5)
  v_mfma_f32_32x32x16_bf16 v[144:159], a[72:75], v[20:23], 0
  v_add_f32 v34, v34, v42
  v_add_f32 v35, v35, v43
  s_waitcnt vmcnt(3)
  v_mfma_f32_32x32x16_bf16 v[160:175], a[80:83], v[20:23], 0
  v_add_f32 v36, v36, v44
  v_add_f32 v37, v37, v45
  s_waitcnt vmcnt(1)
  v_mfma_f32_32x32x16_bf16 v[176:191], a[88:91], v[20:23], 0
  v_add_f32 v38, v38, v46
  v_add_f32 v39, v39, v47
  v_mfma_f32_32x32x16_bf16 v[128:143], a[68:71], v[24:27], v[128:143]
  v_add_f32 v32, v32, v36
  v_add_f32 v33, v33, v37
  v_mfma_f32_32x32x16_bf16 v[144:159], a[76:79], v[24:27], v[144:159]
  v_add_f32 v34, v34, v38
  v_add_f32 v35, v35, v39
  v_mfma_f32_32x32x16_bf16 v[160:175], a[84:87], v[24:27], v[160:175]
  v_add_f32 v32, v32, v34
  v_add_f32 v33, v33, v35
  s_waitcnt vmcnt(0)
  v_mfma_f32_32x32x16_bf16 v[176:191], a[92:95], v[24:27], v[176:191]
  v_add_f32 v12, v32, v33
  s_add_u32 s66, s57, 1
  s_min_u32 s66, s66, 63
AP_33:
  s_cmp_ge_u32 s63, s66
  s_cbranch_scc1 AO_34
  buffer_load_dwordx4 v[16:19], off, s[52:55], s61 sc1
  s_waitcnt vmcnt(0)
  v_min_u32 v16, v16, v17
  v_readfirstlane_b32 s63, v18
  v_readfirstlane_b32 s62, v16
  s_sub_i32 s68, s68, 1
  s_cmp_ge_i32 s68, 0
  s_cbranch_scc1 AP_33
AO_34:
A_30:
  s_add_u32 s67, s59, 4096
  buffer_load_dwordx4 v[80:83], v3, s[52:55], s59 offen offset:0 sc1
  buffer_load_dwordx4 v[84:87], v3, s[52:55], s59 offen offset:512 sc1
  buffer_load_dwordx4 v[88:91], v3, s[52:55], s59 offen offset:2048 sc1
  buffer_load_dwordx4 v[92:95], v3, s[52:55], s59 offen offset:2560 sc1
  buffer_load_dwordx4 v[96:99], v3, s[52:55], s67 offen offset:0 sc1
  buffer_load_dwordx4 v[100:103], v3, s[52:55], s67 offen offset:512 sc1
  buffer_load_dwordx4 v[104:107], v3, s[52:55], s67 offen offset:2048 sc1
  buffer_load_dwordx4 v[108:111], v3, s[52:55], s67 offen offset:2560 sc1
  buffer_load_dwordx2 v[112:113], v4, s[52:55], s59 offen offset:1024 sc1
  buffer_load_dwordx2 v[114:115], v4, s[52:55], s59 offen offset:1536 sc1
  buffer_load_dwordx2 v[116:117], v4, s[52:55], s59 offen offset:3072 sc1
  buffer_load_dwordx2 v[118:119], v4, s[52:55], s59 offen offset:3584 sc1
  buffer_load_dwordx2 v[120:121], v4, s[52:55], s67 offen offset:1024 sc1
  buffer_load_dwordx2 v[122:123], v4, s[52:55], s67 offen offset:1536 sc1
  buffer_load_dwordx2 v[124:125], v4, s[52:55], s67 offen offset:3072 sc1
  buffer_load_dwordx2 v[126:127], v4, s[52:55], s67 offen offset:3584 sc1
  s_waitcnt vmcnt(0)
  v_max3_u32 v6, v80, v81, v82
  v_max3_u32 v6, v83, v84, v6
  v_max3_u32 v6, v85, v86, v6
  v_max3_u32 v6, v87, v88, v6
  v_max3_u32 v6, v89, v90, v6
  v_max3_u32 v6, v91, v92, v6
  v_max3_u32 v6, v93, v94, v6
  v_max3_u32 v6, v95, v96, v6
  v_max3_u32 v6, v97, v98, v6
  v_max3_u32 v6, v99, v100, v6
  v_max3_u32 v6, v101, v102, v6
  v_max3_u32 v6, v103, v104, v6
  v_max3_u32 v6, v105, v106, v6
  v_max3_u32 v6, v107, v108, v6
  v_max3_u32 v6, v109, v110, v6
  v_max3_u32 v6, v111, v112, v6
  v_max3_u32 v6, v113, v114, v6
  v_max3_u32 v6, v115, v116, v6
  v_max3_u32 v6, v117, v118, v6
  v_max3_u32 v6, v119, v120, v6
  v_max3_u32 v6, v121, v122, v6
  v_max3_u32 v6, v123, v124, v6
  v_max3_u32 v6, v125, v126, v6
  v_max_u32 v6, v127, v6
  v_cmp_eq_u32 vcc, -1, v6
  s_sub_i32 s68, s68, 1
  s_cmp_lt_i32 s68, 0
  s_cbranch_scc1 A_29
  s_cbranch_vccnz A_30
A_29:
  v_mfma_f32_32x32x16_bf16 v[48:63], v[80:83], a[0:3], 0
  v_mfma_f32_32x32x16_bf16 v[48:63], v[84:87], a[4:7], v[48:63]
  v_mfma_f32_32x32x16_bf16 v[48:63], v[88:91], a[8:11], v[48:63]
  v_mfma_f32_32x32x16_bf16 v[48:63], v[92:95], a[12:15], v[48:63]
  v_mfma_f32_32x32x16_bf16 v[48:63], v[96:99], a[16:19], v[48:63]
  v_mfma_f32_32x32x16_bf16 v[48:63], v[100:103], a[20:23], v[48:63]
  v_mfma_f32_32x32x16_bf16 v[48:63], v[104:107], a[24:27], v[48:63]
  v_mfma_f32_32x32x16_bf16 v[48:63], v[108:111], a[28:31], v[48:63]
  s_add_u32 s59, s59, 0x100000
  s_nop 10
  v_max3_f32 v7, v48, v49, v10
  v_max3_f32 v7, v50, v51, v7
  v_mov_b32 v8, v7
  s_nop 1
  v_permlane32_swap_b32 v7, v8
  v_max_f32 v7, v7, v8
  v_mul_f32 v7, s65, v7
  v_sub_f32 v13, v11, v7
  v_fma_f32 v48, v48, s65, -v7
  v_fma_f32 v49, v49, s65, -v7
  v_fma_f32 v50, v50, s65, -v7
  v_fma_f32 v51, v51, s65, -v7
  v_exp_f32 v13, v13
  v_exp_f32 v48, v48
  v_exp_f32 v49, v49
  v_exp_f32 v50, v50
  v_exp_f32 v51, v51
  v_add_f32 v7, v48, v49
  v_add_f32 v8, v50, v51
  v_fma_f32 v7, v13, v12, v7
  v_add_f32 v7, v7, v8
  v_mov_b32 v8, v7
  s_nop 1
  v_permlane32_swap_b32 v7, v8
  v_add_f32 v7, v7, v8
  v_rcp_f32 v7, v7
  s_nop 0
  v_mul_f32 v14, v13, v7
  v_mul_f32 v48, v48, v7
  v_mul_f32 v49, v49, v7
  v_mul_f32 v50, v50, v7
  v_mul_f32 v51, v51, v7
  v_cvt_pk_bf16_f32 v28, v48, v49
  v_cvt_pk_bf16_f32 v29, v50, v51
  v_cvt_pk_bf16_f32 v30, v48, v49
  v_cvt_pk_bf16_f32 v31, v50, v51
  v_pk_mul_f32 v[128:129], v[128:129], v[14:15] op_sel_hi:[1,0]
  v_pk_mul_f32 v[130:131], v[130:131], v[14:15] op_sel_hi:[1,0]
  v_pk_mul_f32 v[132:133], v[132:133], v[14:15] op_sel_hi:[1,0]
  v_pk_mul_f32 v[134:135], v[134:135], v[14:15] op_sel_hi:[1,0]
  v_pk_mul_f32 v[136:137], v[136:137], v[14:15] op_sel_hi:[1,0]
  v_pk_mul_f32 v[138:139], v[138:139], v[14:15] op_sel_hi:[1,0]
  v_pk_mul_f32 v[140:141], v[140:141], v[14:15] op_sel_hi:[1,0]
  v_pk_mul_f32 v[142:143], v[142:143], v[14:15] op_sel_hi:[1,0]
  s_nop 1
  v_mfma_f32_32x32x16_bf16 v[128:143], v[112:115], v[28:31], v[128:143]
  v_pk_mul_f32 v[144:145], v[144:145], v[14:15] op_sel_hi:[1,0]
  v_pk_mul_f32 v[146:147], v[146:147], v[14:15] op_sel_hi:[1,0]
  v_pk_mul_f32 v[148:149], v[148:149], v[14:15] op_sel_hi:[1,0]
  v_pk_mul_f32 v[150:151], v[150:151], v[14:15] op_sel_hi:[1,0]
  v_pk_mul_f32 v[152:153], v[152:153], v[14:15] op_sel_hi:[1,0]
  v_pk_mul_f32 v[154:155], v[154:155], v[14:15] op_sel_hi:[1,0]
  v_pk_mul_f32 v[156:157], v[156:157], v[14:15] op_sel_hi:[1,0]
  v_pk_mul_f32 v[158:159], v[158:159], v[14:15] op_sel_hi:[1,0]
  s_nop 1
  v_mfma_f32_32x32x16_bf16 v[144:159], v[116:119], v[28:31], v[144:159]
  s_nop 0
  v_cvt_pk_bf16_f32 v192, v128, v129
  v_cvt_pk_bf16_f32 v193, v130, v131
  v_cvt_pk_bf16_f32 v194, v132, v133
  v_cvt_pk_bf16_f32 v195, v134, v135
  buffer_store_dwordx4 v[192:195], v5, s[52:55], s60 offen offset:0 sc1
  v_cvt_pk_bf16_f32 v196, v136, v137
  v_cvt_pk_bf16_f32 v197, v138, v139
  v_cvt_pk_bf16_f32 v198, v140, v141
  v_cvt_pk_bf16_f32 v199, v142, v143
  buffer_store_dwordx4 v[196:199], v5, s[52:55], s60 offen offset:256 sc1
  v_pk_mul_f32 v[160:161], v[160:161], v[14:15] op_sel_hi:[1,0]
  v_pk_mul_f32 v[162:163], v[162:163], v[14:15] op_sel_hi:[1,0]
  v_pk_mul_f32 v[164:165], v[164:165], v[14:15] op_sel_hi:[1,0]
  v_pk_mul_f32 v[166:167], v[166:167], v[14:15] op_sel_hi:[1,0]
  v_pk_mul_f32 v[168:169], v[168:169], v[14:15] op_sel_hi:[1,0]
  v_pk_mul_f32 v[170:171], v[170:171], v[14:15] op_sel_hi:[1,0]
  v_pk_mul_f32 v[172:173], v[172:173], v[14:15] op_sel_hi:[1,0]
  v_pk_mul_f32 v[174:175], v[174:175], v[14:15] op_sel_hi:[1,0]
  s_nop 1
  v_mfma_f32_32x32x16_bf16 v[160:175], v[120:123], v[28:31], v[160:175]
  v_cvt_pk_bf16_f32 v192, v144, v145
  v_cvt_pk_bf16_f32 v193, v146, v147
  v_cvt_pk_bf16_f32 v194, v148, v149
  v_cvt_pk_bf16_f32 v195, v150, v151
  buffer_store_dwordx4 v[192:195], v5, s[52:55], s60 offen offset:512 sc1
  v_cvt_pk_bf16_f32 v196, v152, v153
  v_cvt_pk_bf16_f32 v197, v154, v155
  v_cvt_pk_bf16_f32 v198, v156, v157
  v_cvt_pk_bf16_f32 v199, v158, v159
  buffer_store_dwordx4 v[196:199], v5, s[52:55], s60 offen offset:768 sc1
  v_pk_mul_f32 v[176:177], v[176:177], v[14:15] op_sel_hi:[1,0]
  v_pk_mul_f32 v[178:179], v[178:179], v[14:15] op_sel_hi:[1,0]
  v_pk_mul_f32 v[180:181], v[180:181], v[14:15] op_sel_hi:[1,0]
  v_pk_mul_f32 v[182:183], v[182:183], v[14:15] op_sel_hi:[1,0]
  v_pk_mul_f32 v[184:185], v[184:185], v[14:15] op_sel_hi:[1,0]
  v_pk_mul_f32 v[186:187], v[186:187], v[14:15] op_sel_hi:[1,0]
  v_pk_mul_f32 v[188:189], v[188:189], v[14:15] op_sel_hi:[1,0]
  v_pk_mul_f32 v[190:191], v[190:191], v[14:15] op_sel_hi:[1,0]
  s_nop 1
  v_mfma_f32_32x32x16_bf16 v[176:191], v[124:127], v[28:31], v[176:191]
  v_cvt_pk_bf16_f32 v192, v160, v161
  v_cvt_pk_bf16_f32 v193, v162, v163
  v_cvt_pk_bf16_f32 v194, v164, v165
  v_cvt_pk_bf16_f32 v195, v166, v167
  buffer_store_dwordx4 v[192:195], v5, s[52:55], s60 offen offset:1024 sc1
  v_cvt_pk_bf16_f32 v196, v168, v169
  v_cvt_pk_bf16_f32 v197, v170, v171
  v_cvt_pk_bf16_f32 v198, v172, v173
  v_cvt_pk_bf16_f32 v199, v174, v175
  buffer_store_dwordx4 v[196:199], v5, s[52:55], s60 offen offset:1280 sc1
  s_nop 1
  v_cvt_pk_bf16_f32 v192, v176, v177
  v_cvt_pk_bf16_f32 v193, v178, v179
  v_cvt_pk_bf16_f32 v194, v180, v181
  v_cvt_pk_bf16_f32 v195, v182, v183
  buffer_store_dwordx4 v[192:195], v5, s[52:55], s60 offen offset:1536 sc1
  v_cvt_pk_bf16_f32 v196, v184, v185
  v_cvt_pk_bf16_f32 v197, v186, v187
  v_cvt_pk_bf16_f32 v198, v188, v189
  v_cvt_pk_bf16_f32 v199, v190, v191
  buffer_store_dwordx4 v[196:199], v5, s[52:55], s60 offen offset:1792 sc1
  s_add_u32 s60, s60, 0x100000
  s_add_u32 s57, s57, 4
  s_cmp_lt_u32 s57, 64
  s_cbranch_scc1 AT_28
  s_waitcnt vmcnt(0)
  s_endpgm
R_Q:
  s_cmp_ge_u32 s7, 32
  s_cbranch_scc1 QKV_V_35
  s_mov_b32 s56, s7
  s_lshl_b32 s63, s56, 7
  s_add_u32 s63, s63, 112197632
  v_and_b32 v11, 0, v0
  v_lshlrev_b32 v11, 7, v11
  v_bfe_u32 v7, v0, 1, 3
  v_bfe_u32 v8, v0, 4, 1
  v_lshlrev_b32 v8, 2, v8
  v_xor_b32 v7, v7, v8
  v_lshlrev_b32 v1, 13, v7
  v_lshrrev_b32 v7, 4, v0
  v_lshl_add_u32 v1, v7, 5, v1
  v_and_b32 v7, 1, v0
  v_lshl_add_u32 v1, v7, 4, v1
  s_lshl_b32 s58, s5, 16
  s_lshl_b32 s65, s56, 8
  s_add_u32 s58, s58, s65
  s_lshl_b32 s59, s5, 11
  s_add_u32 m0, s59, 0
  s_add_u32 s65, s58, 0
  buffer_load_dwordx4 v1, s[16:19], s65 offen lds
  s_add_u32 m0, s59, 1024
  s_add_u32 s65, s58, 128
  buffer_load_dwordx4 v1, s[16:19], s65 offen lds
  s_add_u32 m0, s59, 8192
  s_add_u32 s65, s58, 262144
  buffer_load_dwordx4 v1, s[16:19], s65 offen lds
  s_add_u32 m0, s59, 9216
  s_add_u32 s65, s58, 262272
  buffer_load_dwordx4 v1, s[16:19], s65 offen lds
  s_add_u32 m0, s59, 16384
  s_add_u32 s65, s58, 524288
  buffer_load_dwordx4 v1, s[16:19], s65 offen lds
  s_add_u32 m0, s59, 17408
  s_add_u32 s65, s58, 524416
  buffer_load_dwordx4 v1, s[16:19], s65 offen lds
  s_add_u32 m0, s59, 24576
  s_add_u32 s65, s58, 786432
  buffer_load_dwordx4 v1, s[16:19], s65 offen lds
  s_add_u32 m0, s59, 25600
  s_add_u32 s65, s58, 786560
  buffer_load_dwordx4 v1, s[16:19], s65 offen lds
  s_add_u32 m0, s59, 32768
  s_add_u32 s65, s58, 1048576
  buffer_load_dwordx4 v1, s[16:19], s65 offen lds
  s_add_u32 m0, s59, 33792
  s_add_u32 s65, s58, 1048704
  buffer_load_dwordx4 v1, s[16:19], s65 offen lds
  s_add_u32 m0, s59, 40960
  s_add_u32 s65, s58, 1310720
  buffer_load_dwordx4 v1, s[16:19], s65 offen lds
  s_add_u32 m0, s59, 41984
  s_add_u32 s65, s58, 1310848
  buffer_load_dwordx4 v1, s[16:19], s65 offen lds
  s_add_u32 m0, s59, 49152
  s_add_u32 s65, s58, 1572864
  buffer_load_dwordx4 v1, s[16:19], s65 offen lds
  s_add_u32 m0, s59, 50176
  s_add_u32 s65, s58, 1572992
  buffer_load_dwordx4 v1, s[16:19], s65 offen lds
  s_add_u32 m0, s59, 57344
  s_add_u32 s65, s58, 1835008
  buffer_load_dwordx4 v1, s[16:19], s65 offen lds
  s_add_u32 m0, s59, 58368
  s_add_u32 s65, s58, 1835136
  buffer_load_dwordx4 v1, s[16:19], s65 offen lds
  s_add_u32 m0, s59, 65536
  s_add_u32 s65, s58, 2097152
  buffer_load_dwordx4 v1, s[16:19], s65 offen lds
  s_add_u32 m0, s59, 66560
  s_add_u32 s65, s58, 2097280
  buffer_load_dwordx4 v1, s[16:19], s65 offen lds
  s_add_u32 m0, s59, 73728
  s_add_u32 s65, s58, 2359296
  buffer_load_dwordx4 v1, s[16:19], s65 offen lds
  s_add_u32 m0, s59, 74752
  s_add_u32 s65, s58, 2359424
  buffer_load_dwordx4 v1, s[16:19], s65 offen lds
  s_add_u32 m0, s59, 81920
  s_add_u32 s65, s58, 2621440
  buffer_load_dwordx4 v1, s[16:19], s65 offen lds
  s_add_u32 m0, s59, 82944
  s_add_u32 s65, s58, 2621568
  buffer_load_dwordx4 v1, s[16:19], s65 offen lds
  s_add_u32 m0, s59, 90112
  s_add_u32 s65, s58, 2883584
  buffer_load_dwordx4 v1, s[16:19], s65 offen lds
  s_add_u32 m0, s59, 91136
  s_add_u32 s65, s58, 2883712
  buffer_load_dwordx4 v1, s[16:19], s65 offen lds
  s_add_u32 m0, s59, 98304
  s_add_u32 s65, s58, 3145728
  buffer_load_dwordx4 v1, s[16:19], s65 offen lds
  s_add_u32 m0, s59, 99328
  s_add_u32 s65, s58, 3145856
  buffer_load_dwordx4 v1, s[16:19], s65 offen lds
  s_add_u32 m0, s59, 106496
  s_add_u32 s65, s58, 3407872
  buffer_load_dwordx4 v1, s[16:19], s65 offen lds
  s_add_u32 m0, s59, 107520
  s_add_u32 s65, s58, 3408000
  buffer_load_dwordx4 v1, s[16:19], s65 offen lds
  s_add_u32 m0, s59, 114688
  s_add_u32 s65, s58, 3670016
  buffer_load_dwordx4 v1, s[16:19], s65 offen lds
  s_add_u32 m0, s59, 115712
  s_add_u32 s65, s58, 3670144
  buffer_load_dwordx4 v1, s[16:19], s65 offen lds
  s_add_u32 m0, s59, 122880
  s_add_u32 s65, s58, 3932160
  buffer_load_dwordx4 v1, s[16:19], s65 offen lds
  s_add_u32 m0, s59, 123904
  s_add_u32 s65, s58, 3932288
  buffer_load_dwordx4 v1, s[16:19], s65 offen lds
  s_add_u32 m0, s59, 131072
  s_add_u32 s65, s58, 4194304
  buffer_load_dwordx4 v1, s[16:19], s65 offen lds
  s_add_u32 m0, s59, 132096
  s_add_u32 s65, s58, 4194432
  buffer_load_dwordx4 v1, s[16:19], s65 offen lds
  s_add_u32 m0, s59, 139264
  s_add_u32 s65, s58, 4456448
  buffer_load_dwordx4 v1, s[16:19], s65 offen lds
  s_add_u32 m0, s59, 140288
  s_add_u32 s65, s58, 4456576
  buffer_load_dwordx4 v1, s[16:19], s65 offen lds
  v_lshrrev_b32 v7, 5, v0
  v_lshlrev_b32 v2, 11, v7
  v_bfe_u32 v8, v0, 4, 1
  v_mul_u32_u24 v9, 384, v8
  v_add_u32 v2, v2, v9
  v_and_b32 v9, 15, v0
  v_lshl_add_u32 v2, v9, 3, v2
  s_lshl_b32 s65, s5, 9
  v_add_u32 v2, s65, v2
  v_xor_b32 v3, 128, v2
  v_add_u32 v128, 0x10000, v2
  v_add_u32 v129, 0x10000, v3
  v_add_u32 v130, 0x10000, v128
  v_add_u32 v131, 0x10000, v129
  s_and_b32 s65, s5, 1
  v_lshrrev_b32 v7, 3, v0
  v_xor_b32 v7, s65, v7
  v_and_b32 v8, 7, v0
  v_xor_b32 v8, v8, v7
  s_lshl_b32 s65, s5, 3
  v_add_u32 v7, s65, v7
  v_mul_u32_u24 v4, 1152, v7
  v_lshl_add_u32 v4, v8, 4, v4
  v_bfe_u32 v7, v0, 3, 2
  v_and_b32 v8, 7, v0
  v_and_b32 v9, 1, v7
  v_xor_b32 v9, v9, v8
  v_lshlrev_b32 v9, 7, v9
  v_lshl_add_u32 v9, v7, 10, v9
  v_lshrrev_b32 v7, 5, v0
  v_xor_b32 v8, v8, v7
  v_xor_b32 v10, 0, v8
  v_lshl_add_u32 v12, v10, 4, v9
  v_add_u32 v16, 36864, v12
  v_add_u32 v20, 73728, v12
  v_add_u32 v24, 110592, v12
  v_xor_b32 v10, 2, v8
  v_lshl_add_u32 v13, v10, 4, v9
  v_add_u32 v17, 36864, v13
  v_add_u32 v21, 73728, v13
  v_add_u32 v25, 110592, v13
  v_xor_b32 v10, 4, v8
  v_lshl_add_u32 v14, v10, 4, v9
  v_add_u32 v18, 36864, v14
  v_add_u32 v22, 73728, v14
  v_add_u32 v26, 110592, v14
  v_xor_b32 v10, 6, v8
  v_lshl_add_u32 v15, v10, 4, v9
  v_add_u32 v19, 36864, v15
  v_add_u32 v23, 73728, v15
  v_add_u32 v27, 110592, v15
  v_mov_b32 v28, 0x3f803f80
  v_mov_b32 v29, 0x3f803f80
  v_mov_b32 v30, 0x3f803f80
  v_mov_b32 v31, 0x3f803f80
  v_bfe_u32 v7, v0, 3, 1
  v_bfe_u32 v8, v0, 4, 1
  v_and_b32 v9, 7, v0
  v_lshl_add_u32 v8, v8, 3, v9
  v_lshlrev_b32 v5, 10, v7
  v_lshl_add_u32 v5, v8, 4, v5
  v_lshrrev_b32 v7, 5, v0
  v_lshl_add_u32 v5, v7, 8, v5
  s_lshl_b32 s65, s5, 11
  v_add_u32 v5, s65, v5
  v_and_b32 v6, 31, v0
  v_lshlrev_b32 v6, 2, v6
  v_add_u32 v6, 147200, v6
  s_waitcnt vmcnt(18)
  s_barrier
  ds_read_b64_tr_b16 a[0:1], v2 offset:0
  ds_read_b64_tr_b16 a[2:3], v3 offset:0
  ds_read_b64_tr_b16 a[4:5], v2 offset:4096
  ds_read_b64_tr_b16 a[6:7], v3 offset:4096
  ds_read_b64_tr_b16 a[8:9], v2 offset:8192
  ds_read_b64_tr_b16 a[10:11], v3 offset:8192
  ds_read_b64_tr_b16 a[12:13], v2 offset:12288
  ds_read_b64_tr_b16 a[14:15], v3 offset:12288
  ds_read_b64_tr_b16 a[16:17], v2 offset:16384
  ds_read_b64_tr_b16 a[18:19], v3 offset:16384
  ds_read_b64_tr_b16 a[20:21], v2 offset:20480
  ds_read_b64_tr_b16 a[22:23], v3 offset:20480
  ds_read_b64_tr_b16 a[24:25], v2 offset:24576
  ds_read_b64_tr_b16 a[26:27], v3 offset:24576
  ds_read_b64_tr_b16 a[28:29], v2 offset:28672
  ds_read_b64_tr_b16 a[30:31], v3 offset:28672
  ds_read_b64_tr_b16 a[32:33], v2 offset:32768
  ds_read_b64_tr_b16 a[34:35], v3 offset:32768
  ds_read_b64_tr_b16 a[36:37], v2 offset:36864
  ds_read_b64_tr_b16 a[38:39], v3 offset:36864
  ds_read_b64_tr_b16 a[40:41], v2 offset:40960
  ds_read_b64_tr_b16 a[42:43], v3 offset:40960
  ds_read_b64_tr_b16 a[44:45], v2 offset:45056
  ds_read_b64_tr_b16 a[46:47], v3 offset:45056
  ds_read_b64_tr_b16 a[48:49], v2 offset:49152
  ds_read_b64_tr_b16 a[50:51], v3 offset:49152
  ds_read_b64_tr_b16 a[52:53], v2 offset:53248
  ds_read_b64_tr_b16 a[54:55], v3 offset:53248
  ds_read_b64_tr_b16 a[56:57], v2 offset:57344
  ds_read_b64_tr_b16 a[58:59], v3 offset:57344
  ds_read_b64_tr_b16 a[60:61], v2 offset:61440
  ds_read_b64_tr_b16 a[62:63], v3 offset:61440
  ds_read_b64_tr_b16 a[64:65], v128 offset:0
  ds_read_b64_tr_b16 a[66:67], v129 offset:0
  ds_read_b64_tr_b16 a[68:69], v128 offset:4096
  ds_read_b64_tr_b16 a[70:71], v129 offset:4096
  s_waitcnt lgkmcnt(0)
  s_barrier
  s_add_u32 m0, s59, 0
  s_add_u32 s65, s58, 0
  buffer_load_dwordx4 v1, s[20:23], s65 offen lds
  s_add_u32 m0, s59, 1024
  s_add_u32 s65, s58, 128
  buffer_load_dwordx4 v1, s[20:23], s65 offen lds
  s_add_u32 m0, s59, 8192
  s_add_u32 s65, s58, 262144
  buffer_load_dwordx4 v1, s[20:23], s65 offen lds
  s_add_u32 m0, s59, 9216
  s_add_u32 s65, s58, 262272
  buffer_load_dwordx4 v1, s[20:23], s65 offen lds
  s_add_u32 m0, s59, 16384
  s_add_u32 s65, s58, 524288
  buffer_load_dwordx4 v1, s[20:23], s65 offen lds
  s_add_u32 m0, s59, 17408
  s_add_u32 s65, s58, 524416
  buffer_load_dwordx4 v1, s[20:23], s65 offen lds
  s_add_u32 m0, s59, 24576
  s_add_u32 s65, s58, 786432
  buffer_load_dwordx4 v1, s[20:23], s65 offen lds
  s_add_u32 m0, s59, 25600
  s_add_u32 s65, s58, 786560
  buffer_load_dwordx4 v1, s[20:23], s65 offen lds
  s_add_u32 m0, s59, 32768
  s_add_u32 s65, s58, 1048576
  buffer_load_dwordx4 v1, s[20:23], s65 offen lds
  s_add_u32 m0, s59, 33792
  s_add_u32 s65, s58, 1048704
  buffer_load_dwordx4 v1, s[20:23], s65 offen lds
  s_add_u32 m0, s59, 40960
  s_add_u32 s65, s58, 1310720
  buffer_load_dwordx4 v1, s[20:23], s65 offen lds
  s_add_u32 m0, s59, 41984
  s_add_u32 s65, s58, 1310848
  buffer_load_dwordx4 v1, s[20:23], s65 offen lds
  s_add_u32 m0, s59, 49152
  s_add_u32 s65, s58, 1572864
  buffer_load_dwordx4 v1, s[20:23], s65 offen lds
  s_add_u32 m0, s59, 50176
  s_add_u32 s65, s58, 1572992
  buffer_load_dwordx4 v1, s[20:23], s65 offen lds
  s_add_u32 m0, s59, 57344
  s_add_u32 s65, s58, 1835008
  buffer_load_dwordx4 v1, s[20:23], s65 offen lds
  s_add_u32 m0, s59, 58368
  s_add_u32 s65, s58, 1835136
  buffer_load_dwordx4 v1, s[20:23], s65 offen lds
  s_add_u32 m0, s59, 65536
  s_add_u32 s65, s58, 2097152
  buffer_load_dwordx4 v1, s[20:23], s65 offen lds
  s_add_u32 m0, s59, 66560
  s_add_u32 s65, s58, 2097280
  buffer_load_dwordx4 v1, s[20:23], s65 offen lds
  s_waitcnt vmcnt(18)
  s_barrier
  ds_read_b64_tr_b16 a[72:73], v128 offset:8192
  ds_read_b64_tr_b16 a[74:75], v129 offset:8192
  ds_read_b64_tr_b16 a[76:77], v128 offset:12288
  ds_read_b64_tr_b16 a[78:79], v129 offset:12288
  ds_read_b64_tr_b16 a[80:81], v128 offset:16384
  ds_read_b64_tr_b16 a[82:83], v129 offset:16384
  ds_read_b64_tr_b16 a[84:85], v128 offset:20480
  ds_read_b64_tr_b16 a[86:87], v129 offset:20480
  ds_read_b64_tr_b16 a[88:89], v128 offset:24576
  ds_read_b64_tr_b16 a[90:91], v129 offset:24576
  ds_read_b64_tr_b16 a[92:93], v128 offset:28672
  ds_read_b64_tr_b16 a[94:95], v129 offset:28672
  ds_read_b64_tr_b16 a[96:97], v128 offset:32768
  ds_read_b64_tr_b16 a[98:99], v129 offset:32768
  ds_read_b64_tr_b16 a[100:101], v128 offset:36864
  ds_read_b64_tr_b16 a[102:103], v129 offset:36864
  ds_read_b64_tr_b16 a[104:105], v128 offset:40960
  ds_read_b64_tr_b16 a[106:107], v129 offset:40960
  ds_read_b64_tr_b16 a[108:109], v128 offset:45056
  ds_read_b64_tr_b16 a[110:111], v129 offset:45056
  ds_read_b64_tr_b16 a[112:113], v128 offset:49152
  ds_read_b64_tr_b16 a[114:115], v129 offset:49152
  ds_read_b64_tr_b16 a[116:117], v128 offset:53248
  ds_read_b64_tr_b16 a[118:119], v129 offset:53248
  ds_read_b64_tr_b16 a[120:121], v128 offset:57344
  ds_read_b64_tr_b16 a[122:123], v129 offset:57344
  ds_read_b64_tr_b16 a[124:125], v128 offset:61440
  ds_read_b64_tr_b16 a[126:127], v129 offset:61440
  ds_read_b64_tr_b16 a[128:129], v130 offset:0
  ds_read_b64_tr_b16 a[130:131], v131 offset:0
  ds_read_b64_tr_b16 a[132:133], v130 offset:4096
  ds_read_b64_tr_b16 a[134:135], v131 offset:4096
  ds_read_b64_tr_b16 a[136:137], v130 offset:8192
  ds_read_b64_tr_b16 a[138:139], v131 offset:8192
  ds_read_b64_tr_b16 a[140:141], v130 offset:12288
  ds_read_b64_tr_b16 a[142:143], v131 offset:12288
  s_waitcnt lgkmcnt(0)
  s_barrier
  s_add_u32 m0, s59, 73728
  s_add_u32 s65, s58, 2359296
  buffer_load_dwordx4 v1, s[20:23], s65 offen lds
  s_add_u32 m0, s59, 74752
  s_add_u32 s65, s58, 2359424
  buffer_load_dwordx4 v1, s[20:23], s65 offen lds
  s_add_u32 m0, s59, 81920
  s_add_u32 s65, s58, 2621440
  buffer_load_dwordx4 v1, s[20:23], s65 offen lds
  s_add_u32 m0, s59, 82944
  s_add_u32 s65, s58, 2621568
  buffer_load_dwordx4 v1, s[20:23], s65 offen lds
  s_add_u32 m0, s59, 90112
  s_add_u32 s65, s58, 2883584
  buffer_load_dwordx4 v1, s[20:23], s65 offen lds
  s_add_u32 m0, s59, 91136
  s_add_u32 s65, s58, 2883712
  buffer_load_dwordx4 v1, s[20:23], s65 offen lds
  s_add_u32 m0, s59, 98304
  s_add_u32 s65, s58, 3145728
  buffer_load_dwordx4 v1, s[20:23], s65 offen lds
  s_add_u32 m0, s59, 99328
  s_add_u32 s65, s58, 3145856
  buffer_load_dwordx4 v1, s[20:23], s65 offen lds
  s_add_u32 m0, s59, 106496
  s_add_u32 s65, s58, 3407872
  buffer_load_dwordx4 v1, s[20:23], s65 offen lds
  s_add_u32 m0, s59, 107520
  s_add_u32 s65, s58, 3408000
  buffer_load_dwordx4 v1, s[20:23], s65 offen lds
  s_add_u32 m0, s59, 114688
  s_add_u32 s65, s58, 3670016
  buffer_load_dwordx4 v1, s[20:23], s65 offen lds
  s_add_u32 m0, s59, 115712
  s_add_u32 s65, s58, 3670144
  buffer_load_dwordx4 v1, s[20:23], s65 offen lds
  s_add_u32 m0, s59, 122880
  s_add_u32 s65, s58, 3932160
  buffer_load_dwordx4 v1, s[20:23], s65 offen lds
  s_add_u32 m0, s59, 123904
  s_add_u32 s65, s58, 3932288
  buffer_load_dwordx4 v1, s[20:23], s65 offen lds
  s_add_u32 m0, s59, 131072
  s_add_u32 s65, s58, 4194304
  buffer_load_dwordx4 v1, s[20:23], s65 offen lds
  s_add_u32 m0, s59, 132096
  s_add_u32 s65, s58, 4194432
  buffer_load_dwordx4 v1, s[20:23], s65 offen lds
  s_add_u32 m0, s59, 139264
  s_add_u32 s65, s58, 4456448
  buffer_load_dwordx4 v1, s[20:23], s65 offen lds
  s_add_u32 m0, s59, 140288
  s_add_u32 s65, s58, 4456576
  buffer_load_dwordx4 v1, s[20:23], s65 offen lds
  v_mfma_f32_32x32x16_bf16 v[32:47], a[0:3], v[28:31], 0
  v_mfma_f32_32x32x16_bf16 v[32:47], a[4:7], v[28:31], v[32:47]
  v_mfma_f32_32x32x16_bf16 v[32:47], a[8:11], v[28:31], v[32:47]
  v_mfma_f32_32x32x16_bf16 v[32:47], a[12:15], v[28:31], v[32:47]
  v_mfma_f32_32x32x16_bf16 v[32:47], a[16:19], v[28:31], v[32:47]
  v_mfma_f32_32x32x16_bf16 v[32:47], a[20:23], v[28:31], v[32:47]
  v_mfma_f32_32x32x16_bf16 v[32:47], a[24:27], v[28:31], v[32:47]
  v_mfma_f32_32x32x16_bf16 v[32:47], a[28:31], v[28:31], v[32:47]
  v_mfma_f32_32x32x16_bf16 v[32:47], a[32:35], v[28:31], v[32:47]
  v_mfma_f32_32x32x16_bf16 v[32:47], a[36:39], v[28:31], v[32:47]
  v_mfma_f32_32x32x16_bf16 v[32:47], a[40:43], v[28:31], v[32:47]
  v_mfma_f32_32x32x16_bf16 v[32:47], a[44:47], v[28:31], v[32:47]
  v_mfma_f32_32x32x16_bf16 v[32:47], a[48:51], v[28:31], v[32:47]
  v_mfma_f32_32x32x16_bf16 v[32:47], a[52:55], v[28:31], v[32:47]
  v_mfma_f32_32x32x16_bf16 v[32:47], a[56:59], v[28:31], v[32:47]
  v_mfma_f32_32x32x16_bf16 v[32:47], a[60:63], v[28:31], v[32:47]
  v_mfma_f32_32x32x16_bf16 v[32:47], a[64:67], v[28:31], v[32:47]
  v_mfma_f32_32x32x16_bf16 v[32:47], a[68:71], v[28:31], v[32:47]
  v_mfma_f32_32x32x16_bf16 v[32:47], a[72:75], v[28:31], v[32:47]
  v_mfma_f32_32x32x16_bf16 v[32:47], a[76:79], v[28:31], v[32:47]
  v_mfma_f32_32x32x16_bf16 v[32:47], a[80:83], v[28:31], v[32:47]
  v_mfma_f32_32x32x16_bf16 v[32:47], a[84:87], v[28:31], v[32:47]
  v_mfma_f32_32x32x16_bf16 v[32:47], a[88:91], v[28:31], v[32:47]
  v_mfma_f32_32x32x16_bf16 v[32:47], a[92:95], v[28:31], v[32:47]
  v_mfma_f32_32x32x16_bf16 v[32:47], a[96:99], v[28:31], v[32:47]
  v_mfma_f32_32x32x16_bf16 v[32:47], a[100:103], v[28:31], v[32:47]
  v_mfma_f32_32x32x16_bf16 v[32:47], a[104:107], v[28:31], v[32:47]
  v_mfma_f32_32x32x16_bf16 v[32:47], a[108:111], v[28:31], v[32:47]
  v_mfma_f32_32x32x16_bf16 v[32:47], a[112:115], v[28:31], v[32:47]
  v_mfma_f32_32x32x16_bf16 v[32:47], a[116:119], v[28:31], v[32:47]
  v_mfma_f32_32x32x16_bf16 v[32:47], a[120:123], v[28:31], v[32:47]
  v_mfma_f32_32x32x16_bf16 v[32:47], a[124:127], v[28:31], v[32:47]
  v_mfma_f32_32x32x16_bf16 v[32:47], a[128:131], v[28:31], v[32:47]
  v_mfma_f32_32x32x16_bf16 v[32:47], a[132:135], v[28:31], v[32:47]
  v_mfma_f32_32x32x16_bf16 v[32:47], a[136:139], v[28:31], v[32:47]
  v_mfma_f32_32x32x16_bf16 v[32:47], a[140:143], v[28:31], v[32:47]
  s_waitcnt vmcnt(18)
  s_barrier
  ds_read_b64_tr_b16 a[144:145], v2 offset:0
  ds_read_b64_tr_b16 a[146:147], v3 offset:0
  ds_read_b64_tr_b16 a[148:149], v2 offset:4096
  ds_read_b64_tr_b16 a[150:151], v3 offset:4096
  ds_read_b64_tr_b16 a[152:153], v2 offset:8192
  ds_read_b64_tr_b16 a[154:155], v3 offset:8192
  ds_read_b64_tr_b16 a[156:157], v2 offset:12288
  ds_read_b64_tr_b16 a[158:159], v3 offset:12288
  ds_read_b64_tr_b16 a[160:161], v2 offset:16384
  ds_read_b64_tr_b16 a[162:163], v3 offset:16384
  ds_read_b64_tr_b16 a[164:165], v2 offset:20480
  ds_read_b64_tr_b16 a[166:167], v3 offset:20480
  ds_read_b64_tr_b16 a[168:169], v2 offset:24576
  ds_read_b64_tr_b16 a[170:171], v3 offset:24576
  ds_read_b64_tr_b16 a[172:173], v2 offset:28672
  ds_read_b64_tr_b16 a[174:175], v3 offset:28672
  ds_read_b64_tr_b16 a[176:177], v2 offset:32768
  ds_read_b64_tr_b16 a[178:179], v3 offset:32768
  ds_read_b64_tr_b16 a[180:181], v2 offset:36864
  ds_read_b64_tr_b16 a[182:183], v3 offset:36864
  ds_read_b64_tr_b16 a[184:185], v2 offset:40960
  ds_read_b64_tr_b16 a[186:187], v3 offset:40960
  ds_read_b64_tr_b16 a[188:189], v2 offset:45056
  ds_read_b64_tr_b16 a[190:191], v3 offset:45056
  ds_read_b64_tr_b16 a[192:193], v2 offset:49152
  ds_read_b64_tr_b16 a[194:195], v3 offset:49152
  ds_read_b64_tr_b16 a[196:197], v2 offset:53248
  ds_read_b64_tr_b16 a[198:199], v3 offset:53248
  ds_read_b64_tr_b16 a[200:201], v2 offset:57344
  ds_read_b64_tr_b16 a[202:203], v3 offset:57344
  ds_read_b64_tr_b16 a[204:205], v2 offset:61440
  ds_read_b64_tr_b16 a[206:207], v3 offset:61440
  ds_read_b64_tr_b16 a[208:209], v128 offset:0
  ds_read_b64_tr_b16 a[210:211], v129 offset:0
  ds_read_b64_tr_b16 a[212:213], v128 offset:4096
  ds_read_b64_tr_b16 a[214:215], v129 offset:4096
  s_waitcnt lgkmcnt(0)
  s_barrier
  s_lshl_b32 s59, s5, 10
  s_mov_b32 s60, 0
  s_add_u32 m0, s59, 0
  s_add_u32 s65, s60, 0
  buffer_load_dwordx4 v4, s[8:11], s65 offen lds
  s_add_u32 m0, s59, 4096
  s_add_u32 s65, s60, 128
  buffer_load_dwordx4 v4, s[8:11], s65 offen lds
  s_add_u32 m0, s59, 8192
  s_add_u32 s65, s60, 256
  buffer_load_dwordx4 v4, s[8:11], s65 offen lds
  s_add_u32 m0, s59, 12288
  s_add_u32 s65, s60, 384
  buffer_load_dwordx4 v4, s[8:11], s65 offen lds
  s_add_u32 m0, s59, 16384
  s_add_u32 s65, s60, 512
  buffer_load_dwordx4 v4, s[8:11], s65 offen lds
  s_add_u32 m0, s59, 20480
  s_add_u32 s65, s60, 640
  buffer_load_dwordx4 v4, s[8:11], s65 offen lds
  s_add_u32 m0, s59, 24576
  s_add_u32 s65, s60, 768
  buffer_load_dwordx4 v4, s[8:11], s65 offen lds
  s_add_u32 m0, s59, 28672
  s_add_u32 s65, s60, 896
  buffer_load_dwordx4 v4, s[8:11], s65 offen lds
  s_add_u32 m0, s59, 32768
  s_add_u32 s65, s60, 1024
  buffer_load_dwordx4 v4, s[8:11], s65 offen lds
  s_add_u32 s60, s60, 36864
  s_add_u32 m0, s59, 36864
  s_add_u32 s65, s60, 0
  buffer_load_dwordx4 v4, s[8:11], s65 offen lds
  s_add_u32 m0, s59, 40960
  s_add_u32 s65, s60, 128
  buffer_load_dwordx4 v4, s[8:11], s65 offen lds
  s_add_u32 m0, s59, 45056
  s_add_u32 s65, s60, 256
  buffer_load_dwordx4 v4, s[8:11], s65 offen lds
  s_add_u32 m0, s59, 49152
  s_add_u32 s65, s60, 384
  buffer_load_dwordx4 v4, s[8:11], s65 offen lds
  s_add_u32 m0, s59, 53248
  s_add_u32 s65, s60, 512
  buffer_load_dwordx4 v4, s[8:11], s65 offen lds
  s_add_u32 m0, s59, 57344
  s_add_u32 s65, s60, 640
  buffer_load_dwordx4 v4, s[8:11], s65 offen lds
  s_add_u32 m0, s59, 61440
  s_add_u32 s65, s60, 768
  buffer_load_dwordx4 v4, s[8:11], s65 offen lds
  s_add_u32 m0, s59, 65536
  s_add_u32 s65, s60, 896
  buffer_load_dwordx4 v4, s[8:11], s65 offen lds
  s_add_u32 m0, s59, 69632
  s_add_u32 s65, s60, 1024
  buffer_load_dwordx4 v4, s[8:11], s65 offen lds
  s_add_u32 s60, s60, 36864
  s_waitcnt vmcnt(18)
  s_barrier
  ds_read_b64_tr_b16 a[216:217], v128 offset:8192
  ds_read_b64_tr_b16 a[218:219], v129 offset:8192
  ds_read_b64_tr_b16 a[220:221], v128 offset:12288
  ds_read_b64_tr_b16 a[222:223], v129 offset:12288
  ds_read_b64_tr_b16 a[224:225], v128 offset:16384
  ds_read_b64_tr_b16 a[226:227], v129 offset:16384
  ds_read_b64_tr_b16 a[228:229], v128 offset:20480
  ds_read_b64_tr_b16 a[230:231], v129 offset:20480
  ds_read_b64_tr_b16 a[232:233], v128 offset:24576
  ds_read_b64_tr_b16 a[234:235], v129 offset:24576
  ds_read_b64_tr_b16 a[236:237], v128 offset:28672
  ds_read_b64_tr_b16 a[238:239], v129 offset:28672
  ds_read_b64_tr_b16 a[240:241], v128 offset:32768
  ds_read_b64_tr_b16 a[242:243], v129 offset:32768
  ds_read_b64_tr_b16 a[244:245], v128 offset:36864
  ds_read_b64_tr_b16 a[246:247], v129 offset:36864
  ds_read_b64_tr_b16 a[248:249], v128 offset:40960
  ds_read_b64_tr_b16 a[250:251], v129 offset:40960
  ds_read_b64_tr_b16 a[252:253], v128 offset:45056
  ds_read_b64_tr_b16 a[254:255], v129 offset:45056
  ds_read_b64_tr_b16 v[224:225], v128 offset:49152
  ds_read_b64_tr_b16 v[226:227], v129 offset:49152
  ds_read_b64_tr_b16 v[228:229], v128 offset:53248
  ds_read_b64_tr_b16 v[230:231], v129 offset:53248
  ds_read_b64_tr_b16 v[232:233], v128 offset:57344
  ds_read_b64_tr_b16 v[234:235], v129 offset:57344
  ds_read_b64_tr_b16 v[236:237], v128 offset:61440
  ds_read_b64_tr_b16 v[238:239], v129 offset:61440
  ds_read_b64_tr_b16 v[240:241], v130 offset:0
  ds_read_b64_tr_b16 v[242:243], v131 offset:0
  ds_read_b64_tr_b16 v[244:245], v130 offset:4096
  ds_read_b64_tr_b16 v[246:247], v131 offset:4096
  ds_read_b64_tr_b16 v[248:249], v130 offset:8192
  ds_read_b64_tr_b16 v[250:251], v131 offset:8192
  ds_read_b64_tr_b16 v[252:253], v130 offset:12288
  ds_read_b64_tr_b16 v[254:255], v131 offset:12288
  s_mov_b32 s65, 1048576
POLLD_37:
  buffer_load_dword v7, off, s[48:51], 0 offset:64 sc1
  s_waitcnt vmcnt(0)
  v_readfirstlane_b32 s66, v7
  s_sub_u32 s65, s65, 1
  s_cbranch_scc1 POLLE_38
  s_cmp_lt_u32 s66, 32
  s_cbranch_scc1 POLLD_37
POLLE_38:
  v_lshlrev_b32 v7, 4, v0
  s_lshl_b32 s65, s5, 12
  s_add_u32 m0, s65, 147456
  s_add_u32 s65, s65, 113246208
  buffer_load_dwordx4 v7, s[52:55], s65 offen offset:0 sc1 lds
  buffer_load_dwordx4 v7, s[52:55], s65 offen offset:1024 sc1 lds
  buffer_load_dwordx4 v7, s[52:55], s65 offen offset:2048 sc1 lds
  buffer_load_dwordx4 v7, s[52:55], s65 offen offset:3072 sc1 lds
  s_waitcnt lgkmcnt(0)
  s_barrier
  s_add_u32 m0, s59, 73728
  s_add_u32 s65, s60, 0
  buffer_load_dwordx4 v4, s[8:11], s65 offen lds
  s_add_u32 m0, s59, 77824
  s_add_u32 s65, s60, 128
  buffer_load_dwordx4 v4, s[8:11], s65 offen lds
  s_add_u32 m0, s59, 81920
  s_add_u32 s65, s60, 256
  buffer_load_dwordx4 v4, s[8:11], s65 offen lds
  s_add_u32 m0, s59, 86016
  s_add_u32 s65, s60, 384
  buffer_load_dwordx4 v4, s[8:11], s65 offen lds
  s_add_u32 m0, s59, 90112
  s_add_u32 s65, s60, 512
  buffer_load_dwordx4 v4, s[8:11], s65 offen lds
  s_add_u32 m0, s59, 94208
  s_add_u32 s65, s60, 640
  buffer_load_dwordx4 v4, s[8:11], s65 offen lds
  s_add_u32 m0, s59, 98304
  s_add_u32 s65, s60, 768
  buffer_load_dwordx4 v4, s[8:11], s65 offen lds
  s_add_u32 m0, s59, 102400
  s_add_u32 s65, s60, 896
  buffer_load_dwordx4 v4, s[8:11], s65 offen lds
  s_add_u32 m0, s59, 106496
  s_add_u32 s65, s60, 1024
  buffer_load_dwordx4 v4, s[8:11], s65 offen lds
  s_add_u32 s60, s60, 36864
  v_mfma_f32_32x32x16_bf16 v[48:63], a[144:147], v[28:31], 0
  v_mfma_f32_32x32x16_bf16 v[48:63], a[148:151], v[28:31], v[48:63]
  v_mfma_f32_32x32x16_bf16 v[48:63], a[152:155], v[28:31], v[48:63]
  v_mfma_f32_32x32x16_bf16 v[48:63], a[156:159], v[28:31], v[48:63]
  v_mfma_f32_32x32x16_bf16 v[48:63], a[160:163], v[28:31], v[48:63]
  v_mfma_f32_32x32x16_bf16 v[48:63], a[164:167], v[28:31], v[48:63]
  v_mfma_f32_32x32x16_bf16 v[48:63], a[168:171], v[28:31], v[48:63]
  v_mfma_f32_32x32x16_bf16 v[48:63], a[172:175], v[28:31], v[48:63]
  v_mfma_f32_32x32x16_bf16 v[48:63], a[176:179], v[28:31], v[48:63]
  v_mfma_f32_32x32x16_bf16 v[48:63], a[180:183], v[28:31], v[48:63]
  v_mfma_f32_32x32x16_bf16 v[48:63], a[184:187], v[28:31], v[48:63]
  v_mfma_f32_32x32x16_bf16 v[48:63], a[188:191], v[28:31], v[48:63]
  v_mfma_f32_32x32x16_bf16 v[48:63], a[192:195], v[28:31], v[48:63]
  v_mfma_f32_32x32x16_bf16 v[48:63], a[196:199], v[28:31], v[48:63]
  v_mfma_f32_32x32x16_bf16 v[48:63], a[200:203], v[28:31], v[48:63]
  v_mfma_f32_32x32x16_bf16 v[48:63], a[204:207], v[28:31], v[48:63]
  v_mfma_f32_32x32x16_bf16 v[48:63], a[208:211], v[28:31], v[48:63]
  v_mfma_f32_32x32x16_bf16 v[48:63], a[212:215], v[28:31], v[48:63]
  v_mfma_f32_32x32x16_bf16 v[48:63], a[216:219], v[28:31], v[48:63]
  v_mfma_f32_32x32x16_bf16 v[48:63], a[220:223], v[28:31], v[48:63]
  v_mfma_f32_32x32x16_bf16 v[48:63], a[224:227], v[28:31], v[48:63]
  v_mfma_f32_32x32x16_bf16 v[48:63], a[228:231], v[28:31], v[48:63]
  v_mfma_f32_32x32x16_bf16 v[48:63], a[232:235], v[28:31], v[48:63]
  v_mfma_f32_32x32x16_bf16 v[48:63], a[236:239], v[28:31], v[48:63]
  v_mfma_f32_32x32x16_bf16 v[48:63], a[240:243], v[28:31], v[48:63]
  v_mfma_f32_32x32x16_bf16 v[48:63], a[244:247], v[28:31], v[48:63]
  v_mfma_f32_32x32x16_bf16 v[48:63], a[248:251], v[28:31], v[48:63]
  v_mfma_f32_32x32x16_bf16 v[48:63], a[252:255], v[28:31], v[48:63]
  v_mfma_f32_32x32x16_bf16 v[48:63], v[224:227], v[28:31], v[48:63]
  v_mfma_f32_32x32x16_bf16 v[48:63], v[228:231], v[28:31], v[48:63]
  v_mfma_f32_32x32x16_bf16 v[48:63], v[232:235], v[28:31], v[48:63]
  v_mfma_f32_32x32x16_bf16 v[48:63], v[236:239], v[28:31], v[48:63]
  v_mfma_f32_32x32x16_bf16 v[48:63], v[240:243], v[28:31], v[48:63]
  v_mfma_f32_32x32x16_bf16 v[48:63], v[244:247], v[28:31], v[48:63]
  v_mfma_f32_32x32x16_bf16 v[48:63], v[248:251], v[28:31], v[48:63]
  v_mfma_f32_32x32x16_bf16 v[48:63], v[252:255], v[28:31], v[48:63]
  s_mov_b32 s61, 0x10000000
  s_mov_b32 s62, 0x10000000
  s_mov_b32 s64, -1
  s_mov_b32 s57, 16
  s_waitcnt lgkmcnt(0)
  s_branch QKV_FIRST_40
QKV_LOOP_39:
  s_waitcnt vmcnt(9) lgkmcnt(0)
QKV_FIRST_40:
  s_barrier
  s_cmp_lg_u32 s5, 0
  s_cbranch_scc1 QF_41
  s_sub_i32 s65, s64, 0
  s_max_i32 s65, s65, 0
  v_mov_b32 v7, s65
  s_mov_b64 exec, 3
  buffer_store_dword v7, v11, s[52:55], s63 offen sc1
  s_mov_b64 exec, -1
QF_41:
  s_add_u32 s64, s64, 1
  ds_read_b128 v[128:131], v12 offset:0
  ds_read_b128 v[132:135], v13 offset:0
  ds_read_b128 v[136:139], v14 offset:0
  ds_read_b128 v[140:143], v15 offset:0
  ds_read_b128 v[144:147], v12 offset:4096
  s_waitcnt lgkmcnt(4)
  v_mfma_f32_32x32x16_bf16 v[64:79], a[0:3], v[128:131], 0
  ds_read2_b32 v[152:153], v6 offset0:0 offset1:32
  v_add_u32 v6, 256, v6
  v_mfma_f32_32x32x16_bf16 v[80:95], a[144:147], v[128:131], 0
  ds_read_b128 v[148:151], v13 offset:4096
  s_waitcnt lgkmcnt(1)
  v_fma_f32 v96, -v152, v32, v96
  v_fma_f32 v97, -v152, v33, v97
  v_mfma_f32_32x32x16_bf16 v[64:79], a[4:7], v[132:135], v[64:79]
  v_mul_f32 v96, v153, v96
  v_mul_f32 v97, v153, v97
  v_mfma_f32_32x32x16_bf16 v[80:95], a[148:151], v[132:135], v[80:95]
  ds_read_b128 v[128:131], v14 offset:4096
  v_cvt_pk_bf16_f32 v184, v96, v97
  v_fma_f32 v98, -v152, v34, v98
  v_mfma_f32_32x32x16_bf16 v[64:79], a[8:11], v[136:139], v[64:79]
  v_fma_f32 v99, -v152, v35, v99
  v_mul_f32 v98, v153, v98
  v_mfma_f32_32x32x16_bf16 v[80:95], a[152:155], v[136:139], v[80:95]
  ds_read_b128 v[132:135], v15 offset:4096
  v_mul_f32 v99, v153, v99
  v_cvt_pk_bf16_f32 v185, v98, v99
  v_mfma_f32_32x32x16_bf16 v[64:79], a[12:15], v[140:143], v[64:79]
  v_fma_f32 v100, -v152, v36, v100
  v_fma_f32 v101, -v152, v37, v101
  v_mfma_f32_32x32x16_bf16 v[80:95], a[156:159], v[140:143], v[80:95]
  ds_read_b128 v[136:139], v12 offset:8192
  v_mul_f32 v100, v153, v100
  v_mul_f32 v101, v153, v101
  v_mfma_f32_32x32x16_bf16 v[64:79], a[16:19], v[144:147], v[64:79]
  v_cvt_pk_bf16_f32 v186, v100, v101
  v_fma_f32 v102, -v152, v38, v102
  v_mfma_f32_32x32x16_bf16 v[80:95], a[160:163], v[144:147], v[80:95]
  ds_read_b128 v[140:143], v13 offset:8192
  v_fma_f32 v103, -v152, v39, v103
  s_waitcnt lgkmcnt(4)
  v_mfma_f32_32x32x16_bf16 v[64:79], a[20:23], v[148:151], v[64:79]
  v_mul_f32 v102, v153, v102
  v_mul_f32 v103, v153, v103
  v_mfma_f32_32x32x16_bf16 v[80:95], a[164:167], v[148:151], v[80:95]
  ds_read_b128 v[144:147], v14 offset:8192
  v_cvt_pk_bf16_f32 v187, v102, v103
  buffer_store_dwordx4 v[184:187], v5, s[52:55], s61 offen offset:0 sc1
  s_waitcnt lgkmcnt(4)
  v_mfma_f32_32x32x16_bf16 v[64:79], a[24:27], v[128:131], v[64:79]
  v_fma_f32 v104, -v152, v40, v104
  v_fma_f32 v105, -v152, v41, v105
  v_mfma_f32_32x32x16_bf16 v[80:95], a[168:171], v[128:131], v[80:95]
  ds_read_b128 v[148:151], v15 offset:8192
  v_mul_f32 v104, v153, v104
  v_mul_f32 v105, v153, v105
  s_waitcnt lgkmcnt(4)
  v_mfma_f32_32x32x16_bf16 v[64:79], a[28:31], v[132:135], v[64:79]
  v_cvt_pk_bf16_f32 v188, v104, v105
  v_fma_f32 v106, -v152, v42, v106
  v_mfma_f32_32x32x16_bf16 v[80:95], a[172:175], v[132:135], v[80:95]
  ds_read_b128 v[128:131], v12 offset:12288
  v_fma_f32 v107, -v152, v43, v107
  v_mul_f32 v106, v153, v106
  s_waitcnt lgkmcnt(4)
  v_mfma_f32_32x32x16_bf16 v[64:79], a[32:35], v[136:139], v[64:79]
  v_mul_f32 v107, v153, v107
  v_cvt_pk_bf16_f32 v189, v106, v107
  v_mfma_f32_32x32x16_bf16 v[80:95], a[176:179], v[136:139], v[80:95]
  ds_read_b128 v[132:135], v13 offset:12288
  v_fma_f32 v108, -v152, v44, v108
  v_fma_f32 v109, -v152, v45, v109
  s_waitcnt lgkmcnt(4)
  v_mfma_f32_32x32x16_bf16 v[64:79], a[36:39], v[140:143], v[64:79]
  v_mul_f32 v108, v153, v108
  v_mfma_f32_32x32x16_bf16 v[80:95], a[180:183], v[140:143], v[80:95]
  ds_read_b128 v[136:139], v14 offset:12288
  v_mul_f32 v109, v153, v109
  v_cvt_pk_bf16_f32 v190, v108, v109
  s_waitcnt lgkmcnt(4)
  v_mfma_f32_32x32x16_bf16 v[64:79], a[40:43], v[144:147], v[64:79]
  v_fma_f32 v110, -v152, v46, v110
  v_fma_f32 v111, -v152, v47, v111
  v_mfma_f32_32x32x16_bf16 v[80:95], a[184:187], v[144:147], v[80:95]
  ds_read_b128 v[140:143], v15 offset:12288
  v_mul_f32 v110, v153, v110
  v_mul_f32 v111, v153, v111
  s_waitcnt lgkmcnt(4)
  v_mfma_f32_32x32x16_bf16 v[64:79], a[44:47], v[148:151], v[64:79]
  v_cvt_pk_bf16_f32 v191, v110, v111
  buffer_store_dwordx4 v[188:191], v5, s[52:55], s61 offen offset:512 sc1
  v_mfma_f32_32x32x16_bf16 v[80:95], a[188:191], v[148:151], v[80:95]
  ds_read_b128 v[144:147], v12 offset:16384
  v_fma_f32 v112, -v152, v48, v112
  v_fma_f32 v113, -v152, v49, v113
  s_waitcnt lgkmcnt(4)
  v_mfma_f32_32x32x16_bf16 v[64:79], a[48:51], v[128:131], v[64:79]
  v_mul_f32 v112, v153, v112
  v_mul_f32 v113, v153, v113
  v_mfma_f32_32x32x16_bf16 v[80:95], a[192:195], v[128:131], v[80:95]
  ds_read_b128 v[148:151], v13 offset:16384
  v_cvt_pk_bf16_f32 v192, v112, v113
  v_fma_f32 v114, -v152, v50, v114
  s_waitcnt lgkmcnt(4)
  v_mfma_f32_32x32x16_bf16 v[64:79], a[52:55], v[132:135], v[64:79]
  v_fma_f32 v115, -v152, v51, v115
  v_mul_f32 v114, v153, v114
  v_mfma_f32_32x32x16_bf16 v[80:95], a[196:199], v[132:135], v[80:95]
  ds_read_b128 v[128:131], v14 offset:16384
  v_mul_f32 v115, v153, v115
  s_waitcnt lgkmcnt(4)
  v_mfma_f32_32x32x16_bf16 v[64:79], a[56:59], v[136:139], v[64:79]
  v_cvt_pk_bf16_f32 v193, v114, v115
  v_fma_f32 v116, -v152, v52, v116
  v_mfma_f32_32x32x16_bf16 v[80:95], a[200:203], v[136:139], v[80:95]
  ds_read_b128 v[132:135], v15 offset:16384
  v_fma_f32 v117, -v152, v53, v117
  v_mul_f32 v116, v153, v116
  s_waitcnt lgkmcnt(4)
  v_mfma_f32_32x32x16_bf16 v[64:79], a[60:63], v[140:143], v[64:79]
  v_mul_f32 v117, v153, v117
  v_cvt_pk_bf16_f32 v194, v116, v117
  v_mfma_f32_32x32x16_bf16 v[80:95], a[204:207], v[140:143], v[80:95]
  ds_read_b128 v[136:139], v12 offset:20480
  v_fma_f32 v118, -v152, v54, v118
  v_fma_f32 v119, -v152, v55, v119
  s_waitcnt lgkmcnt(4)
  v_mfma_f32_32x32x16_bf16 v[64:79], a[64:67], v[144:147], v[64:79]
  v_mul_f32 v118, v153, v118
  v_mul_f32 v119, v153, v119
  v_mfma_f32_32x32x16_bf16 v[80:95], a[208:211], v[144:147], v[80:95]
  ds_read_b128 v[140:143], v13 offset:20480
  v_cvt_pk_bf16_f32 v195, v118, v119
  buffer_store_dwordx4 v[192:195], v5, s[52:55], s62 offen offset:0 sc1
  s_waitcnt lgkmcnt(4)
  v_mfma_f32_32x32x16_bf16 v[64:79], a[68:71], v[148:151], v[64:79]
  v_fma_f32 v120, -v152, v56, v120
  v_fma_f32 v121, -v152, v57, v121
  v_mfma_f32_32x32x16_bf16 v[80:95], a[212:215], v[148:151], v[80:95]
  ds_read_b128 v[144:147], v14 offset:20480
  v_mul_f32 v120, v153, v120
  v_mul_f32 v121, v153, v121
  s_waitcnt lgkmcnt(4)
  v_mfma_f32_32x32x16_bf16 v[64:79], a[72:75], v[128:131], v[64:79]
  v_cvt_pk_bf16_f32 v196, v120, v121
  v_mfma_f32_32x32x16_bf16 v[80:95], a[216:219], v[128:131], v[80:95]
  ds_read_b128 v[148:151], v15 offset:20480
  v_fma_f32 v122, -v152, v58, v122
  v_fma_f32 v123, -v152, v59, v123
  s_waitcnt lgkmcnt(4)
  v_mfma_f32_32x32x16_bf16 v[64:79], a[76:79], v[132:135], v[64:79]
  v_mul_f32 v122, v153, v122
  v_mul_f32 v123, v153, v123
  v_mfma_f32_32x32x16_bf16 v[80:95], a[220:223], v[132:135], v[80:95]
  ds_read_b128 v[128:131], v12 offset:24576
  v_cvt_pk_bf16_f32 v197, v122, v123
  v_fma_f32 v124, -v152, v60, v124
  s_waitcnt lgkmcnt(4)
  v_mfma_f32_32x32x16_bf16 v[64:79], a[80:83], v[136:139], v[64:79]
  v_fma_f32 v125, -v152, v61, v125
  v_mul_f32 v124, v153, v124
  v_mfma_f32_32x32x16_bf16 v[80:95], a[224:227], v[136:139], v[80:95]
  ds_read_b128 v[132:135], v13 offset:24576
  v_mul_f32 v125, v153, v125
  v_cvt_pk_bf16_f32 v198, v124, v125
  s_waitcnt lgkmcnt(4)
  v_mfma_f32_32x32x16_bf16 v[64:79], a[84:87], v[140:143], v[64:79]
  v_fma_f32 v126, -v152, v62, v126
  v_fma_f32 v127, -v152, v63, v127
  v_mfma_f32_32x32x16_bf16 v[80:95], a[228:231], v[140:143], v[80:95]
  ds_read_b128 v[136:139], v14 offset:24576
  v_mul_f32 v126, v153, v126
  v_mul_f32 v127, v153, v127
  s_waitcnt lgkmcnt(4)
  v_mfma_f32_32x32x16_bf16 v[64:79], a[88:91], v[144:147], v[64:79]
  v_cvt_pk_bf16_f32 v199, v126, v127
  buffer_store_dwordx4 v[196:199], v5, s[52:55], s62 offen offset:512 sc1
  v_mfma_f32_32x32x16_bf16 v[80:95], a[232:235], v[144:147], v[80:95]
  ds_read_b128 v[140:143], v15 offset:24576
  s_lshl_b32 s61, s64, 18
  s_lshl_b32 s66, s56, 13
  s_add_u32 s66, s66, 0
  s_add_u32 s61, s61, s66
  s_add_u32 s62, s61, 16777216
  s_waitcnt lgkmcnt(4)
  v_mfma_f32_32x32x16_bf16 v[64:79], a[92:95], v[148:151], v[64:79]
  v_mfma_f32_32x32x16_bf16 v[80:95], a[236:239], v[148:151], v[80:95]
  ds_read_b128 v[144:147], v12 offset:28672
  s_waitcnt lgkmcnt(4)
  v_mfma_f32_32x32x16_bf16 v[64:79], a[96:99], v[128:131], v[64:79]
  s_add_u32 m0, s59, 110592
  s_add_u32 s65, s60, 0
  buffer_load_dwordx4 v4, s[8:11], s65 offen lds
  v_mfma_f32_32x32x16_bf16 v[80:95], a[240:243], v[128:131], v[80:95]
  ds_read_b128 v[148:151], v13 offset:28672
  s_waitcnt lgkmcnt(4)
  v_mfma_f32_32x32x16_bf16 v[64:79], a[100:103], v[132:135], v[64:79]
  s_add_u32 m0, s59, 114688
  s_add_u32 s65, s60, 128
  buffer_load_dwordx4 v4, s[8:11], s65 offen lds
  v_mfma_f32_32x32x16_bf16 v[80:95], a[244:247], v[132:135], v[80:95]
  ds_read_b128 v[128:131], v14 offset:28672
  s_waitcnt lgkmcnt(4)
  v_mfma_f32_32x32x16_bf16 v[64:79], a[104:107], v[136:139], v[64:79]
  s_add_u32 m0, s59, 118784
  s_add_u32 s65, s60, 256
  buffer_load_dwordx4 v4, s[8:11], s65 offen lds
  v_mfma_f32_32x32x16_bf16 v[80:95], a[248:251], v[136:139], v[80:95]
  ds_read_b128 v[132:135], v15 offset:28672
  s_waitcnt lgkmcnt(4)
  v_mfma_f32_32x32x16_bf16 v[64:79], a[108:111], v[140:143], v[64:79]
  s_add_u32 m0, s59, 122880
  s_add_u32 s65, s60, 384
  buffer_load_dwordx4 v4, s[8:11], s65 offen lds
  v_mfma_f32_32x32x16_bf16 v[80:95], a[252:255], v[140:143], v[80:95]
  ds_read_b128 v[136:139], v12 offset:32768
  s_waitcnt lgkmcnt(4)
  v_mfma_f32_32x32x16_bf16 v[64:79], a[112:115], v[144:147], v[64:79]
  s_add_u32 m0, s59, 126976
  s_add_u32 s65, s60, 512
  buffer_load_dwordx4 v4, s[8:11], s65 offen lds
  v_mfma_f32_32x32x16_bf16 v[80:95], v[224:227], v[144:147], v[80:95]
  ds_read_b128 v[140:143], v13 offset:32768
  s_waitcnt lgkmcnt(4)
  v_mfma_f32_32x32x16_bf16 v[64:79], a[116:119], v[148:151], v[64:79]
  s_add_u32 m0, s59, 131072
  s_add_u32 s65, s60, 640
  buffer_load_dwordx4 v4, s[8:11], s65 offen lds
  v_mfma_f32_32x32x16_bf16 v[80:95], v[228:231], v[148:151], v[80:95]
  ds_read_b128 v[144:147], v14 offset:32768
  s_waitcnt lgkmcnt(4)
  v_mfma_f32_32x32x16_bf16 v[64:79], a[120:123], v[128:131], v[64:79]
  s_add_u32 m0, s59, 135168
  s_add_u32 s65, s60, 768
  buffer_load_dwordx4 v4, s[8:11], s65 offen lds
  v_mfma_f32_32x32x16_bf16 v[80:95], v[232:235], v[128:131], v[80:95]
  ds_read_b128 v[148:151], v15 offset:32768
  s_waitcnt lgkmcnt(4)
  v_mfma_f32_32x32x16_bf16 v[64:79], a[124:127], v[132:135], v[64:79]
  s_add_u32 m0, s59, 139264
  s_add_u32 s65, s60, 896
  buffer_load_dwordx4 v4, s[8:11], s65 offen lds
  v_mfma_f32_32x32x16_bf16 v[80:95], v[236:239], v[132:135], v[80:95]
  s_waitcnt lgkmcnt(3)
  v_mfma_f32_32x32x16_bf16 v[64:79], a[128:131], v[136:139], v[64:79]
  s_add_u32 m0, s59, 143360
  s_add_u32 s65, s60, 1024
  buffer_load_dwordx4 v4, s[8:11], s65 offen lds
  v_mfma_f32_32x32x16_bf16 v[80:95], v[240:243], v[136:139], v[80:95]
  s_waitcnt lgkmcnt(2)
  v_mfma_f32_32x32x16_bf16 v[64:79], a[132:135], v[140:143], v[64:79]
  s_add_u32 s60, s60, 36864
  v_mfma_f32_32x32x16_bf16 v[80:95], v[244:247], v[140:143], v[80:95]
  s_waitcnt lgkmcnt(1)
  v_mfma_f32_32x32x16_bf16 v[64:79], a[136:139], v[144:147], v[64:79]
  v_mfma_f32_32x32x16_bf16 v[80:95], v[248:251], v[144:147], v[80:95]
  s_waitcnt lgkmcnt(0)
  v_mfma_f32_32x32x16_bf16 v[64:79], a[140:143], v[148:151], v[64:79]
  v_mfma_f32_32x32x16_bf16 v[80:95], v[252:255], v[148:151], v[80:95]
  s_waitcnt vmcnt(9) lgkmcnt(0)
  s_barrier
  s_cmp_lg_u32 s5, 0
  s_cbranch_scc1 QF_42
  s_sub_i32 s65, s64, 0
  s_max_i32 s65, s65, 0
  v_mov_b32 v7, s65
  s_mov_b64 exec, 3
  buffer_store_dword v7, v11, s[52:55], s63 offen sc1
  s_mov_b64 exec, -1
QF_42:
  s_add_u32 s64, s64, 1
  ds_read_b128 v[128:131], v16 offset:0
  ds_read_b128 v[132:135], v17 offset:0
  ds_read_b128 v[136:139], v18 offset:0
  ds_read_b128 v[140:143], v19 offset:0
  ds_read_b128 v[144:147], v16 offset:4096
  s_waitcnt lgkmcnt(4)
  v_mfma_f32_32x32x16_bf16 v[96:111], a[0:3], v[128:131], 0
  ds_read2_b32 v[152:153], v6 offset0:0 offset1:32
  v_add_u32 v6, 256, v6
  v_mfma_f32_32x32x16_bf16 v[112:127], a[144:147], v[128:131], 0
  ds_read_b128 v[148:151], v17 offset:4096
  s_waitcnt lgkmcnt(1)
  v_fma_f32 v64, -v152, v32, v64
  v_fma_f32 v65, -v152, v33, v65
  v_mfma_f32_32x32x16_bf16 v[96:111], a[4:7], v[132:135], v[96:111]
  v_mul_f32 v64, v153, v64
  v_mul_f32 v65, v153, v65
  v_mfma_f32_32x32x16_bf16 v[112:127], a[148:151], v[132:135], v[112:127]
  ds_read_b128 v[128:131], v18 offset:4096
  v_cvt_pk_bf16_f32 v184, v64, v65
  v_fma_f32 v66, -v152, v34, v66
  v_mfma_f32_32x32x16_bf16 v[96:111], a[8:11], v[136:139], v[96:111]
  v_fma_f32 v67, -v152, v35, v67
  v_mul_f32 v66, v153, v66
  v_mfma_f32_32x32x16_bf16 v[112:127], a[152:155], v[136:139], v[112:127]
  ds_read_b128 v[132:135], v19 offset:4096
  v_mul_f32 v67, v153, v67
  v_cvt_pk_bf16_f32 v185, v66, v67
  v_mfma_f32_32x32x16_bf16 v[96:111], a[12:15], v[140:143], v[96:111]
  v_fma_f32 v68, -v152, v36, v68
  v_fma_f32 v69, -v152, v37, v69
  v_mfma_f32_32x32x16_bf16 v[112:127], a[156:159], v[140:143], v[112:127]
  ds_read_b128 v[136:139], v16 offset:8192
  v_mul_f32 v68, v153, v68
  v_mul_f32 v69, v153, v69
  v_mfma_f32_32x32x16_bf16 v[96:111], a[16:19], v[144:147], v[96:111]
  v_cvt_pk_bf16_f32 v186, v68, v69
  v_fma_f32 v70, -v152, v38, v70
  v_mfma_f32_32x32x16_bf16 v[112:127], a[160:163], v[144:147], v[112:127]
  ds_read_b128 v[140:143], v17 offset:8192
  v_fma_f32 v71, -v152, v39, v71
  s_waitcnt lgkmcnt(4)
  v_mfma_f32_32x32x16_bf16 v[96:111], a[20:23], v[148:151], v[96:111]
  v_mul_f32 v70, v153, v70
  v_mul_f32 v71, v153, v71
  v_mfma_f32_32x32x16_bf16 v[112:127], a[164:167], v[148:151], v[112:127]
  ds_read_b128 v[144:147], v18 offset:8192
  v_cvt_pk_bf16_f32 v187, v70, v71
  buffer_store_dwordx4 v[184:187], v5, s[52:55], s61 offen offset:0 sc1
  s_waitcnt lgkmcnt(4)
  v_mfma_f32_32x32x16_bf16 v[96:111], a[24:27], v[128:131], v[96:111]
  v_fma_f32 v72, -v152, v40, v72
  v_fma_f32 v73, -v152, v41, v73
  v_mfma_f32_32x32x16_bf16 v[112:127], a[168:171], v[128:131], v[112:127]
  ds_read_b128 v[148:151], v19 offset:8192
  v_mul_f32 v72, v153, v72
  v_mul_f32 v73, v153, v73
  s_waitcnt lgkmcnt(4)
  v_mfma_f32_32x32x16_bf16 v[96:111], a[28:31], v[132:135], v[96:111]
  v_cvt_pk_bf16_f32 v188, v72, v73
  v_fma_f32 v74, -v152, v42, v74
  v_mfma_f32_32x32x16_bf16 v[112:127], a[172:175], v[132:135], v[112:127]
  ds_read_b128 v[128:131], v16 offset:12288
  v_fma_f32 v75, -v152, v43, v75
  v_mul_f32 v74, v153, v74
  s_waitcnt lgkmcnt(4)
  v_mfma_f32_32x32x16_bf16 v[96:111], a[32:35], v[136:139], v[96:111]
  v_mul_f32 v75, v153, v75
  v_cvt_pk_bf16_f32 v189, v74, v75
  v_mfma_f32_32x32x16_bf16 v[112:127], a[176:179], v[136:139], v[112:127]
  ds_read_b128 v[132:135], v17 offset:12288
  v_fma_f32 v76, -v152, v44, v76
  v_fma_f32 v77, -v152, v45, v77
  s_waitcnt lgkmcnt(4)
  v_mfma_f32_32x32x16_bf16 v[96:111], a[36:39], v[140:143], v[96:111]
  v_mul_f32 v76, v153, v76
  v_mfma_f32_32x32x16_bf16 v[112:127], a[180:183], v[140:143], v[112:127]
  ds_read_b128 v[136:139], v18 offset:12288
  v_mul_f32 v77, v153, v77
  v_cvt_pk_bf16_f32 v190, v76, v77
  s_waitcnt lgkmcnt(4)
  v_mfma_f32_32x32x16_bf16 v[96:111], a[40:43], v[144:147], v[96:111]
  v_fma_f32 v78, -v152, v46, v78
  v_fma_f32 v79, -v152, v47, v79
  v_mfma_f32_32x32x16_bf16 v[112:127], a[184:187], v[144:147], v[112:127]
  ds_read_b128 v[140:143], v19 offset:12288
  v_mul_f32 v78, v153, v78
  v_mul_f32 v79, v153, v79
  s_waitcnt lgkmcnt(4)
  v_mfma_f32_32x32x16_bf16 v[96:111], a[44:47], v[148:151], v[96:111]
  v_cvt_pk_bf16_f32 v191, v78, v79
  buffer_store_dwordx4 v[188:191], v5, s[52:55], s61 offen offset:512 sc1
  v_mfma_f32_32x32x16_bf16 v[112:127], a[188:191], v[148:151], v[112:127]
  ds_read_b128 v[144:147], v16 offset:16384
  v_fma_f32 v80, -v152, v48, v80
  v_fma_f32 v81, -v152, v49, v81
  s_waitcnt lgkmcnt(4)
  v_mfma_f32_32x32x16_bf16 v[96:111], a[48:51], v[128:131], v[96:111]
  v_mul_f32 v80, v153, v80
  v_mul_f32 v81, v153, v81
  v_mfma_f32_32x32x16_bf16 v[112:127], a[192:195], v[128:131], v[112:127]
  ds_read_b128 v[148:151], v17 offset:16384
  v_cvt_pk_bf16_f32 v192, v80, v81
  v_fma_f32 v82, -v152, v50, v82
  s_waitcnt lgkmcnt(4)
  v_mfma_f32_32x32x16_bf16 v[96:111], a[52:55], v[132:135], v[96:111]
  v_fma_f32 v83, -v152, v51, v83
  v_mul_f32 v82, v153, v82
  v_mfma_f32_32x32x16_bf16 v[112:127], a[196:199], v[132:135], v[112:127]
  ds_read_b128 v[128:131], v18 offset:16384
  v_mul_f32 v83, v153, v83
  s_waitcnt lgkmcnt(4)
  v_mfma_f32_32x32x16_bf16 v[96:111], a[56:59], v[136:139], v[96:111]
  v_cvt_pk_bf16_f32 v193, v82, v83
  v_fma_f32 v84, -v152, v52, v84
  v_mfma_f32_32x32x16_bf16 v[112:127], a[200:203], v[136:139], v[112:127]
  ds_read_b128 v[132:135], v19 offset:16384
  v_fma_f32 v85, -v152, v53, v85
  v_mul_f32 v84, v153, v84
  s_waitcnt lgkmcnt(4)
  v_mfma_f32_32x32x16_bf16 v[96:111], a[60:63], v[140:143], v[96:111]
  v_mul_f32 v85, v153, v85
  v_cvt_pk_bf16_f32 v194, v84, v85
  v_mfma_f32_32x32x16_bf16 v[112:127], a[204:207], v[140:143], v[112:127]
  ds_read_b128 v[136:139], v16 offset:20480
  v_fma_f32 v86, -v152, v54, v86
  v_fma_f32 v87, -v152, v55, v87
  s_waitcnt lgkmcnt(4)
  v_mfma_f32_32x32x16_bf16 v[96:111], a[64:67], v[144:147], v[96:111]
  v_mul_f32 v86, v153, v86
  v_mul_f32 v87, v153, v87
  v_mfma_f32_32x32x16_bf16 v[112:127], a[208:211], v[144:147], v[112:127]
  ds_read_b128 v[140:143], v17 offset:20480
  v_cvt_pk_bf16_f32 v195, v86, v87
  buffer_store_dwordx4 v[192:195], v5, s[52:55], s62 offen offset:0 sc1
  s_waitcnt lgkmcnt(4)
  v_mfma_f32_32x32x16_bf16 v[96:111], a[68:71], v[148:151], v[96:111]
  v_fma_f32 v88, -v152, v56, v88
  v_fma_f32 v89, -v152, v57, v89
  v_mfma_f32_32x32x16_bf16 v[112:127], a[212:215], v[148:151], v[112:127]
  ds_read_b128 v[144:147], v18 offset:20480
  v_mul_f32 v88, v153, v88
  v_mul_f32 v89, v153, v89
  s_waitcnt lgkmcnt(4)
  v_mfma_f32_32x32x16_bf16 v[96:111], a[72:75], v[128:131], v[96:111]
  v_cvt_pk_bf16_f32 v196, v88, v89
  v_mfma_f32_32x32x16_bf16 v[112:127], a[216:219], v[128:131], v[112:127]
  ds_read_b128 v[148:151], v19 offset:20480
  v_fma_f32 v90, -v152, v58, v90
  v_fma_f32 v91, -v152, v59, v91
  s_waitcnt lgkmcnt(4)
  v_mfma_f32_32x32x16_bf16 v[96:111], a[76:79], v[132:135], v[96:111]
  v_mul_f32 v90, v153, v90
  v_mul_f32 v91, v153, v91
  v_mfma_f32_32x32x16_bf16 v[112:127], a[220:223], v[132:135], v[112:127]
  ds_read_b128 v[128:131], v16 offset:24576
  v_cvt_pk_bf16_f32 v197, v90, v91
  v_fma_f32 v92, -v152, v60, v92
  s_waitcnt lgkmcnt(4)
  v_mfma_f32_32x32x16_bf16 v[96:111], a[80:83], v[136:139], v[96:111]
  v_fma_f32 v93, -v152, v61, v93
  v_mul_f32 v92, v153, v92
  v_mfma_f32_32x32x16_bf16 v[112:127], a[224:227], v[136:139], v[112:127]
  ds_read_b128 v[132:135], v17 offset:24576
  v_mul_f32 v93, v153, v93
  v_cvt_pk_bf16_f32 v198, v92, v93
  s_waitcnt lgkmcnt(4)
  v_mfma_f32_32x32x16_bf16 v[96:111], a[84:87], v[140:143], v[96:111]
  v_fma_f32 v94, -v152, v62, v94
  v_fma_f32 v95, -v152, v63, v95
  v_mfma_f32_32x32x16_bf16 v[112:127], a[228:231], v[140:143], v[112:127]
  ds_read_b128 v[136:139], v18 offset:24576
  v_mul_f32 v94, v153, v94
  v_mul_f32 v95, v153, v95
  s_waitcnt lgkmcnt(4)
  v_mfma_f32_32x32x16_bf16 v[96:111], a[88:91], v[144:147], v[96:111]
  v_cvt_pk_bf16_f32 v199, v94, v95
  buffer_store_dwordx4 v[196:199], v5, s[52:55], s62 offen offset:512 sc1
  v_mfma_f32_32x32x16_bf16 v[112:127], a[232:235], v[144:147], v[112:127]
  ds_read_b128 v[140:143], v19 offset:24576
  s_lshl_b32 s61, s64, 18
  s_lshl_b32 s66, s56, 13
  s_add_u32 s66, s66, 0
  s_add_u32 s61, s61, s66
  s_add_u32 s62, s61, 16777216
  s_waitcnt lgkmcnt(4)
  v_mfma_f32_32x32x16_bf16 v[96:111], a[92:95], v[148:151], v[96:111]
  v_mfma_f32_32x32x16_bf16 v[112:127], a[236:239], v[148:151], v[112:127]
  ds_read_b128 v[144:147], v16 offset:28672
  s_waitcnt lgkmcnt(4)
  v_mfma_f32_32x32x16_bf16 v[96:111], a[96:99], v[128:131], v[96:111]
  s_add_u32 m0, s59, 0
  s_add_u32 s65, s60, 0
  buffer_load_dwordx4 v4, s[8:11], s65 offen lds
  v_mfma_f32_32x32x16_bf16 v[112:127], a[240:243], v[128:131], v[112:127]
  ds_read_b128 v[148:151], v17 offset:28672
  s_waitcnt lgkmcnt(4)
  v_mfma_f32_32x32x16_bf16 v[96:111], a[100:103], v[132:135], v[96:111]
  s_add_u32 m0, s59, 4096
  s_add_u32 s65, s60, 128
  buffer_load_dwordx4 v4, s[8:11], s65 offen lds
  v_mfma_f32_32x32x16_bf16 v[112:127], a[244:247], v[132:135], v[112:127]
  ds_read_b128 v[128:131], v18 offset:28672
  s_waitcnt lgkmcnt(4)
  v_mfma_f32_32x32x16_bf16 v[96:111], a[104:107], v[136:139], v[96:111]
  s_add_u32 m0, s59, 8192
  s_add_u32 s65, s60, 256
  buffer_load_dwordx4 v4, s[8:11], s65 offen lds
  v_mfma_f32_32x32x16_bf16 v[112:127], a[248:251], v[136:139], v[112:127]
  ds_read_b128 v[132:135], v19 offset:28672
  s_waitcnt lgkmcnt(4)
  v_mfma_f32_32x32x16_bf16 v[96:111], a[108:111], v[140:143], v[96:111]
  s_add_u32 m0, s59, 12288
  s_add_u32 s65, s60, 384
  buffer_load_dwordx4 v4, s[8:11], s65 offen lds
  v_mfma_f32_32x32x16_bf16 v[112:127], a[252:255], v[140:143], v[112:127]
  ds_read_b128 v[136:139], v16 offset:32768
  s_waitcnt lgkmcnt(4)
  v_mfma_f32_32x32x16_bf16 v[96:111], a[112:115], v[144:147], v[96:111]
  s_add_u32 m0, s59, 16384
  s_add_u32 s65, s60, 512
  buffer_load_dwordx4 v4, s[8:11], s65 offen lds
  v_mfma_f32_32x32x16_bf16 v[112:127], v[224:227], v[144:147], v[112:127]
  ds_read_b128 v[140:143], v17 offset:32768
  s_waitcnt lgkmcnt(4)
  v_mfma_f32_32x32x16_bf16 v[96:111], a[116:119], v[148:151], v[96:111]
  s_add_u32 m0, s59, 20480
  s_add_u32 s65, s60, 640
  buffer_load_dwordx4 v4, s[8:11], s65 offen lds
  v_mfma_f32_32x32x16_bf16 v[112:127], v[228:231], v[148:151], v[112:127]
  ds_read_b128 v[144:147], v18 offset:32768
  s_waitcnt lgkmcnt(4)
  v_mfma_f32_32x32x16_bf16 v[96:111], a[120:123], v[128:131], v[96:111]
  s_add_u32 m0, s59, 24576
  s_add_u32 s65, s60, 768
  buffer_load_dwordx4 v4, s[8:11], s65 offen lds
  v_mfma_f32_32x32x16_bf16 v[112:127], v[232:235], v[128:131], v[112:127]
  ds_read_b128 v[148:151], v19 offset:32768
  s_waitcnt lgkmcnt(4)
  v_mfma_f32_32x32x16_bf16 v[96:111], a[124:127], v[132:135], v[96:111]
  s_add_u32 m0, s59, 28672
  s_add_u32 s65, s60, 896
  buffer_load_dwordx4 v4, s[8:11], s65 offen lds
  v_mfma_f32_32x32x16_bf16 v[112:127], v[236:239], v[132:135], v[112:127]
  s_waitcnt lgkmcnt(3)
  v_mfma_f32_32x32x16_bf16 v[96:111], a[128:131], v[136:139], v[96:111]
  s_add_u32 m0, s59, 32768
  s_add_u32 s65, s60, 1024
  buffer_load_dwordx4 v4, s[8:11], s65 offen lds
  v_mfma_f32_32x32x16_bf16 v[112:127], v[240:243], v[136:139], v[112:127]
  s_waitcnt lgkmcnt(2)
  v_mfma_f32_32x32x16_bf16 v[96:111], a[132:135], v[140:143], v[96:111]
  s_add_u32 s60, s60, 36864
  v_mfma_f32_32x32x16_bf16 v[112:127], v[244:247], v[140:143], v[112:127]
  s_waitcnt lgkmcnt(1)
  v_mfma_f32_32x32x16_bf16 v[96:111], a[136:139], v[144:147], v[96:111]
  v_mfma_f32_32x32x16_bf16 v[112:127], v[248:251], v[144:147], v[112:127]
  s_waitcnt lgkmcnt(0)
  v_mfma_f32_32x32x16_bf16 v[96:111], a[140:143], v[148:151], v[96:111]
  v_mfma_f32_32x32x16_bf16 v[112:127], v[252:255], v[148:151], v[112:127]
  s_waitcnt vmcnt(9) lgkmcnt(0)
  s_barrier
  s_cmp_lg_u32 s5, 0
  s_cbranch_scc1 QF_43
  s_sub_i32 s65, s64, 0
  s_max_i32 s65, s65, 0
  v_mov_b32 v7, s65
  s_mov_b64 exec, 3
  buffer_store_dword v7, v11, s[52:55], s63 offen sc1
  s_mov_b64 exec, -1
QF_43:
  s_add_u32 s64, s64, 1
  ds_read_b128 v[128:131], v20 offset:0
  ds_read_b128 v[132:135], v21 offset:0
  ds_read_b128 v[136:139], v22 offset:0
  ds_read_b128 v[140:143], v23 offset:0
  ds_read_b128 v[144:147], v20 offset:4096
  s_waitcnt lgkmcnt(4)
  v_mfma_f32_32x32x16_bf16 v[64:79], a[0:3], v[128:131], 0
  ds_read2_b32 v[152:153], v6 offset0:0 offset1:32
  v_add_u32 v6, 256, v6
  v_mfma_f32_32x32x16_bf16 v[80:95], a[144:147], v[128:131], 0
  ds_read_b128 v[148:151], v21 offset:4096
  s_waitcnt lgkmcnt(1)
  v_fma_f32 v96, -v152, v32, v96
  v_fma_f32 v97, -v152, v33, v97
  v_mfma_f32_32x32x16_bf16 v[64:79], a[4:7], v[132:135], v[64:79]
  v_mul_f32 v96, v153, v96
  v_mul_f32 v97, v153, v97
  v_mfma_f32_32x32x16_bf16 v[80:95], a[148:151], v[132:135], v[80:95]
  ds_read_b128 v[128:131], v22 offset:4096
  v_cvt_pk_bf16_f32 v184, v96, v97
  v_fma_f32 v98, -v152, v34, v98
  v_mfma_f32_32x32x16_bf16 v[64:79], a[8:11], v[136:139], v[64:79]
  v_fma_f32 v99, -v152, v35, v99
  v_mul_f32 v98, v153, v98
  v_mfma_f32_32x32x16_bf16 v[80:95], a[152:155], v[136:139], v[80:95]
  ds_read_b128 v[132:135], v23 offset:4096
  v_mul_f32 v99, v153, v99
  v_cvt_pk_bf16_f32 v185, v98, v99
  v_mfma_f32_32x32x16_bf16 v[64:79], a[12:15], v[140:143], v[64:79]
  v_fma_f32 v100, -v152, v36, v100
  v_fma_f32 v101, -v152, v37, v101
  v_mfma_f32_32x32x16_bf16 v[80:95], a[156:159], v[140:143], v[80:95]
  ds_read_b128 v[136:139], v20 offset:8192
  v_mul_f32 v100, v153, v100
  v_mul_f32 v101, v153, v101
  v_mfma_f32_32x32x16_bf16 v[64:79], a[16:19], v[144:147], v[64:79]
  v_cvt_pk_bf16_f32 v186, v100, v101
  v_fma_f32 v102, -v152, v38, v102
  v_mfma_f32_32x32x16_bf16 v[80:95], a[160:163], v[144:147], v[80:95]
  ds_read_b128 v[140:143], v21 offset:8192
  v_fma_f32 v103, -v152, v39, v103
  s_waitcnt lgkmcnt(4)
  v_mfma_f32_32x32x16_bf16 v[64:79], a[20:23], v[148:151], v[64:79]
  v_mul_f32 v102, v153, v102
  v_mul_f32 v103, v153, v103
  v_mfma_f32_32x32x16_bf16 v[80:95], a[164:167], v[148:151], v[80:95]
  ds_read_b128 v[144:147], v22 offset:8192
  v_cvt_pk_bf16_f32 v187, v102, v103
  buffer_store_dwordx4 v[184:187], v5, s[52:55], s61 offen offset:0 sc1
  s_waitcnt lgkmcnt(4)
  v_mfma_f32_32x32x16_bf16 v[64:79], a[24:27], v[128:131], v[64:79]
  v_fma_f32 v104, -v152, v40, v104
  v_fma_f32 v105, -v152, v41, v105
  v_mfma_f32_32x32x16_bf16 v[80:95], a[168:171], v[128:131], v[80:95]
  ds_read_b128 v[148:151], v23 offset:8192
  v_mul_f32 v104, v153, v104
  v_mul_f32 v105, v153, v105
  s_waitcnt lgkmcnt(4)
  v_mfma_f32_32x32x16_bf16 v[64:79], a[28:31], v[132:135], v[64:79]
  v_cvt_pk_bf16_f32 v188, v104, v105
  v_fma_f32 v106, -v152, v42, v106
  v_mfma_f32_32x32x16_bf16 v[80:95], a[172:175], v[132:135], v[80:95]
  ds_read_b128 v[128:131], v20 offset:12288
  v_fma_f32 v107, -v152, v43, v107
  v_mul_f32 v106, v153, v106
  s_waitcnt lgkmcnt(4)
  v_mfma_f32_32x32x16_bf16 v[64:79], a[32:35], v[136:139], v[64:79]
  v_mul_f32 v107, v153, v107
  v_cvt_pk_bf16_f32 v189, v106, v107
  v_mfma_f32_32x32x16_bf16 v[80:95], a[176:179], v[136:139], v[80:95]
  ds_read_b128 v[132:135], v21 offset:12288
  v_fma_f32 v108, -v152, v44, v108
  v_fma_f32 v109, -v152, v45, v109
  s_waitcnt lgkmcnt(4)
  v_mfma_f32_32x32x16_bf16 v[64:79], a[36:39], v[140:143], v[64:79]
  v_mul_f32 v108, v153, v108
  v_mfma_f32_32x32x16_bf16 v[80:95], a[180:183], v[140:143], v[80:95]
  ds_read_b128 v[136:139], v22 offset:12288
  v_mul_f32 v109, v153, v109
  v_cvt_pk_bf16_f32 v190, v108, v109
  s_waitcnt lgkmcnt(4)
  v_mfma_f32_32x32x16_bf16 v[64:79], a[40:43], v[144:147], v[64:79]
  v_fma_f32 v110, -v152, v46, v110
  v_fma_f32 v111, -v152, v47, v111
  v_mfma_f32_32x32x16_bf16 v[80:95], a[184:187], v[144:147], v[80:95]
  ds_read_b128 v[140:143], v23 offset:12288
  v_mul_f32 v110, v153, v110
  v_mul_f32 v111, v153, v111
  s_waitcnt lgkmcnt(4)
  v_mfma_f32_32x32x16_bf16 v[64:79], a[44:47], v[148:151], v[64:79]
  v_cvt_pk_bf16_f32 v191, v110, v111
  buffer_store_dwordx4 v[188:191], v5, s[52:55], s61 offen offset:512 sc1
  v_mfma_f32_32x32x16_bf16 v[80:95], a[188:191], v[148:151], v[80:95]
  ds_read_b128 v[144:147], v20 offset:16384
  v_fma_f32 v112, -v152, v48, v112
  v_fma_f32 v113, -v152, v49, v113
  s_waitcnt lgkmcnt(4)
  v_mfma_f32_32x32x16_bf16 v[64:79], a[48:51], v[128:131], v[64:79]
  v_mul_f32 v112, v153, v112
  v_mul_f32 v113, v153, v113
  v_mfma_f32_32x32x16_bf16 v[80:95], a[192:195], v[128:131], v[80:95]
  ds_read_b128 v[148:151], v21 offset:16384
  v_cvt_pk_bf16_f32 v192, v112, v113
  v_fma_f32 v114, -v152, v50, v114
  s_waitcnt lgkmcnt(4)
  v_mfma_f32_32x32x16_bf16 v[64:79], a[52:55], v[132:135], v[64:79]
  v_fma_f32 v115, -v152, v51, v115
  v_mul_f32 v114, v153, v114
  v_mfma_f32_32x32x16_bf16 v[80:95], a[196:199], v[132:135], v[80:95]
  ds_read_b128 v[128:131], v22 offset:16384
  v_mul_f32 v115, v153, v115
  s_waitcnt lgkmcnt(4)
  v_mfma_f32_32x32x16_bf16 v[64:79], a[56:59], v[136:139], v[64:79]
  v_cvt_pk_bf16_f32 v193, v114, v115
  v_fma_f32 v116, -v152, v52, v116
  v_mfma_f32_32x32x16_bf16 v[80:95], a[200:203], v[136:139], v[80:95]
  ds_read_b128 v[132:135], v23 offset:16384
  v_fma_f32 v117, -v152, v53, v117
  v_mul_f32 v116, v153, v116
  s_waitcnt lgkmcnt(4)
  v_mfma_f32_32x32x16_bf16 v[64:79], a[60:63], v[140:143], v[64:79]
  v_mul_f32 v117, v153, v117
  v_cvt_pk_bf16_f32 v194, v116, v117
  v_mfma_f32_32x32x16_bf16 v[80:95], a[204:207], v[140:143], v[80:95]
  ds_read_b128 v[136:139], v20 offset:20480
  v_fma_f32 v118, -v152, v54, v118
  v_fma_f32 v119, -v152, v55, v119
  s_waitcnt lgkmcnt(4)
  v_mfma_f32_32x32x16_bf16 v[64:79], a[64:67], v[144:147], v[64:79]
  v_mul_f32 v118, v153, v118
  v_mul_f32 v119, v153, v119
  v_mfma_f32_32x32x16_bf16 v[80:95], a[208:211], v[144:147], v[80:95]
  ds_read_b128 v[140:143], v21 offset:20480
  v_cvt_pk_bf16_f32 v195, v118, v119
  buffer_store_dwordx4 v[192:195], v5, s[52:55], s62 offen offset:0 sc1
  s_waitcnt lgkmcnt(4)
  v_mfma_f32_32x32x16_bf16 v[64:79], a[68:71], v[148:151], v[64:79]
  v_fma_f32 v120, -v152, v56, v120
  v_fma_f32 v121, -v152, v57, v121
  v_mfma_f32_32x32x16_bf16 v[80:95], a[212:215], v[148:151], v[80:95]
  ds_read_b128 v[144:147], v22 offset:20480
  v_mul_f32 v120, v153, v120
  v_mul_f32 v121, v153, v121
  s_waitcnt lgkmcnt(4)
  v_mfma_f32_32x32x16_bf16 v[64:79], a[72:75], v[128:131], v[64:79]
  v_cvt_pk_bf16_f32 v196, v120, v121
  v_mfma_f32_32x32x16_bf16 v[80:95], a[216:219], v[128:131], v[80:95]
  ds_read_b128 v[148:151], v23 offset:20480
  v_fma_f32 v122, -v152, v58, v122
  v_fma_f32 v123, -v152, v59, v123
  s_waitcnt lgkmcnt(4)
  v_mfma_f32_32x32x16_bf16 v[64:79], a[76:79], v[132:135], v[64:79]
  v_mul_f32 v122, v153, v122
  v_mul_f32 v123, v153, v123
  v_mfma_f32_32x32x16_bf16 v[80:95], a[220:223], v[132:135], v[80:95]
  ds_read_b128 v[128:131], v20 offset:24576
  v_cvt_pk_bf16_f32 v197, v122, v123
  v_fma_f32 v124, -v152, v60, v124
  s_waitcnt lgkmcnt(4)
  v_mfma_f32_32x32x16_bf16 v[64:79], a[80:83], v[136:139], v[64:79]
  v_fma_f32 v125, -v152, v61, v125
  v_mul_f32 v124, v153, v124
  v_mfma_f32_32x32x16_bf16 v[80:95], a[224:227], v[136:139], v[80:95]
  ds_read_b128 v[132:135], v21 offset:24576
  v_mul_f32 v125, v153, v125
  v_cvt_pk_bf16_f32 v198, v124, v125
  s_waitcnt lgkmcnt(4)
  v_mfma_f32_32x32x16_bf16 v[64:79], a[84:87], v[140:143], v[64:79]
  v_fma_f32 v126, -v152, v62, v126
  v_fma_f32 v127, -v152, v63, v127
  v_mfma_f32_32x32x16_bf16 v[80:95], a[228:231], v[140:143], v[80:95]
  ds_read_b128 v[136:139], v22 offset:24576
  v_mul_f32 v126, v153, v126
  v_mul_f32 v127, v153, v127
  s_waitcnt lgkmcnt(4)
  v_mfma_f32_32x32x16_bf16 v[64:79], a[88:91], v[144:147], v[64:79]
  v_cvt_pk_bf16_f32 v199, v126, v127
  buffer_store_dwordx4 v[196:199], v5, s[52:55], s62 offen offset:512 sc1
  v_mfma_f32_32x32x16_bf16 v[80:95], a[232:235], v[144:147], v[80:95]
  ds_read_b128 v[140:143], v23 offset:24576
  s_lshl_b32 s61, s64, 18
  s_lshl_b32 s66, s56, 13
  s_add_u32 s66, s66, 0
  s_add_u32 s61, s61, s66
  s_add_u32 s62, s61, 16777216
  s_waitcnt lgkmcnt(4)
  v_mfma_f32_32x32x16_bf16 v[64:79], a[92:95], v[148:151], v[64:79]
  v_mfma_f32_32x32x16_bf16 v[80:95], a[236:239], v[148:151], v[80:95]
  ds_read_b128 v[144:147], v20 offset:28672
  s_waitcnt lgkmcnt(4)
  v_mfma_f32_32x32x16_bf16 v[64:79], a[96:99], v[128:131], v[64:79]
  s_add_u32 m0, s59, 36864
  s_add_u32 s65, s60, 0
  buffer_load_dwordx4 v4, s[8:11], s65 offen lds
  v_mfma_f32_32x32x16_bf16 v[80:95], a[240:243], v[128:131], v[80:95]
  ds_read_b128 v[148:151], v21 offset:28672
  s_waitcnt lgkmcnt(4)
  v_mfma_f32_32x32x16_bf16 v[64:79], a[100:103], v[132:135], v[64:79]
  s_add_u32 m0, s59, 40960
  s_add_u32 s65, s60, 128
  buffer_load_dwordx4 v4, s[8:11], s65 offen lds
  v_mfma_f32_32x32x16_bf16 v[80:95], a[244:247], v[132:135], v[80:95]
  ds_read_b128 v[128:131], v22 offset:28672
  s_waitcnt lgkmcnt(4)
  v_mfma_f32_32x32x16_bf16 v[64:79], a[104:107], v[136:139], v[64:79]
  s_add_u32 m0, s59, 45056
  s_add_u32 s65, s60, 256
  buffer_load_dwordx4 v4, s[8:11], s65 offen lds
  v_mfma_f32_32x32x16_bf16 v[80:95], a[248:251], v[136:139], v[80:95]
  ds_read_b128 v[132:135], v23 offset:28672
  s_waitcnt lgkmcnt(4)
  v_mfma_f32_32x32x16_bf16 v[64:79], a[108:111], v[140:143], v[64:79]
  s_add_u32 m0, s59, 49152
  s_add_u32 s65, s60, 384
  buffer_load_dwordx4 v4, s[8:11], s65 offen lds
  v_mfma_f32_32x32x16_bf16 v[80:95], a[252:255], v[140:143], v[80:95]
  ds_read_b128 v[136:139], v20 offset:32768
  s_waitcnt lgkmcnt(4)
  v_mfma_f32_32x32x16_bf16 v[64:79], a[112:115], v[144:147], v[64:79]
  s_add_u32 m0, s59, 53248
  s_add_u32 s65, s60, 512
  buffer_load_dwordx4 v4, s[8:11], s65 offen lds
  v_mfma_f32_32x32x16_bf16 v[80:95], v[224:227], v[144:147], v[80:95]
  ds_read_b128 v[140:143], v21 offset:32768
  s_waitcnt lgkmcnt(4)
  v_mfma_f32_32x32x16_bf16 v[64:79], a[116:119], v[148:151], v[64:79]
  s_add_u32 m0, s59, 57344
  s_add_u32 s65, s60, 640
  buffer_load_dwordx4 v4, s[8:11], s65 offen lds
  v_mfma_f32_32x32x16_bf16 v[80:95], v[228:231], v[148:151], v[80:95]
  ds_read_b128 v[144:147], v22 offset:32768
  s_waitcnt lgkmcnt(4)
  v_mfma_f32_32x32x16_bf16 v[64:79], a[120:123], v[128:131], v[64:79]
  s_add_u32 m0, s59, 61440
  s_add_u32 s65, s60, 768
  buffer_load_dwordx4 v4, s[8:11], s65 offen lds
  v_mfma_f32_32x32x16_bf16 v[80:95], v[232:235], v[128:131], v[80:95]
  ds_read_b128 v[148:151], v23 offset:32768
  s_waitcnt lgkmcnt(4)
  v_mfma_f32_32x32x16_bf16 v[64:79], a[124:127], v[132:135], v[64:79]
  s_add_u32 m0, s59, 65536
  s_add_u32 s65, s60, 896
  buffer_load_dwordx4 v4, s[8:11], s65 offen lds
  v_mfma_f32_32x32x16_bf16 v[80:95], v[236:239], v[132:135], v[80:95]
  s_waitcnt lgkmcnt(3)
  v_mfma_f32_32x32x16_bf16 v[64:79], a[128:131], v[136:139], v[64:79]
  s_add_u32 m0, s59, 69632
  s_add_u32 s65, s60, 1024
  buffer_load_dwordx4 v4, s[8:11], s65 offen lds
  v_mfma_f32_32x32x16_bf16 v[80:95], v[240:243], v[136:139], v[80:95]
  s_waitcnt lgkmcnt(2)
  v_mfma_f32_32x32x16_bf16 v[64:79], a[132:135], v[140:143], v[64:79]
  s_add_u32 s60, s60, 36864
  v_mfma_f32_32x32x16_bf16 v[80:95], v[244:247], v[140:143], v[80:95]
  s_waitcnt lgkmcnt(1)
  v_mfma_f32_32x32x16_bf16 v[64:79], a[136:139], v[144:147], v[64:79]
  v_mfma_f32_32x32x16_bf16 v[80:95], v[248:251], v[144:147], v[80:95]
  s_waitcnt lgkmcnt(0)
  v_mfma_f32_32x32x16_bf16 v[64:79], a[140:143], v[148:151], v[64:79]
  v_mfma_f32_32x32x16_bf16 v[80:95], v[252:255], v[148:151], v[80:95]
  s_waitcnt vmcnt(9) lgkmcnt(0)
  s_barrier
  s_cmp_lg_u32 s5, 0
  s_cbranch_scc1 QF_44
  s_sub_i32 s65, s64, 0
  s_max_i32 s65, s65, 0
  v_mov_b32 v7, s65
  s_mov_b64 exec, 3
  buffer_store_dword v7, v11, s[52:55], s63 offen sc1
  s_mov_b64 exec, -1
QF_44:
  s_add_u32 s64, s64, 1
  ds_read_b128 v[128:131], v24 offset:0
  ds_read_b128 v[132:135], v25 offset:0
  ds_read_b128 v[136:139], v26 offset:0
  ds_read_b128 v[140:143], v27 offset:0
  ds_read_b128 v[144:147], v24 offset:4096
  s_waitcnt lgkmcnt(4)
  v_mfma_f32_32x32x16_bf16 v[96:111], a[0:3], v[128:131], 0
  ds_read2_b32 v[152:153], v6 offset0:0 offset1:32
  v_add_u32 v6, 256, v6
  v_mfma_f32_32x32x16_bf16 v[112:127], a[144:147], v[128:131], 0
  ds_read_b128 v[148:151], v25 offset:4096
  s_waitcnt lgkmcnt(1)
  v_fma_f32 v64, -v152, v32, v64
  v_fma_f32 v65, -v152, v33, v65
  v_mfma_f32_32x32x16_bf16 v[96:111], a[4:7], v[132:135], v[96:111]
  v_mul_f32 v64, v153, v64
  v_mul_f32 v65, v153, v65
  v_mfma_f32_32x32x16_bf16 v[112:127], a[148:151], v[132:135], v[112:127]
  ds_read_b128 v[128:131], v26 offset:4096
  v_cvt_pk_bf16_f32 v184, v64, v65
  v_fma_f32 v66, -v152, v34, v66
  v_mfma_f32_32x32x16_bf16 v[96:111], a[8:11], v[136:139], v[96:111]
  v_fma_f32 v67, -v152, v35, v67
  v_mul_f32 v66, v153, v66
  v_mfma_f32_32x32x16_bf16 v[112:127], a[152:155], v[136:139], v[112:127]
  ds_read_b128 v[132:135], v27 offset:4096
  v_mul_f32 v67, v153, v67
  v_cvt_pk_bf16_f32 v185, v66, v67
  v_mfma_f32_32x32x16_bf16 v[96:111], a[12:15], v[140:143], v[96:111]
  v_fma_f32 v68, -v152, v36, v68
  v_fma_f32 v69, -v152, v37, v69
  v_mfma_f32_32x32x16_bf16 v[112:127], a[156:159], v[140:143], v[112:127]
  ds_read_b128 v[136:139], v24 offset:8192
  v_mul_f32 v68, v153, v68
  v_mul_f32 v69, v153, v69
  v_mfma_f32_32x32x16_bf16 v[96:111], a[16:19], v[144:147], v[96:111]
  v_cvt_pk_bf16_f32 v186, v68, v69
  v_fma_f32 v70, -v152, v38, v70
  v_mfma_f32_32x32x16_bf16 v[112:127], a[160:163], v[144:147], v[112:127]
  ds_read_b128 v[140:143], v25 offset:8192
  v_fma_f32 v71, -v152, v39, v71
  s_waitcnt lgkmcnt(4)
  v_mfma_f32_32x32x16_bf16 v[96:111], a[20:23], v[148:151], v[96:111]
  v_mul_f32 v70, v153, v70
  v_mul_f32 v71, v153, v71
  v_mfma_f32_32x32x16_bf16 v[112:127], a[164:167], v[148:151], v[112:127]
  ds_read_b128 v[144:147], v26 offset:8192
  v_cvt_pk_bf16_f32 v187, v70, v71
  buffer_store_dwordx4 v[184:187], v5, s[52:55], s61 offen offset:0 sc1
  s_waitcnt lgkmcnt(4)
  v_mfma_f32_32x32x16_bf16 v[96:111], a[24:27], v[128:131], v[96:111]
  v_fma_f32 v72, -v152, v40, v72
  v_fma_f32 v73, -v152, v41, v73
  v_mfma_f32_32x32x16_bf16 v[112:127], a[168:171], v[128:131], v[112:127]
  ds_read_b128 v[148:151], v27 offset:8192
  v_mul_f32 v72, v153, v72
  v_mul_f32 v73, v153, v73
  s_waitcnt lgkmcnt(4)
  v_mfma_f32_32x32x16_bf16 v[96:111], a[28:31], v[132:135], v[96:111]
  v_cvt_pk_bf16_f32 v188, v72, v73
  v_fma_f32 v74, -v152, v42, v74
  v_mfma_f32_32x32x16_bf16 v[112:127], a[172:175], v[132:135], v[112:127]
  ds_read_b128 v[128:131], v24 offset:12288
  v_fma_f32 v75, -v152, v43, v75
  v_mul_f32 v74, v153, v74
  s_waitcnt lgkmcnt(4)
  v_mfma_f32_32x32x16_bf16 v[96:111], a[32:35], v[136:139], v[96:111]
  v_mul_f32 v75, v153, v75
  v_cvt_pk_bf16_f32 v189, v74, v75
  v_mfma_f32_32x32x16_bf16 v[112:127], a[176:179], v[136:139], v[112:127]
  ds_read_b128 v[132:135], v25 offset:12288
  v_fma_f32 v76, -v152, v44, v76
  v_fma_f32 v77, -v152, v45, v77
  s_waitcnt lgkmcnt(4)
  v_mfma_f32_32x32x16_bf16 v[96:111], a[36:39], v[140:143], v[96:111]
  v_mul_f32 v76, v153, v76
  v_mfma_f32_32x32x16_bf16 v[112:127], a[180:183], v[140:143], v[112:127]
  ds_read_b128 v[136:139], v26 offset:12288
  v_mul_f32 v77, v153, v77
  v_cvt_pk_bf16_f32 v190, v76, v77
  s_waitcnt lgkmcnt(4)
  v_mfma_f32_32x32x16_bf16 v[96:111], a[40:43], v[144:147], v[96:111]
  v_fma_f32 v78, -v152, v46, v78
  v_fma_f32 v79, -v152, v47, v79
  v_mfma_f32_32x32x16_bf16 v[112:127], a[184:187], v[144:147], v[112:127]
  ds_read_b128 v[140:143], v27 offset:12288
  v_mul_f32 v78, v153, v78
  v_mul_f32 v79, v153, v79
  s_waitcnt lgkmcnt(4)
  v_mfma_f32_32x32x16_bf16 v[96:111], a[44:47], v[148:151], v[96:111]
  v_cvt_pk_bf16_f32 v191, v78, v79
  buffer_store_dwordx4 v[188:191], v5, s[52:55], s61 offen offset:512 sc1
  v_mfma_f32_32x32x16_bf16 v[112:127], a[188:191], v[148:151], v[112:127]
  ds_read_b128 v[144:147], v24 offset:16384
  v_fma_f32 v80, -v152, v48, v80
  v_fma_f32 v81, -v152, v49, v81
  s_waitcnt lgkmcnt(4)
  v_mfma_f32_32x32x16_bf16 v[96:111], a[48:51], v[128:131], v[96:111]
  v_mul_f32 v80, v153, v80
  v_mul_f32 v81, v153, v81
  v_mfma_f32_32x32x16_bf16 v[112:127], a[192:195], v[128:131], v[112:127]
  ds_read_b128 v[148:151], v25 offset:16384
  v_cvt_pk_bf16_f32 v192, v80, v81
  v_fma_f32 v82, -v152, v50, v82
  s_waitcnt lgkmcnt(4)
  v_mfma_f32_32x32x16_bf16 v[96:111], a[52:55], v[132:135], v[96:111]
  v_fma_f32 v83, -v152, v51, v83
  v_mul_f32 v82, v153, v82
  v_mfma_f32_32x32x16_bf16 v[112:127], a[196:199], v[132:135], v[112:127]
  ds_read_b128 v[128:131], v26 offset:16384
  v_mul_f32 v83, v153, v83
  s_waitcnt lgkmcnt(4)
  v_mfma_f32_32x32x16_bf16 v[96:111], a[56:59], v[136:139], v[96:111]
  v_cvt_pk_bf16_f32 v193, v82, v83
  v_fma_f32 v84, -v152, v52, v84
  v_mfma_f32_32x32x16_bf16 v[112:127], a[200:203], v[136:139], v[112:127]
  ds_read_b128 v[132:135], v27 offset:16384
  v_fma_f32 v85, -v152, v53, v85
  v_mul_f32 v84, v153, v84
  s_waitcnt lgkmcnt(4)
  v_mfma_f32_32x32x16_bf16 v[96:111], a[60:63], v[140:143], v[96:111]
  v_mul_f32 v85, v153, v85
  v_cvt_pk_bf16_f32 v194, v84, v85
  v_mfma_f32_32x32x16_bf16 v[112:127], a[204:207], v[140:143], v[112:127]
  ds_read_b128 v[136:139], v24 offset:20480
  v_fma_f32 v86, -v152, v54, v86
  v_fma_f32 v87, -v152, v55, v87
  s_waitcnt lgkmcnt(4)
  v_mfma_f32_32x32x16_bf16 v[96:111], a[64:67], v[144:147], v[96:111]
  v_mul_f32 v86, v153, v86
  v_mul_f32 v87, v153, v87
  v_mfma_f32_32x32x16_bf16 v[112:127], a[208:211], v[144:147], v[112:127]
  ds_read_b128 v[140:143], v25 offset:20480
  v_cvt_pk_bf16_f32 v195, v86, v87
  buffer_store_dwordx4 v[192:195], v5, s[52:55], s62 offen offset:0 sc1
  s_waitcnt lgkmcnt(4)
  v_mfma_f32_32x32x16_bf16 v[96:111], a[68:71], v[148:151], v[96:111]
  v_fma_f32 v88, -v152, v56, v88
  v_fma_f32 v89, -v152, v57, v89
  v_mfma_f32_32x32x16_bf16 v[112:127], a[212:215], v[148:151], v[112:127]
  ds_read_b128 v[144:147], v26 offset:20480
  v_mul_f32 v88, v153, v88
  v_mul_f32 v89, v153, v89
  s_waitcnt lgkmcnt(4)
  v_mfma_f32_32x32x16_bf16 v[96:111], a[72:75], v[128:131], v[96:111]
  v_cvt_pk_bf16_f32 v196, v88, v89
  v_mfma_f32_32x32x16_bf16 v[112:127], a[216:219], v[128:131], v[112:127]
  ds_read_b128 v[148:151], v27 offset:20480
  v_fma_f32 v90, -v152, v58, v90
  v_fma_f32 v91, -v152, v59, v91
  s_waitcnt lgkmcnt(4)
  v_mfma_f32_32x32x16_bf16 v[96:111], a[76:79], v[132:135], v[96:111]
  v_mul_f32 v90, v153, v90
  v_mul_f32 v91, v153, v91
  v_mfma_f32_32x32x16_bf16 v[112:127], a[220:223], v[132:135], v[112:127]
  ds_read_b128 v[128:131], v24 offset:24576
  v_cvt_pk_bf16_f32 v197, v90, v91
  v_fma_f32 v92, -v152, v60, v92
  s_waitcnt lgkmcnt(4)
  v_mfma_f32_32x32x16_bf16 v[96:111], a[80:83], v[136:139], v[96:111]
  v_fma_f32 v93, -v152, v61, v93
  v_mul_f32 v92, v153, v92
  v_mfma_f32_32x32x16_bf16 v[112:127], a[224:227], v[136:139], v[112:127]
  ds_read_b128 v[132:135], v25 offset:24576
  v_mul_f32 v93, v153, v93
  v_cvt_pk_bf16_f32 v198, v92, v93
  s_waitcnt lgkmcnt(4)
  v_mfma_f32_32x32x16_bf16 v[96:111], a[84:87], v[140:143], v[96:111]
  v_fma_f32 v94, -v152, v62, v94
  v_fma_f32 v95, -v152, v63, v95
  v_mfma_f32_32x32x16_bf16 v[112:127], a[228:231], v[140:143], v[112:127]
  ds_read_b128 v[136:139], v26 offset:24576
  v_mul_f32 v94, v153, v94
  v_mul_f32 v95, v153, v95
  s_waitcnt lgkmcnt(4)
  v_mfma_f32_32x32x16_bf16 v[96:111], a[88:91], v[144:147], v[96:111]
  v_cvt_pk_bf16_f32 v199, v94, v95
  buffer_store_dwordx4 v[196:199], v5, s[52:55], s62 offen offset:512 sc1
  v_mfma_f32_32x32x16_bf16 v[112:127], a[232:235], v[144:147], v[112:127]
  ds_read_b128 v[140:143], v27 offset:24576
  s_lshl_b32 s61, s64, 18
  s_lshl_b32 s66, s56, 13
  s_add_u32 s66, s66, 0
  s_add_u32 s61, s61, s66
  s_add_u32 s62, s61, 16777216
  s_waitcnt lgkmcnt(4)
  v_mfma_f32_32x32x16_bf16 v[96:111], a[92:95], v[148:151], v[96:111]
  v_mfma_f32_32x32x16_bf16 v[112:127], a[236:239], v[148:151], v[112:127]
  ds_read_b128 v[144:147], v24 offset:28672
  s_waitcnt lgkmcnt(4)
  v_mfma_f32_32x32x16_bf16 v[96:111], a[96:99], v[128:131], v[96:111]
  s_add_u32 m0, s59, 73728
  s_add_u32 s65, s60, 0
  buffer_load_dwordx4 v4, s[8:11], s65 offen lds
  v_mfma_f32_32x32x16_bf16 v[112:127], a[240:243], v[128:131], v[112:127]
  ds_read_b128 v[148:151], v25 offset:28672
  s_waitcnt lgkmcnt(4)
  v_mfma_f32_32x32x16_bf16 v[96:111], a[100:103], v[132:135], v[96:111]
  s_add_u32 m0, s59, 77824
  s_add_u32 s65, s60, 128
  buffer_load_dwordx4 v4, s[8:11], s65 offen lds
  v_mfma_f32_32x32x16_bf16 v[112:127], a[244:247], v[132:135], v[112:127]
  ds_read_b128 v[128:131], v26 offset:28672
  s_waitcnt lgkmcnt(4)
  v_mfma_f32_32x32x16_bf16 v[96:111], a[104:107], v[136:139], v[96:111]
  s_add_u32 m0, s59, 81920
  s_add_u32 s65, s60, 256
  buffer_load_dwordx4 v4, s[8:11], s65 offen lds
  v_mfma_f32_32x32x16_bf16 v[112:127], a[248:251], v[136:139], v[112:127]
  ds_read_b128 v[132:135], v27 offset:28672
  s_waitcnt lgkmcnt(4)
  v_mfma_f32_32x32x16_bf16 v[96:111], a[108:111], v[140:143], v[96:111]
  s_add_u32 m0, s59, 86016
  s_add_u32 s65, s60, 384
  buffer_load_dwordx4 v4, s[8:11], s65 offen lds
  v_mfma_f32_32x32x16_bf16 v[112:127], a[252:255], v[140:143], v[112:127]
  ds_read_b128 v[136:139], v24 offset:32768
  s_waitcnt lgkmcnt(4)
  v_mfma_f32_32x32x16_bf16 v[96:111], a[112:115], v[144:147], v[96:111]
  s_add_u32 m0, s59, 90112
  s_add_u32 s65, s60, 512
  buffer_load_dwordx4 v4, s[8:11], s65 offen lds
  v_mfma_f32_32x32x16_bf16 v[112:127], v[224:227], v[144:147], v[112:127]
  ds_read_b128 v[140:143], v25 offset:32768
  s_waitcnt lgkmcnt(4)
  v_mfma_f32_32x32x16_bf16 v[96:111], a[116:119], v[148:151], v[96:111]
  s_add_u32 m0, s59, 94208
  s_add_u32 s65, s60, 640
  buffer_load_dwordx4 v4, s[8:11], s65 offen lds
  v_mfma_f32_32x32x16_bf16 v[112:127], v[228:231], v[148:151], v[112:127]
  ds_read_b128 v[144:147], v26 offset:32768
  s_waitcnt lgkmcnt(4)
  v_mfma_f32_32x32x16_bf16 v[96:111], a[120:123], v[128:131], v[96:111]
  s_add_u32 m0, s59, 98304
  s_add_u32 s65, s60, 768
  buffer_load_dwordx4 v4, s[8:11], s65 offen lds
  v_mfma_f32_32x32x16_bf16 v[112:127], v[232:235], v[128:131], v[112:127]
  ds_read_b128 v[148:151], v27 offset:32768
  s_waitcnt lgkmcnt(4)
  v_mfma_f32_32x32x16_bf16 v[96:111], a[124:127], v[132:135], v[96:111]
  s_add_u32 m0, s59, 102400
  s_add_u32 s65, s60, 896
  buffer_load_dwordx4 v4, s[8:11], s65 offen lds
  v_mfma_f32_32x32x16_bf16 v[112:127], v[236:239], v[132:135], v[112:127]
  s_waitcnt lgkmcnt(3)
  v_mfma_f32_32x32x16_bf16 v[96:111], a[128:131], v[136:139], v[96:111]
  s_add_u32 m0, s59, 106496
  s_add_u32 s65, s60, 1024
  buffer_load_dwordx4 v4, s[8:11], s65 offen lds
  v_mfma_f32_32x32x16_bf16 v[112:127], v[240:243], v[136:139], v[112:127]
  s_waitcnt lgkmcnt(2)
  v_mfma_f32_32x32x16_bf16 v[96:111], a[132:135], v[140:143], v[96:111]
  s_add_u32 s60, s60, 36864
  v_mfma_f32_32x32x16_bf16 v[112:127], v[244:247], v[140:143], v[112:127]
  s_waitcnt lgkmcnt(1)
  v_mfma_f32_32x32x16_bf16 v[96:111], a[136:139], v[144:147], v[96:111]
  v_mfma_f32_32x32x16_bf16 v[112:127], v[248:251], v[144:147], v[112:127]
  s_waitcnt lgkmcnt(0)
  v_mfma_f32_32x32x16_bf16 v[96:111], a[140:143], v[148:151], v[96:111]
  v_mfma_f32_32x32x16_bf16 v[112:127], v[252:255], v[148:151], v[112:127]
  s_sub_u32 s57, s57, 1
  s_cmp_lg_u32 s57, 0
  s_cbranch_scc1 QKV_LOOP_39
  ds_read2_b32 v[152:153], v6 offset0:0 offset1:32
  v_add_u32 v6, 256, v6
  s_waitcnt lgkmcnt(0)
  v_fma_f32 v96, -v152, v32, v96
  v_fma_f32 v97, -v152, v33, v97
  v_mul_f32 v96, v153, v96
  v_mul_f32 v97, v153, v97
  v_cvt_pk_bf16_f32 v184, v96, v97
  v_fma_f32 v98, -v152, v34, v98
  v_fma_f32 v99, -v152, v35, v99
  v_mul_f32 v98, v153, v98
  v_mul_f32 v99, v153, v99
  v_cvt_pk_bf16_f32 v185, v98, v99
  v_fma_f32 v100, -v152, v36, v100
  v_fma_f32 v101, -v152, v37, v101
  v_mul_f32 v100, v153, v100
  v_mul_f32 v101, v153, v101
  v_cvt_pk_bf16_f32 v186, v100, v101
  v_fma_f32 v102, -v152, v38, v102
  v_fma_f32 v103, -v152, v39, v103
  v_mul_f32 v102, v153, v102
  v_mul_f32 v103, v153, v103
  v_cvt_pk_bf16_f32 v187, v102, v103
  buffer_store_dwordx4 v[184:187], v5, s[52:55], s61 offen offset:0 sc1
  v_fma_f32 v104, -v152, v40, v104
  v_fma_f32 v105, -v152, v41, v105
  v_mul_f32 v104, v153, v104
  v_mul_f32 v105, v153, v105
  v_cvt_pk_bf16_f32 v188, v104, v105
  v_fma_f32 v106, -v152, v42, v106
  v_fma_f32 v107, -v152, v43, v107
  v_mul_f32 v106, v153, v106
  v_mul_f32 v107, v153, v107
  v_cvt_pk_bf16_f32 v189, v106, v107
  v_fma_f32 v108, -v152, v44, v108
  v_fma_f32 v109, -v152, v45, v109
  v_mul_f32 v108, v153, v108
  v_mul_f32 v109, v153, v109
  v_cvt_pk_bf16_f32 v190, v108, v109
  v_fma_f32 v110, -v152, v46, v110
  v_fma_f32 v111, -v152, v47, v111
  v_mul_f32 v110, v153, v110
  v_mul_f32 v111, v153, v111
  v_cvt_pk_bf16_f32 v191, v110, v111
  buffer_store_dwordx4 v[188:191], v5, s[52:55], s61 offen offset:512 sc1
  v_fma_f32 v112, -v152, v48, v112
  v_fma_f32 v113, -v152, v49, v113
  v_mul_f32 v112, v153, v112
  v_mul_f32 v113, v153, v113
  v_cvt_pk_bf16_f32 v192, v112, v113
  v_fma_f32 v114, -v152, v50, v114
  v_fma_f32 v115, -v152, v51, v115
  v_mul_f32 v114, v153, v114
  v_mul_f32 v115, v153, v115
  v_cvt_pk_bf16_f32 v193, v114, v115
  v_fma_f32 v116, -v152, v52, v116
  v_fma_f32 v117, -v152, v53, v117
  v_mul_f32 v116, v153, v116
  v_mul_f32 v117, v153, v117
  v_cvt_pk_bf16_f32 v194, v116, v117
  v_fma_f32 v118, -v152, v54, v118
  v_fma_f32 v119, -v152, v55, v119
  v_mul_f32 v118, v153, v118
  v_mul_f32 v119, v153, v119
  v_cvt_pk_bf16_f32 v195, v118, v119
  buffer_store_dwordx4 v[192:195], v5, s[52:55], s62 offen offset:0 sc1
  v_fma_f32 v120, -v152, v56, v120
  v_fma_f32 v121, -v152, v57, v121
  v_mul_f32 v120, v153, v120
  v_mul_f32 v121, v153, v121
  v_cvt_pk_bf16_f32 v196, v120, v121
  v_fma_f32 v122, -v152, v58, v122
  v_fma_f32 v123, -v152, v59, v123
  v_mul_f32 v122, v153, v122
  v_mul_f32 v123, v153, v123
  v_cvt_pk_bf16_f32 v197, v122, v123
  v_fma_f32 v124, -v152, v60, v124
  v_fma_f32 v125, -v152, v61, v125
  v_mul_f32 v124, v153, v124
  v_mul_f32 v125, v153, v125
  v_cvt_pk_bf16_f32 v198, v124, v125
  v_fma_f32 v126, -v152, v62, v126
  v_fma_f32 v127, -v152, v63, v127
  v_mul_f32 v126, v153, v126
  v_mul_f32 v127, v153, v127
  v_cvt_pk_bf16_f32 v199, v126, v127
  buffer_store_dwordx4 v[196:199], v5, s[52:55], s62 offen offset:512 sc1
  s_waitcnt vmcnt(0) lgkmcnt(0)
  s_barrier
  s_cmp_lg_u32 s5, 0
  s_cbranch_scc1 QF_45
  s_sub_i32 s65, s64, -1
  s_max_i32 s65, s65, 0
  v_mov_b32 v7, s65
  s_mov_b64 exec, 3
  buffer_store_dword v7, v11, s[52:55], s63 offen sc1
  s_mov_b64 exec, -1
QF_45:
  s_add_u32 s64, s64, 1
  s_branch QKV_END_36
QKV_V_35:
  s_sub_u32 s56, s7, 32
  s_lshl_b32 s56, s56, 1
  s_lshl_b32 s63, s56, 7
  s_add_u32 s63, s63, 112197636
  v_and_b32 v11, 1, v0
  v_lshlrev_b32 v11, 7, v11
  v_bfe_u32 v7, v0, 1, 3
  v_bfe_u32 v8, v0, 4, 1
  v_lshlrev_b32 v8, 2, v8
  v_xor_b32 v7, v7, v8
  v_lshlrev_b32 v1, 13, v7
  v_lshrrev_b32 v7, 4, v0
  v_lshl_add_u32 v1, v7, 5, v1
  v_and_b32 v7, 1, v0
  v_lshl_add_u32 v1, v7, 4, v1
  s_lshl_b32 s58, s5, 16
  s_lshl_b32 s65, s56, 8
  s_add_u32 s58, s58, s65
  s_lshl_b32 s59, s5, 11
  s_add_u32 m0, s59, 0
  s_add_u32 s65, s58, 0
  buffer_load_dwordx4 v1, s[24:27], s65 offen lds
  s_add_u32 m0, s59, 1024
  s_add_u32 s65, s58, 128
  buffer_load_dwordx4 v1, s[24:27], s65 offen lds
  s_add_u32 m0, s59, 8192
  s_add_u32 s65, s58, 262144
  buffer_load_dwordx4 v1, s[24:27], s65 offen lds
  s_add_u32 m0, s59, 9216
  s_add_u32 s65, s58, 262272
  buffer_load_dwordx4 v1, s[24:27], s65 offen lds
  s_add_u32 m0, s59, 16384
  s_add_u32 s65, s58, 524288
  buffer_load_dwordx4 v1, s[24:27], s65 offen lds
  s_add_u32 m0, s59, 17408
  s_add_u32 s65, s58, 524416
  buffer_load_dwordx4 v1, s[24:27], s65 offen lds
  s_add_u32 m0, s59, 24576
  s_add_u32 s65, s58, 786432
  buffer_load_dwordx4 v1, s[24:27], s65 offen lds
  s_add_u32 m0, s59, 25600
  s_add_u32 s65, s58, 786560
  buffer_load_dwordx4 v1, s[24:27], s65 offen lds
  s_add_u32 m0, s59, 32768
  s_add_u32 s65, s58, 1048576
  buffer_load_dwordx4 v1, s[24:27], s65 offen lds
  s_add_u32 m0, s59, 33792
  s_add_u32 s65, s58, 1048704
  buffer_load_dwordx4 v1, s[24:27], s65 offen lds
  s_add_u32 m0, s59, 40960
  s_add_u32 s65, s58, 1310720
  buffer_load_dwordx4 v1, s[24:27], s65 offen lds
  s_add_u32 m0, s59, 41984
  s_add_u32 s65, s58, 1310848
  buffer_load_dwordx4 v1, s[24:27], s65 offen lds
  s_add_u32 m0, s59, 49152
  s_add_u32 s65, s58, 1572864
  buffer_load_dwordx4 v1, s[24:27], s65 offen lds
  s_add_u32 m0, s59, 50176
  s_add_u32 s65, s58, 1572992
  buffer_load_dwordx4 v1, s[24:27], s65 offen lds
  s_add_u32 m0, s59, 57344
  s_add_u32 s65, s58, 1835008
  buffer_load_dwordx4 v1, s[24:27], s65 offen lds
  s_add_u32 m0, s59, 58368
  s_add_u32 s65, s58, 1835136
  buffer_load_dwordx4 v1, s[24:27], s65 offen lds
  s_add_u32 m0, s59, 65536
  s_add_u32 s65, s58, 2097152
  buffer_load_dwordx4 v1, s[24:27], s65 offen lds
  s_add_u32 m0, s59, 66560
  s_add_u32 s65, s58, 2097280
  buffer_load_dwordx4 v1, s[24:27], s65 offen lds
  s_add_u32 m0, s59, 73728
  s_add_u32 s65, s58, 2359296
  buffer_load_dwordx4 v1, s[24:27], s65 offen lds
  s_add_u32 m0, s59, 74752
  s_add_u32 s65, s58, 2359424
  buffer_load_dwordx4 v1, s[24:27], s65 offen lds
  s_add_u32 m0, s59, 81920
  s_add_u32 s65, s58, 2621440
  buffer_load_dwordx4 v1, s[24:27], s65 offen lds
  s_add_u32 m0, s59, 82944
  s_add_u32 s65, s58, 2621568
  buffer_load_dwordx4 v1, s[24:27], s65 offen lds
  s_add_u32 m0, s59, 90112
  s_add_u32 s65, s58, 2883584
  buffer_load_dwordx4 v1, s[24:27], s65 offen lds
  s_add_u32 m0, s59, 91136
  s_add_u32 s65, s58, 2883712
  buffer_load_dwordx4 v1, s[24:27], s65 offen lds
  s_add_u32 m0, s59, 98304
  s_add_u32 s65, s58, 3145728
  buffer_load_dwordx4 v1, s[24:27], s65 offen lds
  s_add_u32 m0, s59, 99328
  s_add_u32 s65, s58, 3145856
  buffer_load_dwordx4 v1, s[24:27], s65 offen lds
  s_add_u32 m0, s59, 106496
  s_add_u32 s65, s58, 3407872
  buffer_load_dwordx4 v1, s[24:27], s65 offen lds
  s_add_u32 m0, s59, 107520
  s_add_u32 s65, s58, 3408000
  buffer_load_dwordx4 v1, s[24:27], s65 offen lds
  s_add_u32 m0, s59, 114688
  s_add_u32 s65, s58, 3670016
  buffer_load_dwordx4 v1, s[24:27], s65 offen lds
  s_add_u32 m0, s59, 115712
  s_add_u32 s65, s58, 3670144
  buffer_load_dwordx4 v1, s[24:27], s65 offen lds
  s_add_u32 m0, s59, 122880
  s_add_u32 s65, s58, 3932160
  buffer_load_dwordx4 v1, s[24:27], s65 offen lds
  s_add_u32 m0, s59, 123904
  s_add_u32 s65, s58, 3932288
  buffer_load_dwordx4 v1, s[24:27], s65 offen lds
  s_add_u32 m0, s59, 131072
  s_add_u32 s65, s58, 4194304
  buffer_load_dwordx4 v1, s[24:27], s65 offen lds
  s_add_u32 m0, s59, 132096
  s_add_u32 s65, s58, 4194432
  buffer_load_dwordx4 v1, s[24:27], s65 offen lds
  s_add_u32 m0, s59, 139264
  s_add_u32 s65, s58, 4456448
  buffer_load_dwordx4 v1, s[24:27], s65 offen lds
  s_add_u32 m0, s59, 140288
  s_add_u32 s65, s58, 4456576
  buffer_load_dwordx4 v1, s[24:27], s65 offen lds
  v_lshrrev_b32 v7, 5, v0
  v_lshlrev_b32 v2, 11, v7
  v_bfe_u32 v8, v0, 4, 1
  v_mul_u32_u24 v9, 384, v8
  v_add_u32 v2, v2, v9
  v_and_b32 v9, 15, v0
  v_lshl_add_u32 v2, v9, 3, v2
  s_lshl_b32 s65, s5, 9
  v_add_u32 v2, s65, v2
  v_xor_b32 v3, 128, v2
  v_add_u32 v128, 0x10000, v2
  v_add_u32 v129, 0x10000, v3
  v_add_u32 v130, 0x10000, v128
  v_add_u32 v131, 0x10000, v129
  s_and_b32 s65, s5, 1
  v_lshrrev_b32 v7, 3, v0
  v_xor_b32 v7, s65, v7
  v_and_b32 v8, 7, v0
  v_xor_b32 v8, v8, v7
  s_lshl_b32 s65, s5, 3
  v_add_u32 v7, s65, v7
  v_mul_u32_u24 v4, 1152, v7
  v_lshl_add_u32 v4, v8, 4, v4
  v_bfe_u32 v7, v0, 3, 2
  v_and_b32 v8, 7, v0
  v_and_b32 v9, 1, v7
  v_xor_b32 v9, v9, v8
  v_lshlrev_b32 v9, 7, v9
  v_lshl_add_u32 v9, v7, 10, v9
  v_lshrrev_b32 v7, 5, v0
  v_xor_b32 v8, v8, v7
  v_xor_b32 v10, 0, v8
  v_lshl_add_u32 v12, v10, 4, v9
  v_add_u32 v16, 36864, v12
  v_add_u32 v20, 73728, v12
  v_add_u32 v24, 110592, v12
  v_xor_b32 v10, 2, v8
  v_lshl_add_u32 v13, v10, 4, v9
  v_add_u32 v17, 36864, v13
  v_add_u32 v21, 73728, v13
  v_add_u32 v25, 110592, v13
  v_xor_b32 v10, 4, v8
  v_lshl_add_u32 v14, v10, 4, v9
  v_add_u32 v18, 36864, v14
  v_add_u32 v22, 73728, v14
  v_add_u32 v26, 110592, v14
  v_xor_b32 v10, 6, v8
  v_lshl_add_u32 v15, v10, 4, v9
  v_add_u32 v19, 36864, v15
  v_add_u32 v23, 73728, v15
  v_add_u32 v27, 110592, v15
  v_mov_b32 v28, 0x3f803f80
  v_mov_b32 v29, 0x3f803f80
  v_mov_b32 v30, 0x3f803f80
  v_mov_b32 v31, 0x3f803f80
  v_bfe_u32 v7, v0, 2, 1
  v_bfe_u32 v8, v0, 3, 2
  v_and_b32 v9, 3, v0
  v_lshl_add_u32 v8, v8, 2, v9
  v_lshlrev_b32 v5, 10, v7
  v_lshl_add_u32 v5, v8, 4, v5
  v_lshrrev_b32 v7, 5, v0
  v_lshl_add_u32 v5, v7, 8, v5
  s_lshl_b32 s65, s5, 11
  v_add_u32 v5, s65, v5
  v_lshlrev_b32 v6, 4, v7
  v_add_u32 v6, 147200, v6
  s_waitcnt vmcnt(18)
  s_barrier
  ds_read_b64_tr_b16 a[0:1], v2 offset:0
  ds_read_b64_tr_b16 a[2:3], v3 offset:0
  ds_read_b64_tr_b16 a[4:5], v2 offset:4096
  ds_read_b64_tr_b16 a[6:7], v3 offset:4096
  ds_read_b64_tr_b16 a[8:9], v2 offset:8192
  ds_read_b64_tr_b16 a[10:11], v3 offset:8192
  ds_read_b64_tr_b16 a[12:13], v2 offset:12288
  ds_read_b64_tr_b16 a[14:15], v3 offset:12288
  ds_read_b64_tr_b16 a[16:17], v2 offset:16384
  ds_read_b64_tr_b16 a[18:19], v3 offset:16384
  ds_read_b64_tr_b16 a[20:21], v2 offset:20480
  ds_read_b64_tr_b16 a[22:23], v3 offset:20480
  ds_read_b64_tr_b16 a[24:25], v2 offset:24576
  ds_read_b64_tr_b16 a[26:27], v3 offset:24576
  ds_read_b64_tr_b16 a[28:29], v2 offset:28672
  ds_read_b64_tr_b16 a[30:31], v3 offset:28672
  ds_read_b64_tr_b16 a[32:33], v2 offset:32768
  ds_read_b64_tr_b16 a[34:35], v3 offset:32768
  ds_read_b64_tr_b16 a[36:37], v2 offset:36864
  ds_read_b64_tr_b16 a[38:39], v3 offset:36864
  ds_read_b64_tr_b16 a[40:41], v2 offset:40960
  ds_read_b64_tr_b16 a[42:43], v3 offset:40960
  ds_read_b64_tr_b16 a[44:45], v2 offset:45056
  ds_read_b64_tr_b16 a[46:47], v3 offset:45056
  ds_read_b64_tr_b16 a[48:49], v2 offset:49152
  ds_read_b64_tr_b16 a[50:51], v3 offset:49152
  ds_read_b64_tr_b16 a[52:53], v2 offset:53248
  ds_read_b64_tr_b16 a[54:55], v3 offset:53248
  ds_read_b64_tr_b16 a[56:57], v2 offset:57344
  ds_read_b64_tr_b16 a[58:59], v3 offset:57344
  ds_read_b64_tr_b16 a[60:61], v2 offset:61440
  ds_read_b64_tr_b16 a[62:63], v3 offset:61440
  ds_read_b64_tr_b16 a[64:65], v128 offset:0
  ds_read_b64_tr_b16 a[66:67], v129 offset:0
  ds_read_b64_tr_b16 a[68:69], v128 offset:4096
  ds_read_b64_tr_b16 a[70:71], v129 offset:4096
  s_waitcnt lgkmcnt(0)
  s_barrier
  s_add_u32 m0, s59, 0
  s_add_u32 s65, s58, 256
  buffer_load_dwordx4 v1, s[24:27], s65 offen lds
  s_add_u32 m0, s59, 1024
  s_add_u32 s65, s58, 384
  buffer_load_dwordx4 v1, s[24:27], s65 offen lds
  s_add_u32 m0, s59, 8192
  s_add_u32 s65, s58, 262400
  buffer_load_dwordx4 v1, s[24:27], s65 offen lds
  s_add_u32 m0, s59, 9216
  s_add_u32 s65, s58, 262528
  buffer_load_dwordx4 v1, s[24:27], s65 offen lds
  s_add_u32 m0, s59, 16384
  s_add_u32 s65, s58, 524544
  buffer_load_dwordx4 v1, s[24:27], s65 offen lds
  s_add_u32 m0, s59, 17408
  s_add_u32 s65, s58, 524672
  buffer_load_dwordx4 v1, s[24:27], s65 offen lds
  s_add_u32 m0, s59, 24576
  s_add_u32 s65, s58, 786688
  buffer_load_dwordx4 v1, s[24:27], s65 offen lds
  s_add_u32 m0, s59, 25600
  s_add_u32 s65, s58, 786816
  buffer_load_dwordx4 v1, s[24:27], s65 offen lds
  s_add_u32 m0, s59, 32768
  s_add_u32 s65, s58, 1048832
  buffer_load_dwordx4 v1, s[24:27], s65 offen lds
  s_add_u32 m0, s59, 33792
  s_add_u32 s65, s58, 1048960
  buffer_load_dwordx4 v1, s[24:27], s65 offen lds
  s_add_u32 m0, s59, 40960
  s_add_u32 s65, s58, 1310976
  buffer_load_dwordx4 v1, s[24:27], s65 offen lds
  s_add_u32 m0, s59, 41984
  s_add_u32 s65, s58, 1311104
  buffer_load_dwordx4 v1, s[24:27], s65 offen lds
  s_add_u32 m0, s59, 49152
  s_add_u32 s65, s58, 1573120
  buffer_load_dwordx4 v1, s[24:27], s65 offen lds
  s_add_u32 m0, s59, 50176
  s_add_u32 s65, s58, 1573248
  buffer_load_dwordx4 v1, s[24:27], s65 offen lds
  s_add_u32 m0, s59, 57344
  s_add_u32 s65, s58, 1835264
  buffer_load_dwordx4 v1, s[24:27], s65 offen lds
  s_add_u32 m0, s59, 58368
  s_add_u32 s65, s58, 1835392
  buffer_load_dwordx4 v1, s[24:27], s65 offen lds
  s_add_u32 m0, s59, 65536
  s_add_u32 s65, s58, 2097408
  buffer_load_dwordx4 v1, s[24:27], s65 offen lds
  s_add_u32 m0, s59, 66560
  s_add_u32 s65, s58, 2097536
  buffer_load_dwordx4 v1, s[24:27], s65 offen lds
  s_waitcnt vmcnt(18)
  s_barrier
  ds_read_b64_tr_b16 a[72:73], v128 offset:8192
  ds_read_b64_tr_b16 a[74:75], v129 offset:8192
  ds_read_b64_tr_b16 a[76:77], v128 offset:12288
  ds_read_b64_tr_b16 a[78:79], v129 offset:12288
  ds_read_b64_tr_b16 a[80:81], v128 offset:16384
  ds_read_b64_tr_b16 a[82:83], v129 offset:16384
  ds_read_b64_tr_b16 a[84:85], v128 offset:20480
  ds_read_b64_tr_b16 a[86:87], v129 offset:20480
  ds_read_b64_tr_b16 a[88:89], v128 offset:24576
  ds_read_b64_tr_b16 a[90:91], v129 offset:24576
  ds_read_b64_tr_b16 a[92:93], v128 offset:28672
  ds_read_b64_tr_b16 a[94:95], v129 offset:28672
  ds_read_b64_tr_b16 a[96:97], v128 offset:32768
  ds_read_b64_tr_b16 a[98:99], v129 offset:32768
  ds_read_b64_tr_b16 a[100:101], v128 offset:36864
  ds_read_b64_tr_b16 a[102:103], v129 offset:36864
  ds_read_b64_tr_b16 a[104:105], v128 offset:40960
  ds_read_b64_tr_b16 a[106:107], v129 offset:40960
  ds_read_b64_tr_b16 a[108:109], v128 offset:45056
  ds_read_b64_tr_b16 a[110:111], v129 offset:45056
  ds_read_b64_tr_b16 a[112:113], v128 offset:49152
  ds_read_b64_tr_b16 a[114:115], v129 offset:49152
  ds_read_b64_tr_b16 a[116:117], v128 offset:53248
  ds_read_b64_tr_b16 a[118:119], v129 offset:53248
  ds_read_b64_tr_b16 a[120:121], v128 offset:57344
  ds_read_b64_tr_b16 a[122:123], v129 offset:57344
  ds_read_b64_tr_b16 a[124:125], v128 offset:61440
  ds_read_b64_tr_b16 a[126:127], v129 offset:61440
  ds_read_b64_tr_b16 a[128:129], v130 offset:0
  ds_read_b64_tr_b16 a[130:131], v131 offset:0
  ds_read_b64_tr_b16 a[132:133], v130 offset:4096
  ds_read_b64_tr_b16 a[134:135], v131 offset:4096
  ds_read_b64_tr_b16 a[136:137], v130 offset:8192
  ds_read_b64_tr_b16 a[138:139], v131 offset:8192
  ds_read_b64_tr_b16 a[140:141], v130 offset:12288
  ds_read_b64_tr_b16 a[142:143], v131 offset:12288
  s_waitcnt lgkmcnt(0)
  s_barrier
  s_add_u32 m0, s59, 73728
  s_add_u32 s65, s58, 2359552
  buffer_load_dwordx4 v1, s[24:27], s65 offen lds
  s_add_u32 m0, s59, 74752
  s_add_u32 s65, s58, 2359680
  buffer_load_dwordx4 v1, s[24:27], s65 offen lds
  s_add_u32 m0, s59, 81920
  s_add_u32 s65, s58, 2621696
  buffer_load_dwordx4 v1, s[24:27], s65 offen lds
  s_add_u32 m0, s59, 82944
  s_add_u32 s65, s58, 2621824
  buffer_load_dwordx4 v1, s[24:27], s65 offen lds
  s_add_u32 m0, s59, 90112
  s_add_u32 s65, s58, 2883840
  buffer_load_dwordx4 v1, s[24:27], s65 offen lds
  s_add_u32 m0, s59, 91136
  s_add_u32 s65, s58, 2883968
  buffer_load_dwordx4 v1, s[24:27], s65 offen lds
  s_add_u32 m0, s59, 98304
  s_add_u32 s65, s58, 3145984
  buffer_load_dwordx4 v1, s[24:27], s65 offen lds
  s_add_u32 m0, s59, 99328
  s_add_u32 s65, s58, 3146112
  buffer_load_dwordx4 v1, s[24:27], s65 offen lds
  s_add_u32 m0, s59, 106496
  s_add_u32 s65, s58, 3408128
  buffer_load_dwordx4 v1, s[24:27], s65 offen lds
  s_add_u32 m0, s59, 107520
  s_add_u32 s65, s58, 3408256
  buffer_load_dwordx4 v1, s[24:27], s65 offen lds
  s_add_u32 m0, s59, 114688
  s_add_u32 s65, s58, 3670272
  buffer_load_dwordx4 v1, s[24:27], s65 offen lds
  s_add_u32 m0, s59, 115712
  s_add_u32 s65, s58, 3670400
  buffer_load_dwordx4 v1, s[24:27], s65 offen lds
  s_add_u32 m0, s59, 122880
  s_add_u32 s65, s58, 3932416
  buffer_load_dwordx4 v1, s[24:27], s65 offen lds
  s_add_u32 m0, s59, 123904
  s_add_u32 s65, s58, 3932544
  buffer_load_dwordx4 v1, s[24:27], s65 offen lds
  s_add_u32 m0, s59, 131072
  s_add_u32 s65, s58, 4194560
  buffer_load_dwordx4 v1, s[24:27], s65 offen lds
  s_add_u32 m0, s59, 132096
  s_add_u32 s65, s58, 4194688
  buffer_load_dwordx4 v1, s[24:27], s65 offen lds
  s_add_u32 m0, s59, 139264
  s_add_u32 s65, s58, 4456704
  buffer_load_dwordx4 v1, s[24:27], s65 offen lds
  s_add_u32 m0, s59, 140288
  s_add_u32 s65, s58, 4456832
  buffer_load_dwordx4 v1, s[24:27], s65 offen lds
  v_mfma_f32_32x32x16_bf16 v[32:47], v[28:31], a[0:3], 0
  v_mfma_f32_32x32x16_bf16 v[32:47], v[28:31], a[4:7], v[32:47]
  v_mfma_f32_32x32x16_bf16 v[32:47], v[28:31], a[8:11], v[32:47]
  v_mfma_f32_32x32x16_bf16 v[32:47], v[28:31], a[12:15], v[32:47]
  v_mfma_f32_32x32x16_bf16 v[32:47], v[28:31], a[16:19], v[32:47]
  v_mfma_f32_32x32x16_bf16 v[32:47], v[28:31], a[20:23], v[32:47]
  v_mfma_f32_32x32x16_bf16 v[32:47], v[28:31], a[24:27], v[32:47]
  v_mfma_f32_32x32x16_bf16 v[32:47], v[28:31], a[28:31], v[32:47]
  v_mfma_f32_32x32x16_bf16 v[32:47], v[28:31], a[32:35], v[32:47]
  v_mfma_f32_32x32x16_bf16 v[32:47], v[28:31], a[36:39], v[32:47]
  v_mfma_f32_32x32x16_bf16 v[32:47], v[28:31], a[40:43], v[32:47]
  v_mfma_f32_32x32x16_bf16 v[32:47], v[28:31], a[44:47], v[32:47]
  v_mfma_f32_32x32x16_bf16 v[32:47], v[28:31], a[48:51], v[32:47]
  v_mfma_f32_32x32x16_bf16 v[32:47], v[28:31], a[52:55], v[32:47]
  v_mfma_f32_32x32x16_bf16 v[32:47], v[28:31], a[56:59], v[32:47]
  v_mfma_f32_32x32x16_bf16 v[32:47], v[28:31], a[60:63], v[32:47]
  v_mfma_f32_32x32x16_bf16 v[32:47], v[28:31], a[64:67], v[32:47]
  v_mfma_f32_32x32x16_bf16 v[32:47], v[28:31], a[68:71], v[32:47]
  v_mfma_f32_32x32x16_bf16 v[32:47], v[28:31], a[72:75], v[32:47]
  v_mfma_f32_32x32x16_bf16 v[32:47], v[28:31], a[76:79], v[32:47]
  v_mfma_f32_32x32x16_bf16 v[32:47], v[28:31], a[80:83], v[32:47]
  v_mfma_f32_32x32x16_bf16 v[32:47], v[28:31], a[84:87], v[32:47]
  v_mfma_f32_32x32x16_bf16 v[32:47], v[28:31], a[88:91], v[32:47]
  v_mfma_f32_32x32x16_bf16 v[32:47], v[28:31], a[92:95], v[32:47]
  v_mfma_f32_32x32x16_bf16 v[32:47], v[28:31], a[96:99], v[32:47]
  v_mfma_f32_32x32x16_bf16 v[32:47], v[28:31], a[100:103], v[32:47]
  v_mfma_f32_32x32x16_bf16 v[32:47], v[28:31], a[104:107], v[32:47]
  v_mfma_f32_32x32x16_bf16 v[32:47], v[28:31], a[108:111], v[32:47]
  v_mfma_f32_32x32x16_bf16 v[32:47], v[28:31], a[112:115], v[32:47]
  v_mfma_f32_32x32x16_bf16 v[32:47], v[28:31], a[116:119], v[32:47]
  v_mfma_f32_32x32x16_bf16 v[32:47], v[28:31], a[120:123], v[32:47]
  v_mfma_f32_32x32x16_bf16 v[32:47], v[28:31], a[124:127], v[32:47]
  v_mfma_f32_32x32x16_bf16 v[32:47], v[28:31], a[128:131], v[32:47]
  v_mfma_f32_32x32x16_bf16 v[32:47], v[28:31], a[132:135], v[32:47]
  v_mfma_f32_32x32x16_bf16 v[32:47], v[28:31], a[136:139], v[32:47]
  v_mfma_f32_32x32x16_bf16 v[32:47], v[28:31], a[140:143], v[32:47]
  s_waitcnt vmcnt(18)
  s_barrier
  ds_read_b64_tr_b16 a[144:145], v2 offset:0
  ds_read_b64_tr_b16 a[146:147], v3 offset:0
  ds_read_b64_tr_b16 a[148:149], v2 offset:4096
  ds_read_b64_tr_b16 a[150:151], v3 offset:4096
  ds_read_b64_tr_b16 a[152:153], v2 offset:8192
  ds_read_b64_tr_b16 a[154:155], v3 offset:8192
  ds_read_b64_tr_b16 a[156:157], v2 offset:12288
  ds_read_b64_tr_b16 a[158:159], v3 offset:12288
  ds_read_b64_tr_b16 a[160:161], v2 offset:16384
  ds_read_b64_tr_b16 a[162:163], v3 offset:16384
  ds_read_b64_tr_b16 a[164:165], v2 offset:20480
  ds_read_b64_tr_b16 a[166:167], v3 offset:20480
  ds_read_b64_tr_b16 a[168:169], v2 offset:24576
  ds_read_b64_tr_b16 a[170:171], v3 offset:24576
  ds_read_b64_tr_b16 a[172:173], v2 offset:28672
  ds_read_b64_tr_b16 a[174:175], v3 offset:28672
  ds_read_b64_tr_b16 a[176:177], v2 offset:32768
  ds_read_b64_tr_b16 a[178:179], v3 offset:32768
  ds_read_b64_tr_b16 a[180:181], v2 offset:36864
  ds_read_b64_tr_b16 a[182:183], v3 offset:36864
  ds_read_b64_tr_b16 a[184:185], v2 offset:40960
  ds_read_b64_tr_b16 a[186:187], v3 offset:40960
  ds_read_b64_tr_b16 a[188:189], v2 offset:45056
  ds_read_b64_tr_b16 a[190:191], v3 offset:45056
  ds_read_b64_tr_b16 a[192:193], v2 offset:49152
  ds_read_b64_tr_b16 a[194:195], v3 offset:49152
  ds_read_b64_tr_b16 a[196:197], v2 offset:53248
  ds_read_b64_tr_b16 a[198:199], v3 offset:53248
  ds_read_b64_tr_b16 a[200:201], v2 offset:57344
  ds_read_b64_tr_b16 a[202:203], v3 offset:57344
  ds_read_b64_tr_b16 a[204:205], v2 offset:61440
  ds_read_b64_tr_b16 a[206:207], v3 offset:61440
  ds_read_b64_tr_b16 a[208:209], v128 offset:0
  ds_read_b64_tr_b16 a[210:211], v129 offset:0
  ds_read_b64_tr_b16 a[212:213], v128 offset:4096
  ds_read_b64_tr_b16 a[214:215], v129 offset:4096
  s_waitcnt lgkmcnt(0)
  s_barrier
  s_lshl_b32 s59, s5, 10
  s_mov_b32 s60, 0
  s_add_u32 m0, s59, 0
  s_add_u32 s65, s60, 0
  buffer_load_dwordx4 v4, s[8:11], s65 offen lds
  s_add_u32 m0, s59, 4096
  s_add_u32 s65, s60, 128
  buffer_load_dwordx4 v4, s[8:11], s65 offen lds
  s_add_u32 m0, s59, 8192
  s_add_u32 s65, s60, 256
  buffer_load_dwordx4 v4, s[8:11], s65 offen lds
  s_add_u32 m0, s59, 12288
  s_add_u32 s65, s60, 384
  buffer_load_dwordx4 v4, s[8:11], s65 offen lds
  s_add_u32 m0, s59, 16384
  s_add_u32 s65, s60, 512
  buffer_load_dwordx4 v4, s[8:11], s65 offen lds
  s_add_u32 m0, s59, 20480
  s_add_u32 s65, s60, 640
  buffer_load_dwordx4 v4, s[8:11], s65 offen lds
  s_add_u32 m0, s59, 24576
  s_add_u32 s65, s60, 768
  buffer_load_dwordx4 v4, s[8:11], s65 offen lds
  s_add_u32 m0, s59, 28672
  s_add_u32 s65, s60, 896
  buffer_load_dwordx4 v4, s[8:11], s65 offen lds
  s_add_u32 m0, s59, 32768
  s_add_u32 s65, s60, 1024
  buffer_load_dwordx4 v4, s[8:11], s65 offen lds
  s_add_u32 s60, s60, 36864
  s_add_u32 m0, s59, 36864
  s_add_u32 s65, s60, 0
  buffer_load_dwordx4 v4, s[8:11], s65 offen lds
  s_add_u32 m0, s59, 40960
  s_add_u32 s65, s60, 128
  buffer_load_dwordx4 v4, s[8:11], s65 offen lds
  s_add_u32 m0, s59, 45056
  s_add_u32 s65, s60, 256
  buffer_load_dwordx4 v4, s[8:11], s65 offen lds
  s_add_u32 m0, s59, 49152
  s_add_u32 s65, s60, 384
  buffer_load_dwordx4 v4, s[8:11], s65 offen lds
  s_add_u32 m0, s59, 53248
  s_add_u32 s65, s60, 512
  buffer_load_dwordx4 v4, s[8:11], s65 offen lds
  s_add_u32 m0, s59, 57344
  s_add_u32 s65, s60, 640
  buffer_load_dwordx4 v4, s[8:11], s65 offen lds
  s_add_u32 m0, s59, 61440
  s_add_u32 s65, s60, 768
  buffer_load_dwordx4 v4, s[8:11], s65 offen lds
  s_add_u32 m0, s59, 65536
  s_add_u32 s65, s60, 896
  buffer_load_dwordx4 v4, s[8:11], s65 offen lds
  s_add_u32 m0, s59, 69632
  s_add_u32 s65, s60, 1024
  buffer_load_dwordx4 v4, s[8:11], s65 offen lds
  s_add_u32 s60, s60, 36864
  s_waitcnt vmcnt(18)
  s_barrier
  ds_read_b64_tr_b16 a[216:217], v128 offset:8192
  ds_read_b64_tr_b16 a[218:219], v129 offset:8192
  ds_read_b64_tr_b16 a[220:221], v128 offset:12288
  ds_read_b64_tr_b16 a[222:223], v129 offset:12288
  ds_read_b64_tr_b16 a[224:225], v128 offset:16384
  ds_read_b64_tr_b16 a[226:227], v129 offset:16384
  ds_read_b64_tr_b16 a[228:229], v128 offset:20480
  ds_read_b64_tr_b16 a[230:231], v129 offset:20480
  ds_read_b64_tr_b16 a[232:233], v128 offset:24576
  ds_read_b64_tr_b16 a[234:235], v129 offset:24576
  ds_read_b64_tr_b16 a[236:237], v128 offset:28672
  ds_read_b64_tr_b16 a[238:239], v129 offset:28672
  ds_read_b64_tr_b16 a[240:241], v128 offset:32768
  ds_read_b64_tr_b16 a[242:243], v129 offset:32768
  ds_read_b64_tr_b16 a[244:245], v128 offset:36864
  ds_read_b64_tr_b16 a[246:247], v129 offset:36864
  ds_read_b64_tr_b16 a[248:249], v128 offset:40960
  ds_read_b64_tr_b16 a[250:251], v129 offset:40960
  ds_read_b64_tr_b16 a[252:253], v128 offset:45056
  ds_read_b64_tr_b16 a[254:255], v129 offset:45056
  ds_read_b64_tr_b16 v[224:225], v128 offset:49152
  ds_read_b64_tr_b16 v[226:227], v129 offset:49152
  ds_read_b64_tr_b16 v[228:229], v128 offset:53248
  ds_read_b64_tr_b16 v[230:231], v129 offset:53248
  ds_read_b64_tr_b16 v[232:233], v128 offset:57344
  ds_read_b64_tr_b16 v[234:235], v129 offset:57344
  ds_read_b64_tr_b16 v[236:237], v128 offset:61440
  ds_read_b64_tr_b16 v[238:239], v129 offset:61440
  ds_read_b64_tr_b16 v[240:241], v130 offset:0
  ds_read_b64_tr_b16 v[242:243], v131 offset:0
  ds_read_b64_tr_b16 v[244:245], v130 offset:4096
  ds_read_b64_tr_b16 v[246:247], v131 offset:4096
  ds_read_b64_tr_b16 v[248:249], v130 offset:8192
  ds_read_b64_tr_b16 v[250:251], v131 offset:8192
  ds_read_b64_tr_b16 v[252:253], v130 offset:12288
  ds_read_b64_tr_b16 v[254:255], v131 offset:12288
  s_mov_b32 s65, 1048576
POLLD_46:
  buffer_load_dword v7, off, s[48:51], 0 offset:64 sc1
  s_waitcnt vmcnt(0)
  v_readfirstlane_b32 s66, v7
  s_sub_u32 s65, s65, 1
  s_cbranch_scc1 POLLE_47
  s_cmp_lt_u32 s66, 32
  s_cbranch_scc1 POLLD_46
POLLE_47:
  v_lshlrev_b32 v7, 4, v0
  s_lshl_b32 s65, s5, 12
  s_add_u32 m0, s65, 147456
  s_add_u32 s65, s65, 113246208
  buffer_load_dwordx4 v7, s[52:55], s65 offen offset:0 sc1 lds
  buffer_load_dwordx4 v7, s[52:55], s65 offen offset:1024 sc1 lds
  buffer_load_dwordx4 v7, s[52:55], s65 offen offset:2048 sc1 lds
  buffer_load_dwordx4 v7, s[52:55], s65 offen offset:3072 sc1 lds
  s_waitcnt lgkmcnt(0)
  s_barrier
  s_add_u32 m0, s59, 73728
  s_add_u32 s65, s60, 0
  buffer_load_dwordx4 v4, s[8:11], s65 offen lds
  s_add_u32 m0, s59, 77824
  s_add_u32 s65, s60, 128
  buffer_load_dwordx4 v4, s[8:11], s65 offen lds
  s_add_u32 m0, s59, 81920
  s_add_u32 s65, s60, 256
  buffer_load_dwordx4 v4, s[8:11], s65 offen lds
  s_add_u32 m0, s59, 86016
  s_add_u32 s65, s60, 384
  buffer_load_dwordx4 v4, s[8:11], s65 offen lds
  s_add_u32 m0, s59, 90112
  s_add_u32 s65, s60, 512
  buffer_load_dwordx4 v4, s[8:11], s65 offen lds
  s_add_u32 m0, s59, 94208
  s_add_u32 s65, s60, 640
  buffer_load_dwordx4 v4, s[8:11], s65 offen lds
  s_add_u32 m0, s59, 98304
  s_add_u32 s65, s60, 768
  buffer_load_dwordx4 v4, s[8:11], s65 offen lds
  s_add_u32 m0, s59, 102400
  s_add_u32 s65, s60, 896
  buffer_load_dwordx4 v4, s[8:11], s65 offen lds
  s_add_u32 m0, s59, 106496
  s_add_u32 s65, s60, 1024
  buffer_load_dwordx4 v4, s[8:11], s65 offen lds
  s_add_u32 s60, s60, 36864
  v_mfma_f32_32x32x16_bf16 v[48:63], v[28:31], a[144:147], 0
  v_mfma_f32_32x32x16_bf16 v[48:63], v[28:31], a[148:151], v[48:63]
  v_mfma_f32_32x32x16_bf16 v[48:63], v[28:31], a[152:155], v[48:63]
  v_mfma_f32_32x32x16_bf16 v[48:63], v[28:31], a[156:159], v[48:63]
  v_mfma_f32_32x32x16_bf16 v[48:63], v[28:31], a[160:163], v[48:63]
  v_mfma_f32_32x32x16_bf16 v[48:63], v[28:31], a[164:167], v[48:63]
  v_mfma_f32_32x32x16_bf16 v[48:63], v[28:31], a[168:171], v[48:63]
  v_mfma_f32_32x32x16_bf16 v[48:63], v[28:31], a[172:175], v[48:63]
  v_mfma_f32_32x32x16_bf16 v[48:63], v[28:31], a[176:179], v[48:63]
  v_mfma_f32_32x32x16_bf16 v[48:63], v[28:31], a[180:183], v[48:63]
  v_mfma_f32_32x32x16_bf16 v[48:63], v[28:31], a[184:187], v[48:63]
  v_mfma_f32_32x32x16_bf16 v[48:63], v[28:31], a[188:191], v[48:63]
  v_mfma_f32_32x32x16_bf16 v[48:63], v[28:31], a[192:195], v[48:63]
  v_mfma_f32_32x32x16_bf16 v[48:63], v[28:31], a[196:199], v[48:63]
  v_mfma_f32_32x32x16_bf16 v[48:63], v[28:31], a[200:203], v[48:63]
  v_mfma_f32_32x32x16_bf16 v[48:63], v[28:31], a[204:207], v[48:63]
  v_mfma_f32_32x32x16_bf16 v[48:63], v[28:31], a[208:211], v[48:63]
  v_mfma_f32_32x32x16_bf16 v[48:63], v[28:31], a[212:215], v[48:63]
  v_mfma_f32_32x32x16_bf16 v[48:63], v[28:31], a[216:219], v[48:63]
  v_mfma_f32_32x32x16_bf16 v[48:63], v[28:31], a[220:223], v[48:63]
  v_mfma_f32_32x32x16_bf16 v[48:63], v[28:31], a[224:227], v[48:63]
  v_mfma_f32_32x32x16_bf16 v[48:63], v[28:31], a[228:231], v[48:63]
  v_mfma_f32_32x32x16_bf16 v[48:63], v[28:31], a[232:235], v[48:63]
  v_mfma_f32_32x32x16_bf16 v[48:63], v[28:31], a[236:239], v[48:63]
  v_mfma_f32_32x32x16_bf16 v[48:63], v[28:31], a[240:243], v[48:63]
  v_mfma_f32_32x32x16_bf16 v[48:63], v[28:31], a[244:247], v[48:63]
  v_mfma_f32_32x32x16_bf16 v[48:63], v[28:31], a[248:251], v[48:63]
  v_mfma_f32_32x32x16_bf16 v[48:63], v[28:31], a[252:255], v[48:63]
  v_mfma_f32_32x32x16_bf16 v[48:63], v[28:31], v[224:227], v[48:63]
  v_mfma_f32_32x32x16_bf16 v[48:63], v[28:31], v[228:231], v[48:63]
  v_mfma_f32_32x32x16_bf16 v[48:63], v[28:31], v[232:235], v[48:63]
  v_mfma_f32_32x32x16_bf16 v[48:63], v[28:31], v[236:239], v[48:63]
  v_mfma_f32_32x32x16_bf16 v[48:63], v[28:31], v[240:243], v[48:63]
  v_mfma_f32_32x32x16_bf16 v[48:63], v[28:31], v[244:247], v[48:63]
  v_mfma_f32_32x32x16_bf16 v[48:63], v[28:31], v[248:251], v[48:63]
  v_mfma_f32_32x32x16_bf16 v[48:63], v[28:31], v[252:255], v[48:63]
  s_mov_b32 s61, 0x10000000
  s_mov_b32 s62, 0x10000000
  s_mov_b32 s64, -1
  s_mov_b32 s57, 16
  s_waitcnt lgkmcnt(0)
  s_branch QKV_FIRST_49
QKV_LOOP_48:
  s_waitcnt vmcnt(9) lgkmcnt(0)
QKV_FIRST_49:
  s_barrier
  s_cmp_lg_u32 s5, 0
  s_cbranch_scc1 QF_50
  s_sub_i32 s65, s64, 0
  s_max_i32 s65, s65, 0
  v_mov_b32 v7, s65
  s_mov_b64 exec, 3
  buffer_store_dword v7, v11, s[52:55], s63 offen sc1
  s_mov_b64 exec, -1
QF_50:
  s_add_u32 s64, s64, 1
  ds_read_b128 v[128:131], v12 offset:0
  ds_read_b128 v[132:135], v13 offset:0
  ds_read_b128 v[136:139], v14 offset:0
  ds_read_b128 v[140:143], v15 offset:0
  ds_read_b128 v[144:147], v12 offset:4096
  s_waitcnt lgkmcnt(4)
  v_mfma_f32_32x32x16_bf16 v[64:79], v[128:131], a[0:3], 0
  ds_read_b128 v[152:155], v6 offset:0
  ds_read_b128 v[168:171], v6 offset:128
  ds_read_b128 v[156:159], v6 offset:32
  v_mfma_f32_32x32x16_bf16 v[80:95], v[128:131], a[144:147], 0
  ds_read_b128 v[148:151], v13 offset:4096
  ds_read_b128 v[172:175], v6 offset:160
  ds_read_b128 v[160:163], v6 offset:64
  s_waitcnt lgkmcnt(9)
  v_mfma_f32_32x32x16_bf16 v[64:79], v[132:135], a[4:7], v[64:79]
  ds_read_b128 v[176:179], v6 offset:192
  ds_read_b128 v[164:167], v6 offset:96
  v_mfma_f32_32x32x16_bf16 v[80:95], v[132:135], a[148:151], v[80:95]
  ds_read_b128 v[128:131], v14 offset:4096
  ds_read_b128 v[180:183], v6 offset:224
  v_add_u32 v6, 256, v6
  s_waitcnt lgkmcnt(12)
  v_mfma_f32_32x32x16_bf16 v[64:79], v[136:139], a[8:11], v[64:79]
  s_waitcnt lgkmcnt(9)
  v_fma_f32 v96, -v152, v32, v96
  v_fma_f32 v97, -v153, v32, v97
  v_mfma_f32_32x32x16_bf16 v[80:95], v[136:139], a[152:155], v[80:95]
  ds_read_b128 v[132:135], v15 offset:4096
  s_waitcnt lgkmcnt(9)
  v_mul_f32 v96, v168, v96
  v_mul_f32 v97, v169, v97
  v_mfma_f32_32x32x16_bf16 v[64:79], v[140:143], a[12:15], v[64:79]
  v_cvt_pk_bf16_f32 v184, v96, v97
  v_fma_f32 v98, -v154, v32, v98
  v_mfma_f32_32x32x16_bf16 v[80:95], v[140:143], a[156:159], v[80:95]
  ds_read_b128 v[136:139], v12 offset:8192
  v_fma_f32 v99, -v155, v32, v99
  v_mul_f32 v98, v170, v98
  v_mfma_f32_32x32x16_bf16 v[64:79], v[144:147], a[16:19], v[64:79]
  v_mul_f32 v99, v171, v99
  v_cvt_pk_bf16_f32 v185, v98, v99
  v_mfma_f32_32x32x16_bf16 v[80:95], v[144:147], a[160:163], v[80:95]
  ds_read_b128 v[140:143], v13 offset:8192
  s_waitcnt lgkmcnt(10)
  v_fma_f32 v100, -v156, v32, v100
  v_fma_f32 v101, -v157, v32, v101
  s_waitcnt lgkmcnt(9)
  v_mfma_f32_32x32x16_bf16 v[64:79], v[148:151], a[20:23], v[64:79]
  s_waitcnt lgkmcnt(8)
  v_mul_f32 v100, v172, v100
  v_mul_f32 v101, v173, v101
  v_mfma_f32_32x32x16_bf16 v[80:95], v[148:151], a[164:167], v[80:95]
  ds_read_b128 v[144:147], v14 offset:8192
  v_cvt_pk_bf16_f32 v186, v100, v101
  v_fma_f32 v102, -v158, v32, v102
  s_waitcnt lgkmcnt(5)
  v_mfma_f32_32x32x16_bf16 v[64:79], v[128:131], a[24:27], v[64:79]
  v_fma_f32 v103, -v159, v32, v103
  v_mul_f32 v102, v174, v102
  v_mfma_f32_32x32x16_bf16 v[80:95], v[128:131], a[168:171], v[80:95]
  ds_read_b128 v[148:151], v15 offset:8192
  v_mul_f32 v103, v175, v103
  v_cvt_pk_bf16_f32 v187, v102, v103
  s_waitcnt lgkmcnt(4)
  v_mfma_f32_32x32x16_bf16 v[64:79], v[132:135], a[28:31], v[64:79]
  buffer_store_dwordx4 v[184:187], v5, s[52:55], s61 offen offset:0 sc1
  v_fma_f32 v104, -v160, v32, v104
  v_mfma_f32_32x32x16_bf16 v[80:95], v[132:135], a[172:175], v[80:95]
  ds_read_b128 v[128:131], v12 offset:12288
  v_fma_f32 v105, -v161, v32, v105
  v_mul_f32 v104, v176, v104
  s_waitcnt lgkmcnt(4)
  v_mfma_f32_32x32x16_bf16 v[64:79], v[136:139], a[32:35], v[64:79]
  v_mul_f32 v105, v177, v105
  v_cvt_pk_bf16_f32 v188, v104, v105
  v_mfma_f32_32x32x16_bf16 v[80:95], v[136:139], a[176:179], v[80:95]
  ds_read_b128 v[132:135], v13 offset:12288
  v_fma_f32 v106, -v162, v32, v106
  v_fma_f32 v107, -v163, v32, v107
  s_waitcnt lgkmcnt(4)
  v_mfma_f32_32x32x16_bf16 v[64:79], v[140:143], a[36:39], v[64:79]
  v_mul_f32 v106, v178, v106
  v_mul_f32 v107, v179, v107
  v_mfma_f32_32x32x16_bf16 v[80:95], v[140:143], a[180:183], v[80:95]
  ds_read_b128 v[136:139], v14 offset:12288
  v_cvt_pk_bf16_f32 v189, v106, v107
  v_fma_f32 v108, -v164, v32, v108
  s_waitcnt lgkmcnt(4)
  v_mfma_f32_32x32x16_bf16 v[64:79], v[144:147], a[40:43], v[64:79]
  v_fma_f32 v109, -v165, v32, v109
  v_mul_f32 v108, v180, v108
  v_mfma_f32_32x32x16_bf16 v[80:95], v[144:147], a[184:187], v[80:95]
  ds_read_b128 v[140:143], v15 offset:12288
  v_mul_f32 v109, v181, v109
  v_cvt_pk_bf16_f32 v190, v108, v109
  s_waitcnt lgkmcnt(4)
  v_mfma_f32_32x32x16_bf16 v[64:79], v[148:151], a[44:47], v[64:79]
  v_fma_f32 v110, -v166, v32, v110
  v_fma_f32 v111, -v167, v32, v111
  v_mfma_f32_32x32x16_bf16 v[80:95], v[148:151], a[188:191], v[80:95]
  ds_read_b128 v[144:147], v12 offset:16384
  v_mul_f32 v110, v182, v110
  v_mul_f32 v111, v183, v111
  v_cvt_pk_bf16_f32 v191, v110, v111
  s_waitcnt lgkmcnt(4)
  v_mfma_f32_32x32x16_bf16 v[64:79], v[128:131], a[48:51], v[64:79]
  buffer_store_dwordx4 v[188:191], v5, s[52:55], s61 offen offset:512 sc1
  v_fma_f32 v112, -v152, v48, v112
  v_mfma_f32_32x32x16_bf16 v[80:95], v[128:131], a[192:195], v[80:95]
  ds_read_b128 v[148:151], v13 offset:16384
  v_fma_f32 v113, -v153, v48, v113
  v_mul_f32 v112, v168, v112
  s_waitcnt lgkmcnt(4)
  v_mfma_f32_32x32x16_bf16 v[64:79], v[132:135], a[52:55], v[64:79]
  v_mul_f32 v113, v169, v113
  v_cvt_pk_bf16_f32 v192, v112, v113
  v_mfma_f32_32x32x16_bf16 v[80:95], v[132:135], a[196:199], v[80:95]
  ds_read_b128 v[128:131], v14 offset:16384
  v_fma_f32 v114, -v154, v48, v114
  v_fma_f32 v115, -v155, v48, v115
  s_waitcnt lgkmcnt(4)
  v_mfma_f32_32x32x16_bf16 v[64:79], v[136:139], a[56:59], v[64:79]
  v_mul_f32 v114, v170, v114
  v_mul_f32 v115, v171, v115
  v_mfma_f32_32x32x16_bf16 v[80:95], v[136:139], a[200:203], v[80:95]
  ds_read_b128 v[132:135], v15 offset:16384
  v_cvt_pk_bf16_f32 v193, v114, v115
  v_fma_f32 v116, -v156, v48, v116
  s_waitcnt lgkmcnt(4)
  v_mfma_f32_32x32x16_bf16 v[64:79], v[140:143], a[60:63], v[64:79]
  v_fma_f32 v117, -v157, v48, v117
  v_mul_f32 v116, v172, v116
  v_mfma_f32_32x32x16_bf16 v[80:95], v[140:143], a[204:207], v[80:95]
  ds_read_b128 v[136:139], v12 offset:20480
  v_mul_f32 v117, v173, v117
  v_cvt_pk_bf16_f32 v194, v116, v117
  s_waitcnt lgkmcnt(4)
  v_mfma_f32_32x32x16_bf16 v[64:79], v[144:147], a[64:67], v[64:79]
  v_fma_f32 v118, -v158, v48, v118
  v_fma_f32 v119, -v159, v48, v119
  v_mfma_f32_32x32x16_bf16 v[80:95], v[144:147], a[208:211], v[80:95]
  ds_read_b128 v[140:143], v13 offset:20480
  v_mul_f32 v118, v174, v118
  v_mul_f32 v119, v175, v119
  s_waitcnt lgkmcnt(4)
  v_mfma_f32_32x32x16_bf16 v[64:79], v[148:151], a[68:71], v[64:79]
  v_cvt_pk_bf16_f32 v195, v118, v119
  buffer_store_dwordx4 v[192:195], v5, s[52:55], s62 offen offset:0 sc1
  v_mfma_f32_32x32x16_bf16 v[80:95], v[148:151], a[212:215], v[80:95]
  ds_read_b128 v[144:147], v14 offset:20480
  v_fma_f32 v120, -v160, v48, v120
  v_fma_f32 v121, -v161, v48, v121
  s_waitcnt lgkmcnt(4)
  v_mfma_f32_32x32x16_bf16 v[64:79], v[128:131], a[72:75], v[64:79]
  v_mul_f32 v120, v176, v120
  v_mul_f32 v121, v177, v121
  v_mfma_f32_32x32x16_bf16 v[80:95], v[128:131], a[216:219], v[80:95]
  ds_read_b128 v[148:151], v15 offset:20480
  v_cvt_pk_bf16_f32 v196, v120, v121
  v_fma_f32 v122, -v162, v48, v122
  s_waitcnt lgkmcnt(4)
  v_mfma_f32_32x32x16_bf16 v[64:79], v[132:135], a[76:79], v[64:79]
  v_fma_f32 v123, -v163, v48, v123
  v_mul_f32 v122, v178, v122
  v_mfma_f32_32x32x16_bf16 v[80:95], v[132:135], a[220:223], v[80:95]
  ds_read_b128 v[128:131], v12 offset:24576
  v_mul_f32 v123, v179, v123
  v_cvt_pk_bf16_f32 v197, v122, v123
  s_waitcnt lgkmcnt(4)
  v_mfma_f32_32x32x16_bf16 v[64:79], v[136:139], a[80:83], v[64:79]
  v_fma_f32 v124, -v164, v48, v124
  v_fma_f32 v125, -v165, v48, v125
  v_mfma_f32_32x32x16_bf16 v[80:95], v[136:139], a[224:227], v[80:95]
  ds_read_b128 v[132:135], v13 offset:24576
  v_mul_f32 v124, v180, v124
  v_mul_f32 v125, v181, v125
  s_waitcnt lgkmcnt(4)
  v_mfma_f32_32x32x16_bf16 v[64:79], v[140:143], a[84:87], v[64:79]
  v_cvt_pk_bf16_f32 v198, v124, v125
  v_fma_f32 v126, -v166, v48, v126
  v_mfma_f32_32x32x16_bf16 v[80:95], v[140:143], a[228:231], v[80:95]
  ds_read_b128 v[136:139], v14 offset:24576
  v_fma_f32 v127, -v167, v48, v127
  v_mul_f32 v126, v182, v126
  s_waitcnt lgkmcnt(4)
  v_mfma_f32_32x32x16_bf16 v[64:79], v[144:147], a[88:91], v[64:79]
  v_mul_f32 v127, v183, v127
  v_cvt_pk_bf16_f32 v199, v126, v127
  v_mfma_f32_32x32x16_bf16 v[80:95], v[144:147], a[232:235], v[80:95]
  ds_read_b128 v[140:143], v15 offset:24576
  buffer_store_dwordx4 v[196:199], v5, s[52:55], s62 offen offset:512 sc1
  s_lshl_b32 s61, s64, 18
  s_lshl_b32 s66, s56, 13
  s_add_u32 s66, s66, 33554432
  s_add_u32 s61, s61, s66
  s_add_u32 s62, s61, 8192
  s_waitcnt lgkmcnt(4)
  v_mfma_f32_32x32x16_bf16 v[64:79], v[148:151], a[92:95], v[64:79]
  v_mfma_f32_32x32x16_bf16 v[80:95], v[148:151], a[236:239], v[80:95]
  ds_read_b128 v[144:147], v12 offset:28672
  s_waitcnt lgkmcnt(4)
  v_mfma_f32_32x32x16_bf16 v[64:79], v[128:131], a[96:99], v[64:79]
  s_add_u32 m0, s59, 110592
  s_add_u32 s65, s60, 0
  buffer_load_dwordx4 v4, s[8:11], s65 offen lds
  v_mfma_f32_32x32x16_bf16 v[80:95], v[128:131], a[240:243], v[80:95]
  ds_read_b128 v[148:151], v13 offset:28672
  s_waitcnt lgkmcnt(4)
  v_mfma_f32_32x32x16_bf16 v[64:79], v[132:135], a[100:103], v[64:79]
  s_add_u32 m0, s59, 114688
  s_add_u32 s65, s60, 128
  buffer_load_dwordx4 v4, s[8:11], s65 offen lds
  v_mfma_f32_32x32x16_bf16 v[80:95], v[132:135], a[244:247], v[80:95]
  ds_read_b128 v[128:131], v14 offset:28672
  s_waitcnt lgkmcnt(4)
  v_mfma_f32_32x32x16_bf16 v[64:79], v[136:139], a[104:107], v[64:79]
  s_add_u32 m0, s59, 118784
  s_add_u32 s65, s60, 256
  buffer_load_dwordx4 v4, s[8:11], s65 offen lds
  v_mfma_f32_32x32x16_bf16 v[80:95], v[136:139], a[248:251], v[80:95]
  ds_read_b128 v[132:135], v15 offset:28672
  s_waitcnt lgkmcnt(4)
  v_mfma_f32_32x32x16_bf16 v[64:79], v[140:143], a[108:111], v[64:79]
  s_add_u32 m0, s59, 122880
  s_add_u32 s65, s60, 384
  buffer_load_dwordx4 v4, s[8:11], s65 offen lds
  v_mfma_f32_32x32x16_bf16 v[80:95], v[140:143], a[252:255], v[80:95]
  ds_read_b128 v[136:139], v12 offset:32768
  s_waitcnt lgkmcnt(4)
  v_mfma_f32_32x32x16_bf16 v[64:79], v[144:147], a[112:115], v[64:79]
  s_add_u32 m0, s59, 126976
  s_add_u32 s65, s60, 512
  buffer_load_dwordx4 v4, s[8:11], s65 offen lds
  v_mfma_f32_32x32x16_bf16 v[80:95], v[144:147], v[224:227], v[80:95]
  ds_read_b128 v[140:143], v13 offset:32768
  s_waitcnt lgkmcnt(4)
  v_mfma_f32_32x32x16_bf16 v[64:79], v[148:151], a[116:119], v[64:79]
  s_add_u32 m0, s59, 131072
  s_add_u32 s65, s60, 640
  buffer_load_dwordx4 v4, s[8:11], s65 offen lds
  v_mfma_f32_32x32x16_bf16 v[80:95], v[148:151], v[228:231], v[80:95]
  ds_read_b128 v[144:147], v14 offset:32768
  s_waitcnt lgkmcnt(4)
  v_mfma_f32_32x32x16_bf16 v[64:79], v[128:131], a[120:123], v[64:79]
  s_add_u32 m0, s59, 135168
  s_add_u32 s65, s60, 768
  buffer_load_dwordx4 v4, s[8:11], s65 offen lds
  v_mfma_f32_32x32x16_bf16 v[80:95], v[128:131], v[232:235], v[80:95]
  ds_read_b128 v[148:151], v15 offset:32768
  s_waitcnt lgkmcnt(4)
  v_mfma_f32_32x32x16_bf16 v[64:79], v[132:135], a[124:127], v[64:79]
  s_add_u32 m0, s59, 139264
  s_add_u32 s65, s60, 896
  buffer_load_dwordx4 v4, s[8:11], s65 offen lds
  v_mfma_f32_32x32x16_bf16 v[80:95], v[132:135], v[236:239], v[80:95]
  s_waitcnt lgkmcnt(3)
  v_mfma_f32_32x32x16_bf16 v[64:79], v[136:139], a[128:131], v[64:79]
  s_add_u32 m0, s59, 143360
  s_add_u32 s65, s60, 1024
  buffer_load_dwordx4 v4, s[8:11], s65 offen lds
  v_mfma_f32_32x32x16_bf16 v[80:95], v[136:139], v[240:243], v[80:95]
  s_waitcnt lgkmcnt(2)
  v_mfma_f32_32x32x16_bf16 v[64:79], v[140:143], a[132:135], v[64:79]
  s_add_u32 s60, s60, 36864
  v_mfma_f32_32x32x16_bf16 v[80:95], v[140:143], v[244:247], v[80:95]
  s_waitcnt lgkmcnt(1)
  v_mfma_f32_32x32x16_bf16 v[64:79], v[144:147], a[136:139], v[64:79]
  v_mfma_f32_32x32x16_bf16 v[80:95], v[144:147], v[248:251], v[80:95]
  s_waitcnt lgkmcnt(0)
  v_mfma_f32_32x32x16_bf16 v[64:79], v[148:151], a[140:143], v[64:79]
  v_mfma_f32_32x32x16_bf16 v[80:95], v[148:151], v[252:255], v[80:95]
  s_waitcnt vmcnt(9) lgkmcnt(0)
  s_barrier
  s_cmp_lg_u32 s5, 0
  s_cbranch_scc1 QF_51
  s_sub_i32 s65, s64, 0
  s_max_i32 s65, s65, 0
  v_mov_b32 v7, s65
  s_mov_b64 exec, 3
  buffer_store_dword v7, v11, s[52:55], s63 offen sc1
  s_mov_b64 exec, -1
QF_51:
  s_add_u32 s64, s64, 1
  ds_read_b128 v[128:131], v16 offset:0
  ds_read_b128 v[132:135], v17 offset:0
  ds_read_b128 v[136:139], v18 offset:0
  ds_read_b128 v[140:143], v19 offset:0
  ds_read_b128 v[144:147], v16 offset:4096
  s_waitcnt lgkmcnt(4)
  v_mfma_f32_32x32x16_bf16 v[96:111], v[128:131], a[0:3], 0
  ds_read_b128 v[152:155], v6 offset:0
  ds_read_b128 v[168:171], v6 offset:128
  ds_read_b128 v[156:159], v6 offset:32
  v_mfma_f32_32x32x16_bf16 v[112:127], v[128:131], a[144:147], 0
  ds_read_b128 v[148:151], v17 offset:4096
  ds_read_b128 v[172:175], v6 offset:160
  ds_read_b128 v[160:163], v6 offset:64
  s_waitcnt lgkmcnt(9)
  v_mfma_f32_32x32x16_bf16 v[96:111], v[132:135], a[4:7], v[96:111]
  ds_read_b128 v[176:179], v6 offset:192
  ds_read_b128 v[164:167], v6 offset:96
  v_mfma_f32_32x32x16_bf16 v[112:127], v[132:135], a[148:151], v[112:127]
  ds_read_b128 v[128:131], v18 offset:4096
  ds_read_b128 v[180:183], v6 offset:224
  v_add_u32 v6, 256, v6
  s_waitcnt lgkmcnt(12)
  v_mfma_f32_32x32x16_bf16 v[96:111], v[136:139], a[8:11], v[96:111]
  s_waitcnt lgkmcnt(9)
  v_fma_f32 v64, -v152, v32, v64
  v_fma_f32 v65, -v153, v32, v65
  v_mfma_f32_32x32x16_bf16 v[112:127], v[136:139], a[152:155], v[112:127]
  ds_read_b128 v[132:135], v19 offset:4096
  s_waitcnt lgkmcnt(9)
  v_mul_f32 v64, v168, v64
  v_mul_f32 v65, v169, v65
  v_mfma_f32_32x32x16_bf16 v[96:111], v[140:143], a[12:15], v[96:111]
  v_cvt_pk_bf16_f32 v184, v64, v65
  v_fma_f32 v66, -v154, v32, v66
  v_mfma_f32_32x32x16_bf16 v[112:127], v[140:143], a[156:159], v[112:127]
  ds_read_b128 v[136:139], v16 offset:8192
  v_fma_f32 v67, -v155, v32, v67
  v_mul_f32 v66, v170, v66
  v_mfma_f32_32x32x16_bf16 v[96:111], v[144:147], a[16:19], v[96:111]
  v_mul_f32 v67, v171, v67
  v_cvt_pk_bf16_f32 v185, v66, v67
  v_mfma_f32_32x32x16_bf16 v[112:127], v[144:147], a[160:163], v[112:127]
  ds_read_b128 v[140:143], v17 offset:8192
  s_waitcnt lgkmcnt(10)
  v_fma_f32 v68, -v156, v32, v68
  v_fma_f32 v69, -v157, v32, v69
  s_waitcnt lgkmcnt(9)
  v_mfma_f32_32x32x16_bf16 v[96:111], v[148:151], a[20:23], v[96:111]
  s_waitcnt lgkmcnt(8)
  v_mul_f32 v68, v172, v68
  v_mul_f32 v69, v173, v69
  v_mfma_f32_32x32x16_bf16 v[112:127], v[148:151], a[164:167], v[112:127]
  ds_read_b128 v[144:147], v18 offset:8192
  v_cvt_pk_bf16_f32 v186, v68, v69
  v_fma_f32 v70, -v158, v32, v70
  s_waitcnt lgkmcnt(5)
  v_mfma_f32_32x32x16_bf16 v[96:111], v[128:131], a[24:27], v[96:111]
  v_fma_f32 v71, -v159, v32, v71
  v_mul_f32 v70, v174, v70
  v_mfma_f32_32x32x16_bf16 v[112:127], v[128:131], a[168:171], v[112:127]
  ds_read_b128 v[148:151], v19 offset:8192
  v_mul_f32 v71, v175, v71
  v_cvt_pk_bf16_f32 v187, v70, v71
  s_waitcnt lgkmcnt(4)
  v_mfma_f32_32x32x16_bf16 v[96:111], v[132:135], a[28:31], v[96:111]
  buffer_store_dwordx4 v[184:187], v5, s[52:55], s61 offen offset:0 sc1
  v_fma_f32 v72, -v160, v32, v72
  v_mfma_f32_32x32x16_bf16 v[112:127], v[132:135], a[172:175], v[112:127]
  ds_read_b128 v[128:131], v16 offset:12288
  v_fma_f32 v73, -v161, v32, v73
  v_mul_f32 v72, v176, v72
  s_waitcnt lgkmcnt(4)
  v_mfma_f32_32x32x16_bf16 v[96:111], v[136:139], a[32:35], v[96:111]
  v_mul_f32 v73, v177, v73
  v_cvt_pk_bf16_f32 v188, v72, v73
  v_mfma_f32_32x32x16_bf16 v[112:127], v[136:139], a[176:179], v[112:127]
  ds_read_b128 v[132:135], v17 offset:12288
  v_fma_f32 v74, -v162, v32, v74
  v_fma_f32 v75, -v163, v32, v75
  s_waitcnt lgkmcnt(4)
  v_mfma_f32_32x32x16_bf16 v[96:111], v[140:143], a[36:39], v[96:111]
  v_mul_f32 v74, v178, v74
  v_mul_f32 v75, v179, v75
  v_mfma_f32_32x32x16_bf16 v[112:127], v[140:143], a[180:183], v[112:127]
  ds_read_b128 v[136:139], v18 offset:12288
  v_cvt_pk_bf16_f32 v189, v74, v75
  v_fma_f32 v76, -v164, v32, v76
  s_waitcnt lgkmcnt(4)
  v_mfma_f32_32x32x16_bf16 v[96:111], v[144:147], a[40:43], v[96:111]
  v_fma_f32 v77, -v165, v32, v77
  v_mul_f32 v76, v180, v76
  v_mfma_f32_32x32x16_bf16 v[112:127], v[144:147], a[184:187], v[112:127]
  ds_read_b128 v[140:143], v19 offset:12288
  v_mul_f32 v77, v181, v77
  v_cvt_pk_bf16_f32 v190, v76, v77
  s_waitcnt lgkmcnt(4)
  v_mfma_f32_32x32x16_bf16 v[96:111], v[148:151], a[44:47], v[96:111]
  v_fma_f32 v78, -v166, v32, v78
  v_fma_f32 v79, -v167, v32, v79
  v_mfma_f32_32x32x16_bf16 v[112:127], v[148:151], a[188:191], v[112:127]
  ds_read_b128 v[144:147], v16 offset:16384
  v_mul_f32 v78, v182, v78
  v_mul_f32 v79, v183, v79
  v_cvt_pk_bf16_f32 v191, v78, v79
  s_waitcnt lgkmcnt(4)
  v_mfma_f32_32x32x16_bf16 v[96:111], v[128:131], a[48:51], v[96:111]
  buffer_store_dwordx4 v[188:191], v5, s[52:55], s61 offen offset:512 sc1
  v_fma_f32 v80, -v152, v48, v80
  v_mfma_f32_32x32x16_bf16 v[112:127], v[128:131], a[192:195], v[112:127]
  ds_read_b128 v[148:151], v17 offset:16384
  v_fma_f32 v81, -v153, v48, v81
  v_mul_f32 v80, v168, v80
  s_waitcnt lgkmcnt(4)
  v_mfma_f32_32x32x16_bf16 v[96:111], v[132:135], a[52:55], v[96:111]
  v_mul_f32 v81, v169, v81
  v_cvt_pk_bf16_f32 v192, v80, v81
  v_mfma_f32_32x32x16_bf16 v[112:127], v[132:135], a[196:199], v[112:127]
  ds_read_b128 v[128:131], v18 offset:16384
  v_fma_f32 v82, -v154, v48, v82
  v_fma_f32 v83, -v155, v48, v83
  s_waitcnt lgkmcnt(4)
  v_mfma_f32_32x32x16_bf16 v[96:111], v[136:139], a[56:59], v[96:111]
  v_mul_f32 v82, v170, v82
  v_mul_f32 v83, v171, v83
  v_mfma_f32_32x32x16_bf16 v[112:127], v[136:139], a[200:203], v[112:127]
  ds_read_b128 v[132:135], v19 offset:16384
  v_cvt_pk_bf16_f32 v193, v82, v83
  v_fma_f32 v84, -v156, v48, v84
  s_waitcnt lgkmcnt(4)
  v_mfma_f32_32x32x16_bf16 v[96:111], v[140:143], a[60:63], v[96:111]
  v_fma_f32 v85, -v157, v48, v85
  v_mul_f32 v84, v172, v84
  v_mfma_f32_32x32x16_bf16 v[112:127], v[140:143], a[204:207], v[112:127]
  ds_read_b128 v[136:139], v16 offset:20480
  v_mul_f32 v85, v173, v85
  v_cvt_pk_bf16_f32 v194, v84, v85
  s_waitcnt lgkmcnt(4)
  v_mfma_f32_32x32x16_bf16 v[96:111], v[144:147], a[64:67], v[96:111]
  v_fma_f32 v86, -v158, v48, v86
  v_fma_f32 v87, -v159, v48, v87
  v_mfma_f32_32x32x16_bf16 v[112:127], v[144:147], a[208:211], v[112:127]
  ds_read_b128 v[140:143], v17 offset:20480
  v_mul_f32 v86, v174, v86
  v_mul_f32 v87, v175, v87
  s_waitcnt lgkmcnt(4)
  v_mfma_f32_32x32x16_bf16 v[96:111], v[148:151], a[68:71], v[96:111]
  v_cvt_pk_bf16_f32 v195, v86, v87
  buffer_store_dwordx4 v[192:195], v5, s[52:55], s62 offen offset:0 sc1
  v_mfma_f32_32x32x16_bf16 v[112:127], v[148:151], a[212:215], v[112:127]
  ds_read_b128 v[144:147], v18 offset:20480
  v_fma_f32 v88, -v160, v48, v88
  v_fma_f32 v89, -v161, v48, v89
  s_waitcnt lgkmcnt(4)
  v_mfma_f32_32x32x16_bf16 v[96:111], v[128:131], a[72:75], v[96:111]
  v_mul_f32 v88, v176, v88
  v_mul_f32 v89, v177, v89
  v_mfma_f32_32x32x16_bf16 v[112:127], v[128:131], a[216:219], v[112:127]
  ds_read_b128 v[148:151], v19 offset:20480
  v_cvt_pk_bf16_f32 v196, v88, v89
  v_fma_f32 v90, -v162, v48, v90
  s_waitcnt lgkmcnt(4)
  v_mfma_f32_32x32x16_bf16 v[96:111], v[132:135], a[76:79], v[96:111]
  v_fma_f32 v91, -v163, v48, v91
  v_mul_f32 v90, v178, v90
  v_mfma_f32_32x32x16_bf16 v[112:127], v[132:135], a[220:223], v[112:127]
  ds_read_b128 v[128:131], v16 offset:24576
  v_mul_f32 v91, v179, v91
  v_cvt_pk_bf16_f32 v197, v90, v91
  s_waitcnt lgkmcnt(4)
  v_mfma_f32_32x32x16_bf16 v[96:111], v[136:139], a[80:83], v[96:111]
  v_fma_f32 v92, -v164, v48, v92
  v_fma_f32 v93, -v165, v48, v93
  v_mfma_f32_32x32x16_bf16 v[112:127], v[136:139], a[224:227], v[112:127]
  ds_read_b128 v[132:135], v17 offset:24576
  v_mul_f32 v92, v180, v92
  v_mul_f32 v93, v181, v93
  s_waitcnt lgkmcnt(4)
  v_mfma_f32_32x32x16_bf16 v[96:111], v[140:143], a[84:87], v[96:111]
  v_cvt_pk_bf16_f32 v198, v92, v93
  v_fma_f32 v94, -v166, v48, v94
  v_mfma_f32_32x32x16_bf16 v[112:127], v[140:143], a[228:231], v[112:127]
  ds_read_b128 v[136:139], v18 offset:24576
  v_fma_f32 v95, -v167, v48, v95
  v_mul_f32 v94, v182, v94
  s_waitcnt lgkmcnt(4)
  v_mfma_f32_32x32x16_bf16 v[96:111], v[144:147], a[88:91], v[96:111]
  v_mul_f32 v95, v183, v95
  v_cvt_pk_bf16_f32 v199, v94, v95
  v_mfma_f32_32x32x16_bf16 v[112:127], v[144:147], a[232:235], v[112:127]
  ds_read_b128 v[140:143], v19 offset:24576
  buffer_store_dwordx4 v[196:199], v5, s[52:55], s62 offen offset:512 sc1
  s_lshl_b32 s61, s64, 18
  s_lshl_b32 s66, s56, 13
  s_add_u32 s66, s66, 33554432
  s_add_u32 s61, s61, s66
  s_add_u32 s62, s61, 8192
  s_waitcnt lgkmcnt(4)
  v_mfma_f32_32x32x16_bf16 v[96:111], v[148:151], a[92:95], v[96:111]
  v_mfma_f32_32x32x16_bf16 v[112:127], v[148:151], a[236:239], v[112:127]
  ds_read_b128 v[144:147], v16 offset:28672
  s_waitcnt lgkmcnt(4)
  v_mfma_f32_32x32x16_bf16 v[96:111], v[128:131], a[96:99], v[96:111]
  s_add_u32 m0, s59, 0
  s_add_u32 s65, s60, 0
  buffer_load_dwordx4 v4, s[8:11], s65 offen lds
  v_mfma_f32_32x32x16_bf16 v[112:127], v[128:131], a[240:243], v[112:127]
  ds_read_b128 v[148:151], v17 offset:28672
  s_waitcnt lgkmcnt(4)
  v_mfma_f32_32x32x16_bf16 v[96:111], v[132:135], a[100:103], v[96:111]
  s_add_u32 m0, s59, 4096
  s_add_u32 s65, s60, 128
  buffer_load_dwordx4 v4, s[8:11], s65 offen lds
  v_mfma_f32_32x32x16_bf16 v[112:127], v[132:135], a[244:247], v[112:127]
  ds_read_b128 v[128:131], v18 offset:28672
  s_waitcnt lgkmcnt(4)
  v_mfma_f32_32x32x16_bf16 v[96:111], v[136:139], a[104:107], v[96:111]
  s_add_u32 m0, s59, 8192
  s_add_u32 s65, s60, 256
  buffer_load_dwordx4 v4, s[8:11], s65 offen lds
  v_mfma_f32_32x32x16_bf16 v[112:127], v[136:139], a[248:251], v[112:127]
  ds_read_b128 v[132:135], v19 offset:28672
  s_waitcnt lgkmcnt(4)
  v_mfma_f32_32x32x16_bf16 v[96:111], v[140:143], a[108:111], v[96:111]
  s_add_u32 m0, s59, 12288
  s_add_u32 s65, s60, 384
  buffer_load_dwordx4 v4, s[8:11], s65 offen lds
  v_mfma_f32_32x32x16_bf16 v[112:127], v[140:143], a[252:255], v[112:127]
  ds_read_b128 v[136:139], v16 offset:32768
  s_waitcnt lgkmcnt(4)
  v_mfma_f32_32x32x16_bf16 v[96:111], v[144:147], a[112:115], v[96:111]
  s_add_u32 m0, s59, 16384
  s_add_u32 s65, s60, 512
  buffer_load_dwordx4 v4, s[8:11], s65 offen lds
  v_mfma_f32_32x32x16_bf16 v[112:127], v[144:147], v[224:227], v[112:127]
  ds_read_b128 v[140:143], v17 offset:32768
  s_waitcnt lgkmcnt(4)
  v_mfma_f32_32x32x16_bf16 v[96:111], v[148:151], a[116:119], v[96:111]
  s_add_u32 m0, s59, 20480
  s_add_u32 s65, s60, 640
  buffer_load_dwordx4 v4, s[8:11], s65 offen lds
  v_mfma_f32_32x32x16_bf16 v[112:127], v[148:151], v[228:231], v[112:127]
  ds_read_b128 v[144:147], v18 offset:32768
  s_waitcnt lgkmcnt(4)
  v_mfma_f32_32x32x16_bf16 v[96:111], v[128:131], a[120:123], v[96:111]
  s_add_u32 m0, s59, 24576
  s_add_u32 s65, s60, 768
  buffer_load_dwordx4 v4, s[8:11], s65 offen lds
  v_mfma_f32_32x32x16_bf16 v[112:127], v[128:131], v[232:235], v[112:127]
  ds_read_b128 v[148:151], v19 offset:32768
  s_waitcnt lgkmcnt(4)
  v_mfma_f32_32x32x16_bf16 v[96:111], v[132:135], a[124:127], v[96:111]
  s_add_u32 m0, s59, 28672
  s_add_u32 s65, s60, 896
  buffer_load_dwordx4 v4, s[8:11], s65 offen lds
  v_mfma_f32_32x32x16_bf16 v[112:127], v[132:135], v[236:239], v[112:127]
  s_waitcnt lgkmcnt(3)
  v_mfma_f32_32x32x16_bf16 v[96:111], v[136:139], a[128:131], v[96:111]
  s_add_u32 m0, s59, 32768
  s_add_u32 s65, s60, 1024
  buffer_load_dwordx4 v4, s[8:11], s65 offen lds
  v_mfma_f32_32x32x16_bf16 v[112:127], v[136:139], v[240:243], v[112:127]
  s_waitcnt lgkmcnt(2)
  v_mfma_f32_32x32x16_bf16 v[96:111], v[140:143], a[132:135], v[96:111]
  s_add_u32 s60, s60, 36864
  v_mfma_f32_32x32x16_bf16 v[112:127], v[140:143], v[244:247], v[112:127]
  s_waitcnt lgkmcnt(1)
  v_mfma_f32_32x32x16_bf16 v[96:111], v[144:147], a[136:139], v[96:111]
  v_mfma_f32_32x32x16_bf16 v[112:127], v[144:147], v[248:251], v[112:127]
  s_waitcnt lgkmcnt(0)
  v_mfma_f32_32x32x16_bf16 v[96:111], v[148:151], a[140:143], v[96:111]
  v_mfma_f32_32x32x16_bf16 v[112:127], v[148:151], v[252:255], v[112:127]
  s_waitcnt vmcnt(9) lgkmcnt(0)
  s_barrier
  s_cmp_lg_u32 s5, 0
  s_cbranch_scc1 QF_52
  s_sub_i32 s65, s64, 0
  s_max_i32 s65, s65, 0
  v_mov_b32 v7, s65
  s_mov_b64 exec, 3
  buffer_store_dword v7, v11, s[52:55], s63 offen sc1
  s_mov_b64 exec, -1
QF_52:
  s_add_u32 s64, s64, 1
  ds_read_b128 v[128:131], v20 offset:0
  ds_read_b128 v[132:135], v21 offset:0
  ds_read_b128 v[136:139], v22 offset:0
  ds_read_b128 v[140:143], v23 offset:0
  ds_read_b128 v[144:147], v20 offset:4096
  s_waitcnt lgkmcnt(4)
  v_mfma_f32_32x32x16_bf16 v[64:79], v[128:131], a[0:3], 0
  ds_read_b128 v[152:155], v6 offset:0
  ds_read_b128 v[168:171], v6 offset:128
  ds_read_b128 v[156:159], v6 offset:32
  v_mfma_f32_32x32x16_bf16 v[80:95], v[128:131], a[144:147], 0
  ds_read_b128 v[148:151], v21 offset:4096
  ds_read_b128 v[172:175], v6 offset:160
  ds_read_b128 v[160:163], v6 offset:64
  s_waitcnt lgkmcnt(9)
  v_mfma_f32_32x32x16_bf16 v[64:79], v[132:135], a[4:7], v[64:79]
  ds_read_b128 v[176:179], v6 offset:192
  ds_read_b128 v[164:167], v6 offset:96
  v_mfma_f32_32x32x16_bf16 v[80:95], v[132:135], a[148:151], v[80:95]
  ds_read_b128 v[128:131], v22 offset:4096
  ds_read_b128 v[180:183], v6 offset:224
  v_add_u32 v6, 256, v6
  s_waitcnt lgkmcnt(12)
  v_mfma_f32_32x32x16_bf16 v[64:79], v[136:139], a[8:11], v[64:79]
  s_waitcnt lgkmcnt(9)
  v_fma_f32 v96, -v152, v32, v96
  v_fma_f32 v97, -v153, v32, v97
  v_mfma_f32_32x32x16_bf16 v[80:95], v[136:139], a[152:155], v[80:95]
  ds_read_b128 v[132:135], v23 offset:4096
  s_waitcnt lgkmcnt(9)
  v_mul_f32 v96, v168, v96
  v_mul_f32 v97, v169, v97
  v_mfma_f32_32x32x16_bf16 v[64:79], v[140:143], a[12:15], v[64:79]
  v_cvt_pk_bf16_f32 v184, v96, v97
  v_fma_f32 v98, -v154, v32, v98
  v_mfma_f32_32x32x16_bf16 v[80:95], v[140:143], a[156:159], v[80:95]
  ds_read_b128 v[136:139], v20 offset:8192
  v_fma_f32 v99, -v155, v32, v99
  v_mul_f32 v98, v170, v98
  v_mfma_f32_32x32x16_bf16 v[64:79], v[144:147], a[16:19], v[64:79]
  v_mul_f32 v99, v171, v99
  v_cvt_pk_bf16_f32 v185, v98, v99
  v_mfma_f32_32x32x16_bf16 v[80:95], v[144:147], a[160:163], v[80:95]
  ds_read_b128 v[140:143], v21 offset:8192
  s_waitcnt lgkmcnt(10)
  v_fma_f32 v100, -v156, v32, v100
  v_fma_f32 v101, -v157, v32, v101
  s_waitcnt lgkmcnt(9)
  v_mfma_f32_32x32x16_bf16 v[64:79], v[148:151], a[20:23], v[64:79]
  s_waitcnt lgkmcnt(8)
  v_mul_f32 v100, v172, v100
  v_mul_f32 v101, v173, v101
  v_mfma_f32_32x32x16_bf16 v[80:95], v[148:151], a[164:167], v[80:95]
  ds_read_b128 v[144:147], v22 offset:8192
  v_cvt_pk_bf16_f32 v186, v100, v101
  v_fma_f32 v102, -v158, v32, v102
  s_waitcnt lgkmcnt(5)
  v_mfma_f32_32x32x16_bf16 v[64:79], v[128:131], a[24:27], v[64:79]
  v_fma_f32 v103, -v159, v32, v103
  v_mul_f32 v102, v174, v102
  v_mfma_f32_32x32x16_bf16 v[80:95], v[128:131], a[168:171], v[80:95]
  ds_read_b128 v[148:151], v23 offset:8192
  v_mul_f32 v103, v175, v103
  v_cvt_pk_bf16_f32 v187, v102, v103
  s_waitcnt lgkmcnt(4)
  v_mfma_f32_32x32x16_bf16 v[64:79], v[132:135], a[28:31], v[64:79]
  buffer_store_dwordx4 v[184:187], v5, s[52:55], s61 offen offset:0 sc1
  v_fma_f32 v104, -v160, v32, v104
  v_mfma_f32_32x32x16_bf16 v[80:95], v[132:135], a[172:175], v[80:95]
  ds_read_b128 v[128:131], v20 offset:12288
  v_fma_f32 v105, -v161, v32, v105
  v_mul_f32 v104, v176, v104
  s_waitcnt lgkmcnt(4)
  v_mfma_f32_32x32x16_bf16 v[64:79], v[136:139], a[32:35], v[64:79]
  v_mul_f32 v105, v177, v105
  v_cvt_pk_bf16_f32 v188, v104, v105
  v_mfma_f32_32x32x16_bf16 v[80:95], v[136:139], a[176:179], v[80:95]
  ds_read_b128 v[132:135], v21 offset:12288
  v_fma_f32 v106, -v162, v32, v106
  v_fma_f32 v107, -v163, v32, v107
  s_waitcnt lgkmcnt(4)
  v_mfma_f32_32x32x16_bf16 v[64:79], v[140:143], a[36:39], v[64:79]
  v_mul_f32 v106, v178, v106
  v_mul_f32 v107, v179, v107
  v_mfma_f32_32x32x16_bf16 v[80:95], v[140:143], a[180:183], v[80:95]
  ds_read_b128 v[136:139], v22 offset:12288
  v_cvt_pk_bf16_f32 v189, v106, v107
  v_fma_f32 v108, -v164, v32, v108
  s_waitcnt lgkmcnt(4)
  v_mfma_f32_32x32x16_bf16 v[64:79], v[144:147], a[40:43], v[64:79]
  v_fma_f32 v109, -v165, v32, v109
  v_mul_f32 v108, v180, v108
  v_mfma_f32_32x32x16_bf16 v[80:95], v[144:147], a[184:187], v[80:95]
  ds_read_b128 v[140:143], v23 offset:12288
  v_mul_f32 v109, v181, v109
  v_cvt_pk_bf16_f32 v190, v108, v109
  s_waitcnt lgkmcnt(4)
  v_mfma_f32_32x32x16_bf16 v[64:79], v[148:151], a[44:47], v[64:79]
  v_fma_f32 v110, -v166, v32, v110
  v_fma_f32 v111, -v167, v32, v111
  v_mfma_f32_32x32x16_bf16 v[80:95], v[148:151], a[188:191], v[80:95]
  ds_read_b128 v[144:147], v20 offset:16384
  v_mul_f32 v110, v182, v110
  v_mul_f32 v111, v183, v111
  v_cvt_pk_bf16_f32 v191, v110, v111
  s_waitcnt lgkmcnt(4)
  v_mfma_f32_32x32x16_bf16 v[64:79], v[128:131], a[48:51], v[64:79]
  buffer_store_dwordx4 v[188:191], v5, s[52:55], s61 offen offset:512 sc1
  v_fma_f32 v112, -v152, v48, v112
  v_mfma_f32_32x32x16_bf16 v[80:95], v[128:131], a[192:195], v[80:95]
  ds_read_b128 v[148:151], v21 offset:16384
  v_fma_f32 v113, -v153, v48, v113
  v_mul_f32 v112, v168, v112
  s_waitcnt lgkmcnt(4)
  v_mfma_f32_32x32x16_bf16 v[64:79], v[132:135], a[52:55], v[64:79]
  v_mul_f32 v113, v169, v113
  v_cvt_pk_bf16_f32 v192, v112, v113
  v_mfma_f32_32x32x16_bf16 v[80:95], v[132:135], a[196:199], v[80:95]
  ds_read_b128 v[128:131], v22 offset:16384
  v_fma_f32 v114, -v154, v48, v114
  v_fma_f32 v115, -v155, v48, v115
  s_waitcnt lgkmcnt(4)
  v_mfma_f32_32x32x16_bf16 v[64:79], v[136:139], a[56:59], v[64:79]
  v_mul_f32 v114, v170, v114
  v_mul_f32 v115, v171, v115
  v_mfma_f32_32x32x16_bf16 v[80:95], v[136:139], a[200:203], v[80:95]
  ds_read_b128 v[132:135], v23 offset:16384
  v_cvt_pk_bf16_f32 v193, v114, v115
  v_fma_f32 v116, -v156, v48, v116
  s_waitcnt lgkmcnt(4)
  v_mfma_f32_32x32x16_bf16 v[64:79], v[140:143], a[60:63], v[64:79]
  v_fma_f32 v117, -v157, v48, v117
  v_mul_f32 v116, v172, v116
  v_mfma_f32_32x32x16_bf16 v[80:95], v[140:143], a[204:207], v[80:95]
  ds_read_b128 v[136:139], v20 offset:20480
  v_mul_f32 v117, v173, v117
  v_cvt_pk_bf16_f32 v194, v116, v117
  s_waitcnt lgkmcnt(4)
  v_mfma_f32_32x32x16_bf16 v[64:79], v[144:147], a[64:67], v[64:79]
  v_fma_f32 v118, -v158, v48, v118
  v_fma_f32 v119, -v159, v48, v119
  v_mfma_f32_32x32x16_bf16 v[80:95], v[144:147], a[208:211], v[80:95]
  ds_read_b128 v[140:143], v21 offset:20480
  v_mul_f32 v118, v174, v118
  v_mul_f32 v119, v175, v119
  s_waitcnt lgkmcnt(4)
  v_mfma_f32_32x32x16_bf16 v[64:79], v[148:151], a[68:71], v[64:79]
  v_cvt_pk_bf16_f32 v195, v118, v119
  buffer_store_dwordx4 v[192:195], v5, s[52:55], s62 offen offset:0 sc1
  v_mfma_f32_32x32x16_bf16 v[80:95], v[148:151], a[212:215], v[80:95]
  ds_read_b128 v[144:147], v22 offset:20480
  v_fma_f32 v120, -v160, v48, v120
  v_fma_f32 v121, -v161, v48, v121
  s_waitcnt lgkmcnt(4)
  v_mfma_f32_32x32x16_bf16 v[64:79], v[128:131], a[72:75], v[64:79]
  v_mul_f32 v120, v176, v120
  v_mul_f32 v121, v177, v121
  v_mfma_f32_32x32x16_bf16 v[80:95], v[128:131], a[216:219], v[80:95]
  ds_read_b128 v[148:151], v23 offset:20480
  v_cvt_pk_bf16_f32 v196, v120, v121
  v_fma_f32 v122, -v162, v48, v122
  s_waitcnt lgkmcnt(4)
  v_mfma_f32_32x32x16_bf16 v[64:79], v[132:135], a[76:79], v[64:79]
  v_fma_f32 v123, -v163, v48, v123
  v_mul_f32 v122, v178, v122
  v_mfma_f32_32x32x16_bf16 v[80:95], v[132:135], a[220:223], v[80:95]
  ds_read_b128 v[128:131], v20 offset:24576
  v_mul_f32 v123, v179, v123
  v_cvt_pk_bf16_f32 v197, v122, v123
  s_waitcnt lgkmcnt(4)
  v_mfma_f32_32x32x16_bf16 v[64:79], v[136:139], a[80:83], v[64:79]
  v_fma_f32 v124, -v164, v48, v124
  v_fma_f32 v125, -v165, v48, v125
  v_mfma_f32_32x32x16_bf16 v[80:95], v[136:139], a[224:227], v[80:95]
  ds_read_b128 v[132:135], v21 offset:24576
  v_mul_f32 v124, v180, v124
  v_mul_f32 v125, v181, v125
  s_waitcnt lgkmcnt(4)
  v_mfma_f32_32x32x16_bf16 v[64:79], v[140:143], a[84:87], v[64:79]
  v_cvt_pk_bf16_f32 v198, v124, v125
  v_fma_f32 v126, -v166, v48, v126
  v_mfma_f32_32x32x16_bf16 v[80:95], v[140:143], a[228:231], v[80:95]
  ds_read_b128 v[136:139], v22 offset:24576
  v_fma_f32 v127, -v167, v48, v127
  v_mul_f32 v126, v182, v126
  s_waitcnt lgkmcnt(4)
  v_mfma_f32_32x32x16_bf16 v[64:79], v[144:147], a[88:91], v[64:79]
  v_mul_f32 v127, v183, v127
  v_cvt_pk_bf16_f32 v199, v126, v127
  v_mfma_f32_32x32x16_bf16 v[80:95], v[144:147], a[232:235], v[80:95]
  ds_read_b128 v[140:143], v23 offset:24576
  buffer_store_dwordx4 v[196:199], v5, s[52:55], s62 offen offset:512 sc1
  s_lshl_b32 s61, s64, 18
  s_lshl_b32 s66, s56, 13
  s_add_u32 s66, s66, 33554432
  s_add_u32 s61, s61, s66
  s_add_u32 s62, s61, 8192
  s_waitcnt lgkmcnt(4)
  v_mfma_f32_32x32x16_bf16 v[64:79], v[148:151], a[92:95], v[64:79]
  v_mfma_f32_32x32x16_bf16 v[80:95], v[148:151], a[236:239], v[80:95]
  ds_read_b128 v[144:147], v20 offset:28672
  s_waitcnt lgkmcnt(4)
  v_mfma_f32_32x32x16_bf16 v[64:79], v[128:131], a[96:99], v[64:79]
  s_add_u32 m0, s59, 36864
  s_add_u32 s65, s60, 0
  buffer_load_dwordx4 v4, s[8:11], s65 offen lds
  v_mfma_f32_32x32x16_bf16 v[80:95], v[128:131], a[240:243], v[80:95]
  ds_read_b128 v[148:151], v21 offset:28672
  s_waitcnt lgkmcnt(4)
  v_mfma_f32_32x32x16_bf16 v[64:79], v[132:135], a[100:103], v[64:79]
  s_add_u32 m0, s59, 40960
  s_add_u32 s65, s60, 128
  buffer_load_dwordx4 v4, s[8:11], s65 offen lds
  v_mfma_f32_32x32x16_bf16 v[80:95], v[132:135], a[244:247], v[80:95]
  ds_read_b128 v[128:131], v22 offset:28672
  s_waitcnt lgkmcnt(4)
  v_mfma_f32_32x32x16_bf16 v[64:79], v[136:139], a[104:107], v[64:79]
  s_add_u32 m0, s59, 45056
  s_add_u32 s65, s60, 256
  buffer_load_dwordx4 v4, s[8:11], s65 offen lds
  v_mfma_f32_32x32x16_bf16 v[80:95], v[136:139], a[248:251], v[80:95]
  ds_read_b128 v[132:135], v23 offset:28672
  s_waitcnt lgkmcnt(4)
  v_mfma_f32_32x32x16_bf16 v[64:79], v[140:143], a[108:111], v[64:79]
  s_add_u32 m0, s59, 49152
  s_add_u32 s65, s60, 384
  buffer_load_dwordx4 v4, s[8:11], s65 offen lds
  v_mfma_f32_32x32x16_bf16 v[80:95], v[140:143], a[252:255], v[80:95]
  ds_read_b128 v[136:139], v20 offset:32768
  s_waitcnt lgkmcnt(4)
  v_mfma_f32_32x32x16_bf16 v[64:79], v[144:147], a[112:115], v[64:79]
  s_add_u32 m0, s59, 53248
  s_add_u32 s65, s60, 512
  buffer_load_dwordx4 v4, s[8:11], s65 offen lds
  v_mfma_f32_32x32x16_bf16 v[80:95], v[144:147], v[224:227], v[80:95]
  ds_read_b128 v[140:143], v21 offset:32768
  s_waitcnt lgkmcnt(4)
  v_mfma_f32_32x32x16_bf16 v[64:79], v[148:151], a[116:119], v[64:79]
  s_add_u32 m0, s59, 57344
  s_add_u32 s65, s60, 640
  buffer_load_dwordx4 v4, s[8:11], s65 offen lds
  v_mfma_f32_32x32x16_bf16 v[80:95], v[148:151], v[228:231], v[80:95]
  ds_read_b128 v[144:147], v22 offset:32768
  s_waitcnt lgkmcnt(4)
  v_mfma_f32_32x32x16_bf16 v[64:79], v[128:131], a[120:123], v[64:79]
  s_add_u32 m0, s59, 61440
  s_add_u32 s65, s60, 768
  buffer_load_dwordx4 v4, s[8:11], s65 offen lds
  v_mfma_f32_32x32x16_bf16 v[80:95], v[128:131], v[232:235], v[80:95]
  ds_read_b128 v[148:151], v23 offset:32768
  s_waitcnt lgkmcnt(4)
  v_mfma_f32_32x32x16_bf16 v[64:79], v[132:135], a[124:127], v[64:79]
  s_add_u32 m0, s59, 65536
  s_add_u32 s65, s60, 896
  buffer_load_dwordx4 v4, s[8:11], s65 offen lds
  v_mfma_f32_32x32x16_bf16 v[80:95], v[132:135], v[236:239], v[80:95]
  s_waitcnt lgkmcnt(3)
  v_mfma_f32_32x32x16_bf16 v[64:79], v[136:139], a[128:131], v[64:79]
  s_add_u32 m0, s59, 69632
  s_add_u32 s65, s60, 1024
  buffer_load_dwordx4 v4, s[8:11], s65 offen lds
  v_mfma_f32_32x32x16_bf16 v[80:95], v[136:139], v[240:243], v[80:95]
  s_waitcnt lgkmcnt(2)
  v_mfma_f32_32x32x16_bf16 v[64:79], v[140:143], a[132:135], v[64:79]
  s_add_u32 s60, s60, 36864
  v_mfma_f32_32x32x16_bf16 v[80:95], v[140:143], v[244:247], v[80:95]
  s_waitcnt lgkmcnt(1)
  v_mfma_f32_32x32x16_bf16 v[64:79], v[144:147], a[136:139], v[64:79]
  v_mfma_f32_32x32x16_bf16 v[80:95], v[144:147], v[248:251], v[80:95]
  s_waitcnt lgkmcnt(0)
  v_mfma_f32_32x32x16_bf16 v[64:79], v[148:151], a[140:143], v[64:79]
  v_mfma_f32_32x32x16_bf16 v[80:95], v[148:151], v[252:255], v[80:95]
  s_waitcnt vmcnt(9) lgkmcnt(0)
  s_barrier
  s_cmp_lg_u32 s5, 0
  s_cbranch_scc1 QF_53
  s_sub_i32 s65, s64, 0
  s_max_i32 s65, s65, 0
  v_mov_b32 v7, s65
  s_mov_b64 exec, 3
  buffer_store_dword v7, v11, s[52:55], s63 offen sc1
  s_mov_b64 exec, -1
QF_53:
  s_add_u32 s64, s64, 1
  ds_read_b128 v[128:131], v24 offset:0
  ds_read_b128 v[132:135], v25 offset:0
  ds_read_b128 v[136:139], v26 offset:0
  ds_read_b128 v[140:143], v27 offset:0
  ds_read_b128 v[144:147], v24 offset:4096
  s_waitcnt lgkmcnt(4)
  v_mfma_f32_32x32x16_bf16 v[96:111], v[128:131], a[0:3], 0
  ds_read_b128 v[152:155], v6 offset:0
  ds_read_b128 v[168:171], v6 offset:128
  ds_read_b128 v[156:159], v6 offset:32
  v_mfma_f32_32x32x16_bf16 v[112:127], v[128:131], a[144:147], 0
  ds_read_b128 v[148:151], v25 offset:4096
  ds_read_b128 v[172:175], v6 offset:160
  ds_read_b128 v[160:163], v6 offset:64
  s_waitcnt lgkmcnt(9)
  v_mfma_f32_32x32x16_bf16 v[96:111], v[132:135], a[4:7], v[96:111]
  ds_read_b128 v[176:179], v6 offset:192
  ds_read_b128 v[164:167], v6 offset:96
  v_mfma_f32_32x32x16_bf16 v[112:127], v[132:135], a[148:151], v[112:127]
  ds_read_b128 v[128:131], v26 offset:4096
  ds_read_b128 v[180:183], v6 offset:224
  v_add_u32 v6, 256, v6
  s_waitcnt lgkmcnt(12)
  v_mfma_f32_32x32x16_bf16 v[96:111], v[136:139], a[8:11], v[96:111]
  s_waitcnt lgkmcnt(9)
  v_fma_f32 v64, -v152, v32, v64
  v_fma_f32 v65, -v153, v32, v65
  v_mfma_f32_32x32x16_bf16 v[112:127], v[136:139], a[152:155], v[112:127]
  ds_read_b128 v[132:135], v27 offset:4096
  s_waitcnt lgkmcnt(9)
  v_mul_f32 v64, v168, v64
  v_mul_f32 v65, v169, v65
  v_mfma_f32_32x32x16_bf16 v[96:111], v[140:143], a[12:15], v[96:111]
  v_cvt_pk_bf16_f32 v184, v64, v65
  v_fma_f32 v66, -v154, v32, v66
  v_mfma_f32_32x32x16_bf16 v[112:127], v[140:143], a[156:159], v[112:127]
  ds_read_b128 v[136:139], v24 offset:8192
  v_fma_f32 v67, -v155, v32, v67
  v_mul_f32 v66, v170, v66
  v_mfma_f32_32x32x16_bf16 v[96:111], v[144:147], a[16:19], v[96:111]
  v_mul_f32 v67, v171, v67
  v_cvt_pk_bf16_f32 v185, v66, v67
  v_mfma_f32_32x32x16_bf16 v[112:127], v[144:147], a[160:163], v[112:127]
  ds_read_b128 v[140:143], v25 offset:8192
  s_waitcnt lgkmcnt(10)
  v_fma_f32 v68, -v156, v32, v68
  v_fma_f32 v69, -v157, v32, v69
  s_waitcnt lgkmcnt(9)
  v_mfma_f32_32x32x16_bf16 v[96:111], v[148:151], a[20:23], v[96:111]
  s_waitcnt lgkmcnt(8)
  v_mul_f32 v68, v172, v68
  v_mul_f32 v69, v173, v69
  v_mfma_f32_32x32x16_bf16 v[112:127], v[148:151], a[164:167], v[112:127]
  ds_read_b128 v[144:147], v26 offset:8192
  v_cvt_pk_bf16_f32 v186, v68, v69
  v_fma_f32 v70, -v158, v32, v70
  s_waitcnt lgkmcnt(5)
  v_mfma_f32_32x32x16_bf16 v[96:111], v[128:131], a[24:27], v[96:111]
  v_fma_f32 v71, -v159, v32, v71
  v_mul_f32 v70, v174, v70
  v_mfma_f32_32x32x16_bf16 v[112:127], v[128:131], a[168:171], v[112:127]
  ds_read_b128 v[148:151], v27 offset:8192
  v_mul_f32 v71, v175, v71
  v_cvt_pk_bf16_f32 v187, v70, v71
  s_waitcnt lgkmcnt(4)
  v_mfma_f32_32x32x16_bf16 v[96:111], v[132:135], a[28:31], v[96:111]
  buffer_store_dwordx4 v[184:187], v5, s[52:55], s61 offen offset:0 sc1
  v_fma_f32 v72, -v160, v32, v72
  v_mfma_f32_32x32x16_bf16 v[112:127], v[132:135], a[172:175], v[112:127]
  ds_read_b128 v[128:131], v24 offset:12288
  v_fma_f32 v73, -v161, v32, v73
  v_mul_f32 v72, v176, v72
  s_waitcnt lgkmcnt(4)
  v_mfma_f32_32x32x16_bf16 v[96:111], v[136:139], a[32:35], v[96:111]
  v_mul_f32 v73, v177, v73
  v_cvt_pk_bf16_f32 v188, v72, v73
  v_mfma_f32_32x32x16_bf16 v[112:127], v[136:139], a[176:179], v[112:127]
  ds_read_b128 v[132:135], v25 offset:12288
  v_fma_f32 v74, -v162, v32, v74
  v_fma_f32 v75, -v163, v32, v75
  s_waitcnt lgkmcnt(4)
  v_mfma_f32_32x32x16_bf16 v[96:111], v[140:143], a[36:39], v[96:111]
  v_mul_f32 v74, v178, v74
  v_mul_f32 v75, v179, v75
  v_mfma_f32_32x32x16_bf16 v[112:127], v[140:143], a[180:183], v[112:127]
  ds_read_b128 v[136:139], v26 offset:12288
  v_cvt_pk_bf16_f32 v189, v74, v75
  v_fma_f32 v76, -v164, v32, v76
  s_waitcnt lgkmcnt(4)
  v_mfma_f32_32x32x16_bf16 v[96:111], v[144:147], a[40:43], v[96:111]
  v_fma_f32 v77, -v165, v32, v77
  v_mul_f32 v76, v180, v76
  v_mfma_f32_32x32x16_bf16 v[112:127], v[144:147], a[184:187], v[112:127]
  ds_read_b128 v[140:143], v27 offset:12288
  v_mul_f32 v77, v181, v77
  v_cvt_pk_bf16_f32 v190, v76, v77
  s_waitcnt lgkmcnt(4)
  v_mfma_f32_32x32x16_bf16 v[96:111], v[148:151], a[44:47], v[96:111]
  v_fma_f32 v78, -v166, v32, v78
  v_fma_f32 v79, -v167, v32, v79
  v_mfma_f32_32x32x16_bf16 v[112:127], v[148:151], a[188:191], v[112:127]
  ds_read_b128 v[144:147], v24 offset:16384
  v_mul_f32 v78, v182, v78
  v_mul_f32 v79, v183, v79
  v_cvt_pk_bf16_f32 v191, v78, v79
  s_waitcnt lgkmcnt(4)
  v_mfma_f32_32x32x16_bf16 v[96:111], v[128:131], a[48:51], v[96:111]
  buffer_store_dwordx4 v[188:191], v5, s[52:55], s61 offen offset:512 sc1
  v_fma_f32 v80, -v152, v48, v80
  v_mfma_f32_32x32x16_bf16 v[112:127], v[128:131], a[192:195], v[112:127]
  ds_read_b128 v[148:151], v25 offset:16384
  v_fma_f32 v81, -v153, v48, v81
  v_mul_f32 v80, v168, v80
  s_waitcnt lgkmcnt(4)
  v_mfma_f32_32x32x16_bf16 v[96:111], v[132:135], a[52:55], v[96:111]
  v_mul_f32 v81, v169, v81
  v_cvt_pk_bf16_f32 v192, v80, v81
  v_mfma_f32_32x32x16_bf16 v[112:127], v[132:135], a[196:199], v[112:127]
  ds_read_b128 v[128:131], v26 offset:16384
  v_fma_f32 v82, -v154, v48, v82
  v_fma_f32 v83, -v155, v48, v83
  s_waitcnt lgkmcnt(4)
  v_mfma_f32_32x32x16_bf16 v[96:111], v[136:139], a[56:59], v[96:111]
  v_mul_f32 v82, v170, v82
  v_mul_f32 v83, v171, v83
  v_mfma_f32_32x32x16_bf16 v[112:127], v[136:139], a[200:203], v[112:127]
  ds_read_b128 v[132:135], v27 offset:16384
  v_cvt_pk_bf16_f32 v193, v82, v83
  v_fma_f32 v84, -v156, v48, v84
  s_waitcnt lgkmcnt(4)
  v_mfma_f32_32x32x16_bf16 v[96:111], v[140:143], a[60:63], v[96:111]
  v_fma_f32 v85, -v157, v48, v85
  v_mul_f32 v84, v172, v84
  v_mfma_f32_32x32x16_bf16 v[112:127], v[140:143], a[204:207], v[112:127]
  ds_read_b128 v[136:139], v24 offset:20480
  v_mul_f32 v85, v173, v85
  v_cvt_pk_bf16_f32 v194, v84, v85
  s_waitcnt lgkmcnt(4)
  v_mfma_f32_32x32x16_bf16 v[96:111], v[144:147], a[64:67], v[96:111]
  v_fma_f32 v86, -v158, v48, v86
  v_fma_f32 v87, -v159, v48, v87
  v_mfma_f32_32x32x16_bf16 v[112:127], v[144:147], a[208:211], v[112:127]
  ds_read_b128 v[140:143], v25 offset:20480
  v_mul_f32 v86, v174, v86
  v_mul_f32 v87, v175, v87
  s_waitcnt lgkmcnt(4)
  v_mfma_f32_32x32x16_bf16 v[96:111], v[148:151], a[68:71], v[96:111]
  v_cvt_pk_bf16_f32 v195, v86, v87
  buffer_store_dwordx4 v[192:195], v5, s[52:55], s62 offen offset:0 sc1
  v_mfma_f32_32x32x16_bf16 v[112:127], v[148:151], a[212:215], v[112:127]
  ds_read_b128 v[144:147], v26 offset:20480
  v_fma_f32 v88, -v160, v48, v88
  v_fma_f32 v89, -v161, v48, v89
  s_waitcnt lgkmcnt(4)
  v_mfma_f32_32x32x16_bf16 v[96:111], v[128:131], a[72:75], v[96:111]
  v_mul_f32 v88, v176, v88
  v_mul_f32 v89, v177, v89
  v_mfma_f32_32x32x16_bf16 v[112:127], v[128:131], a[216:219], v[112:127]
  ds_read_b128 v[148:151], v27 offset:20480
  v_cvt_pk_bf16_f32 v196, v88, v89
  v_fma_f32 v90, -v162, v48, v90
  s_waitcnt lgkmcnt(4)
  v_mfma_f32_32x32x16_bf16 v[96:111], v[132:135], a[76:79], v[96:111]
  v_fma_f32 v91, -v163, v48, v91
  v_mul_f32 v90, v178, v90
  v_mfma_f32_32x32x16_bf16 v[112:127], v[132:135], a[220:223], v[112:127]
  ds_read_b128 v[128:131], v24 offset:24576
  v_mul_f32 v91, v179, v91
  v_cvt_pk_bf16_f32 v197, v90, v91
  s_waitcnt lgkmcnt(4)
  v_mfma_f32_32x32x16_bf16 v[96:111], v[136:139], a[80:83], v[96:111]
  v_fma_f32 v92, -v164, v48, v92
  v_fma_f32 v93, -v165, v48, v93
  v_mfma_f32_32x32x16_bf16 v[112:127], v[136:139], a[224:227], v[112:127]
  ds_read_b128 v[132:135], v25 offset:24576
  v_mul_f32 v92, v180, v92
  v_mul_f32 v93, v181, v93
  s_waitcnt lgkmcnt(4)
  v_mfma_f32_32x32x16_bf16 v[96:111], v[140:143], a[84:87], v[96:111]
  v_cvt_pk_bf16_f32 v198, v92, v93
  v_fma_f32 v94, -v166, v48, v94
  v_mfma_f32_32x32x16_bf16 v[112:127], v[140:143], a[228:231], v[112:127]
  ds_read_b128 v[136:139], v26 offset:24576
  v_fma_f32 v95, -v167, v48, v95
  v_mul_f32 v94, v182, v94
  s_waitcnt lgkmcnt(4)
  v_mfma_f32_32x32x16_bf16 v[96:111], v[144:147], a[88:91], v[96:111]
  v_mul_f32 v95, v183, v95
  v_cvt_pk_bf16_f32 v199, v94, v95
  v_mfma_f32_32x32x16_bf16 v[112:127], v[144:147], a[232:235], v[112:127]
  ds_read_b128 v[140:143], v27 offset:24576
  buffer_store_dwordx4 v[196:199], v5, s[52:55], s62 offen offset:512 sc1
  s_lshl_b32 s61, s64, 18
  s_lshl_b32 s66, s56, 13
  s_add_u32 s66, s66, 33554432
  s_add_u32 s61, s61, s66
  s_add_u32 s62, s61, 8192
  s_waitcnt lgkmcnt(4)
  v_mfma_f32_32x32x16_bf16 v[96:111], v[148:151], a[92:95], v[96:111]
  v_mfma_f32_32x32x16_bf16 v[112:127], v[148:151], a[236:239], v[112:127]
  ds_read_b128 v[144:147], v24 offset:28672
  s_waitcnt lgkmcnt(4)
  v_mfma_f32_32x32x16_bf16 v[96:111], v[128:131], a[96:99], v[96:111]
  s_add_u32 m0, s59, 73728
  s_add_u32 s65, s60, 0
  buffer_load_dwordx4 v4, s[8:11], s65 offen lds
  v_mfma_f32_32x32x16_bf16 v[112:127], v[128:131], a[240:243], v[112:127]
  ds_read_b128 v[148:151], v25 offset:28672
  s_waitcnt lgkmcnt(4)
  v_mfma_f32_32x32x16_bf16 v[96:111], v[132:135], a[100:103], v[96:111]
  s_add_u32 m0, s59, 77824
  s_add_u32 s65, s60, 128
  buffer_load_dwordx4 v4, s[8:11], s65 offen lds
  v_mfma_f32_32x32x16_bf16 v[112:127], v[132:135], a[244:247], v[112:127]
  ds_read_b128 v[128:131], v26 offset:28672
  s_waitcnt lgkmcnt(4)
  v_mfma_f32_32x32x16_bf16 v[96:111], v[136:139], a[104:107], v[96:111]
  s_add_u32 m0, s59, 81920
  s_add_u32 s65, s60, 256
  buffer_load_dwordx4 v4, s[8:11], s65 offen lds
  v_mfma_f32_32x32x16_bf16 v[112:127], v[136:139], a[248:251], v[112:127]
  ds_read_b128 v[132:135], v27 offset:28672
  s_waitcnt lgkmcnt(4)
  v_mfma_f32_32x32x16_bf16 v[96:111], v[140:143], a[108:111], v[96:111]
  s_add_u32 m0, s59, 86016
  s_add_u32 s65, s60, 384
  buffer_load_dwordx4 v4, s[8:11], s65 offen lds
  v_mfma_f32_32x32x16_bf16 v[112:127], v[140:143], a[252:255], v[112:127]
  ds_read_b128 v[136:139], v24 offset:32768
  s_waitcnt lgkmcnt(4)
  v_mfma_f32_32x32x16_bf16 v[96:111], v[144:147], a[112:115], v[96:111]
  s_add_u32 m0, s59, 90112
  s_add_u32 s65, s60, 512
  buffer_load_dwordx4 v4, s[8:11], s65 offen lds
  v_mfma_f32_32x32x16_bf16 v[112:127], v[144:147], v[224:227], v[112:127]
  ds_read_b128 v[140:143], v25 offset:32768
  s_waitcnt lgkmcnt(4)
  v_mfma_f32_32x32x16_bf16 v[96:111], v[148:151], a[116:119], v[96:111]
  s_add_u32 m0, s59, 94208
  s_add_u32 s65, s60, 640
  buffer_load_dwordx4 v4, s[8:11], s65 offen lds
  v_mfma_f32_32x32x16_bf16 v[112:127], v[148:151], v[228:231], v[112:127]
  ds_read_b128 v[144:147], v26 offset:32768
  s_waitcnt lgkmcnt(4)
  v_mfma_f32_32x32x16_bf16 v[96:111], v[128:131], a[120:123], v[96:111]
  s_add_u32 m0, s59, 98304
  s_add_u32 s65, s60, 768
  buffer_load_dwordx4 v4, s[8:11], s65 offen lds
  v_mfma_f32_32x32x16_bf16 v[112:127], v[128:131], v[232:235], v[112:127]
  ds_read_b128 v[148:151], v27 offset:32768
  s_waitcnt lgkmcnt(4)
  v_mfma_f32_32x32x16_bf16 v[96:111], v[132:135], a[124:127], v[96:111]
  s_add_u32 m0, s59, 102400
  s_add_u32 s65, s60, 896
  buffer_load_dwordx4 v4, s[8:11], s65 offen lds
  v_mfma_f32_32x32x16_bf16 v[112:127], v[132:135], v[236:239], v[112:127]
  s_waitcnt lgkmcnt(3)
  v_mfma_f32_32x32x16_bf16 v[96:111], v[136:139], a[128:131], v[96:111]
  s_add_u32 m0, s59, 106496
  s_add_u32 s65, s60, 1024
  buffer_load_dwordx4 v4, s[8:11], s65 offen lds
  v_mfma_f32_32x32x16_bf16 v[112:127], v[136:139], v[240:243], v[112:127]
  s_waitcnt lgkmcnt(2)
  v_mfma_f32_32x32x16_bf16 v[96:111], v[140:143], a[132:135], v[96:111]
  s_add_u32 s60, s60, 36864
  v_mfma_f32_32x32x16_bf16 v[112:127], v[140:143], v[244:247], v[112:127]
  s_waitcnt lgkmcnt(1)
  v_mfma_f32_32x32x16_bf16 v[96:111], v[144:147], a[136:139], v[96:111]
  v_mfma_f32_32x32x16_bf16 v[112:127], v[144:147], v[248:251], v[112:127]
  s_waitcnt lgkmcnt(0)
  v_mfma_f32_32x32x16_bf16 v[96:111], v[148:151], a[140:143], v[96:111]
  v_mfma_f32_32x32x16_bf16 v[112:127], v[148:151], v[252:255], v[112:127]
  s_sub_u32 s57, s57, 1
  s_cmp_lg_u32 s57, 0
  s_cbranch_scc1 QKV_LOOP_48
  ds_read_b128 v[152:155], v6 offset:0
  ds_read_b128 v[168:171], v6 offset:128
  ds_read_b128 v[156:159], v6 offset:32
  ds_read_b128 v[172:175], v6 offset:160
  ds_read_b128 v[160:163], v6 offset:64
  ds_read_b128 v[176:179], v6 offset:192
  ds_read_b128 v[164:167], v6 offset:96
  ds_read_b128 v[180:183], v6 offset:224
  v_add_u32 v6, 256, v6
  s_waitcnt lgkmcnt(7)
  v_fma_f32 v96, -v152, v32, v96
  v_fma_f32 v97, -v153, v32, v97
  s_waitcnt lgkmcnt(6)
  v_mul_f32 v96, v168, v96
  v_mul_f32 v97, v169, v97
  v_cvt_pk_bf16_f32 v184, v96, v97
  v_fma_f32 v98, -v154, v32, v98
  v_fma_f32 v99, -v155, v32, v99
  v_mul_f32 v98, v170, v98
  v_mul_f32 v99, v171, v99
  v_cvt_pk_bf16_f32 v185, v98, v99
  s_waitcnt lgkmcnt(5)
  v_fma_f32 v100, -v156, v32, v100
  v_fma_f32 v101, -v157, v32, v101
  s_waitcnt lgkmcnt(4)
  v_mul_f32 v100, v172, v100
  v_mul_f32 v101, v173, v101
  v_cvt_pk_bf16_f32 v186, v100, v101
  v_fma_f32 v102, -v158, v32, v102
  v_fma_f32 v103, -v159, v32, v103
  v_mul_f32 v102, v174, v102
  v_mul_f32 v103, v175, v103
  v_cvt_pk_bf16_f32 v187, v102, v103
  buffer_store_dwordx4 v[184:187], v5, s[52:55], s61 offen offset:0 sc1
  s_waitcnt lgkmcnt(3)
  v_fma_f32 v104, -v160, v32, v104
  v_fma_f32 v105, -v161, v32, v105
  s_waitcnt lgkmcnt(2)
  v_mul_f32 v104, v176, v104
  v_mul_f32 v105, v177, v105
  v_cvt_pk_bf16_f32 v188, v104, v105
  v_fma_f32 v106, -v162, v32, v106
  v_fma_f32 v107, -v163, v32, v107
  v_mul_f32 v106, v178, v106
  v_mul_f32 v107, v179, v107
  v_cvt_pk_bf16_f32 v189, v106, v107
  s_waitcnt lgkmcnt(1)
  v_fma_f32 v108, -v164, v32, v108
  v_fma_f32 v109, -v165, v32, v109
  s_waitcnt lgkmcnt(0)
  v_mul_f32 v108, v180, v108
  v_mul_f32 v109, v181, v109
  v_cvt_pk_bf16_f32 v190, v108, v109
  v_fma_f32 v110, -v166, v32, v110
  v_fma_f32 v111, -v167, v32, v111
  v_mul_f32 v110, v182, v110
  v_mul_f32 v111, v183, v111
  v_cvt_pk_bf16_f32 v191, v110, v111
  buffer_store_dwordx4 v[188:191], v5, s[52:55], s61 offen offset:512 sc1
  v_fma_f32 v112, -v152, v48, v112
  v_fma_f32 v113, -v153, v48, v113
  v_mul_f32 v112, v168, v112
  v_mul_f32 v113, v169, v113
  v_cvt_pk_bf16_f32 v192, v112, v113
  v_fma_f32 v114, -v154, v48, v114
  v_fma_f32 v115, -v155, v48, v115
  v_mul_f32 v114, v170, v114
  v_mul_f32 v115, v171, v115
  v_cvt_pk_bf16_f32 v193, v114, v115
  v_fma_f32 v116, -v156, v48, v116
  v_fma_f32 v117, -v157, v48, v117
  v_mul_f32 v116, v172, v116
  v_mul_f32 v117, v173, v117
  v_cvt_pk_bf16_f32 v194, v116, v117
  v_fma_f32 v118, -v158, v48, v118
  v_fma_f32 v119, -v159, v48, v119
  v_mul_f32 v118, v174, v118
  v_mul_f32 v119, v175, v119
  v_cvt_pk_bf16_f32 v195, v118, v119
  buffer_store_dwordx4 v[192:195], v5, s[52:55], s62 offen offset:0 sc1
  v_fma_f32 v120, -v160, v48, v120
  v_fma_f32 v121, -v161, v48, v121
  v_mul_f32 v120, v176, v120
  v_mul_f32 v121, v177, v121
  v_cvt_pk_bf16_f32 v196, v120, v121
  v_fma_f32 v122, -v162, v48, v122
  v_fma_f32 v123, -v163, v48, v123
  v_mul_f32 v122, v178, v122
  v_mul_f32 v123, v179, v123
  v_cvt_pk_bf16_f32 v197, v122, v123
  v_fma_f32 v124, -v164, v48, v124
  v_fma_f32 v125, -v165, v48, v125
  v_mul_f32 v124, v180, v124
  v_mul_f32 v125, v181, v125
  v_cvt_pk_bf16_f32 v198, v124, v125
  v_fma_f32 v126, -v166, v48, v126
  v_fma_f32 v127, -v167, v48, v127
  v_mul_f32 v126, v182, v126
  v_mul_f32 v127, v183, v127
  v_cvt_pk_bf16_f32 v199, v126, v127
  buffer_store_dwordx4 v[196:199], v5, s[52:55], s62 offen offset:512 sc1
  s_waitcnt vmcnt(0) lgkmcnt(0)
  s_barrier
  s_cmp_lg_u32 s5, 0
  s_cbranch_scc1 QF_54
  s_sub_i32 s65, s64, -1
  s_max_i32 s65, s65, 0
  v_mov_b32 v7, s65
  s_mov_b64 exec, 3
  buffer_store_dword v7, v11, s[52:55], s63 offen sc1
  s_mov_b64 exec, -1
QF_54:
  s_add_u32 s64, s64, 1
QKV_END_36:
  s_endpgm
R_C:
  s_mov_b32 s56, s7
  s_mul_i32 s78, s5, 40960
  s_sub_u32 s64, 0, s78
  s_xor_b32 s73, s5, 1
  s_mul_i32 s73, s73, 40960
  s_sub_u32 s60, s73, s78
  s_xor_b32 s73, s5, 2
  s_mul_i32 s73, s73, 40960
  s_sub_u32 s61, s73, s78
  s_xor_b32 s73, s5, 3
  s_mul_i32 s73, s73, 40960
  s_sub_u32 s62, s73, s78
  s_lshl_b32 s65, s56, 13
  s_lshl_b32 s73, s5, 11
  s_add_u32 s65, s65, s73
  s_add_u32 s65, s65, 16777216
  s_add_u32 s65, s65, s64
  s_add_u32 s7, s65, 16777216
  s_add_u32 s100, s65, 75497472
  s_mul_i32 s66, s5, 98304
  s_lshl_b32 s73, s56, 10
  s_add_u32 s66, s66, s73
  s_add_u32 s66, s66, 110100480
  s_add_u32 s92, s66, 65536
  s_mov_b32 s80, 0xff00ff00
  s_mov_b32 s81, 0xff00ff00
  s_mov_b32 s82, 0x3f803f80
  s_mov_b32 s83, 0x3f803f80
  s_mov_b32 s84, 0x3f003f00
  s_mov_b32 s85, 0x3f003f00
  s_lshl_b32 s73, s5, 5
  s_add_u32 s73, s73, s56
  s_cmp_lt_u32 s73, 72
  s_cselect_b32 s75, 1, 0
  s_cselect_b32 s73, s73, 0
  s_lshr_b32 s74, s56, 3
  s_lshl_b32 s74, s74, 4
  s_and_b32 s77, s56, 7
  s_add_u32 s74, s74, s77
  s_lshl_b32 s77, s5, 3
  s_add_u32 s74, s74, s77
  s_cmp_lt_u32 s5, 2
  s_cselect_b32 s73, s74, s73
  s_lshr_b32 s74, s73, 4
  s_and_b32 s77, s73, 15
  s_bfe_u32 s67, s73, 131073
  s_and_b32 s68, s73, 1
  s_add_u32 s68, s68, 16
  s_cmp_lt_u32 s73, 64
  s_cselect_b32 s74, s74, s67
  s_cselect_b32 s77, s77, s68
  s_mul_i32 s67, s74, 3
  s_lshr_b32 s74, s77, 3
  s_add_u32 s67, s67, s74
  s_lshl_b32 s67, s67, 15
  s_and_b32 s74, s77, 7
  s_lshl_b32 s74, s74, 7
  s_add_u32 s67, s67, s74
  s_add_u32 s67, s67, 110100480
  s_lshl_b32 s74, s73, 7
  s_and_b32 s74, s74, 256
  s_cmp_lt_u32 s73, 64
  s_cselect_b32 s74, 0, s74
  s_add_u32 s67, s67, s74
  s_xor_b32 s68, s67, 512
  s_add_u32 s68, s68, 8192
  s_lshr_b32 s74, s73, 3
  s_lshl_b32 s74, s74, 2
  s_lshr_b32 s69, 0x97863120, s74
  s_and_b32 s69, s69, 15
  s_cmp_lt_u32 s73, 64
  s_cselect_b32 s69, s69, 4
  s_lshl_b32 s69, s69, 10
  s_and_b32 s74, s73, 6
  s_lshl_b32 s74, s74, 7
  s_add_u32 s69, s69, s74
  s_cmp_lt_u32 s73, 64
  s_cselect_b32 s74, 0, s74
  s_cselect_b32 s91, 5, 6
  s_add_u32 s69, s69, s74
  s_and_b32 s74, s73, 1
  s_lshl_b32 s74, s74, 6
  s_add_u32 s69, s69, s74
  s_add_u32 s69, s69, 109051904
  s_lshl_b32 s70, s56, 7
  s_add_u32 s70, s70, 112197632
  s_cmp_eq_u32 s5, 3
  s_cselect_b32 s93, s70, 268435456
  s_mov_b32 s72, 1048576
  s_mov_b32 s76, 0x3e0293ee
  s_mov_b32 s57, 0
  s_mov_b32 s71, 0
  v_mov_b32 v22, v0
  v_bfe_u32 v23, v22, 4, 1
  v_lshlrev_b32 v24, 2, v23
  v_and_b32 v25, 7, v22
  v_xor_b32 v25, v25, v24
  v_lshrrev_b32 v4, 5, v22
  v_add_u32 v4, v4, v24
  v_bfe_u32 v24, v22, 3, 1
  v_lshl_add_u32 v4, v4, 1, v24
  v_lshlrev_b32 v4, 13, v4
  v_lshl_add_u32 v4, v25, 4, v4
  s_lshl_b32 s58, s56, 8
  s_lshr_b32 s73, s5, 1
  s_lshl_b32 s59, s73, 21
  s_lshl_b32 s73, s73, 7
  s_add_u32 s58, s58, s73
  s_and_b32 s73, s5, 1
  s_lshl_b32 s73, s73, 18
  s_add_u32 s58, s58, s73
  v_lshrrev_b32 v23, 3, v22
  v_mul_u32_u24 v5, 1152, v23
  v_and_b32 v24, 7, v22
  v_lshl_add_u32 v5, v24, 4, v5
  s_mul_i32 s63, s56, 147456
  v_lshrrev_b32 v23, 4, v22
  v_lshlrev_b32 v23, 1, v23
  v_bfe_u32 v24, v22, 2, 1
  v_add_u32 v23, v23, v24
  v_bfe_u32 v24, v22, 3, 1
  v_lshl_add_u32 v25, v24, 5, v23
  v_bfe_u32 v24, v22, 1, 1
  v_lshl_add_u32 v25, v24, 6, v25
  s_lshl_b32 s73, s5, 5
  v_xor_b32 v25, s73, v25
  v_mul_u32_u24 v6, 1152, v25
  v_and_b32 v24, 1, v22
  v_lshl_add_u32 v6, v24, 4, v6
  s_lshr_b32 s89, s16, 8
  s_add_u32 s90, s56, s89
  s_and_b32 s90, s90, 31
  s_xor_b32 s73, s90, 1
  s_and_b32 s73, s73, 3
  s_xor_b32 s86, s73, s90
  s_sub_u32 s86, s86, s89
  s_and_b32 s86, s86, 31
  s_lshl_b32 s86, s86, 8
  s_lshl_b32 s88, s73, 1
  s_lshr_b32 s74, s5, 1
  s_add_u32 s88, s88, s74
  s_lshl_b32 s90, s90, 1
  s_add_u32 s90, s90, s74
  s_and_b32 s73, s5, 1
  s_lshl_b32 s87, s73, 21
  s_lshl_b32 s73, s73, 7
  s_add_u32 s86, s86, s73
  s_sub_u32 s89, 31, s89
  s_and_b32 s89, s89, 31
  s_lshl_b32 s89, s89, 8
  s_add_u32 s89, s89, s73
  v_lshlrev_b32 v30, 13, v22
  s_xor_b32 s73, s59, 2097152
  s_add_u32 s73, s73, s58
  s_add_u32 m0, s78, 16384
  s_add_u32 s74, s73, 0
  buffer_load_dwordx4 v4, s[16:19], s74 offen lds
  s_add_u32 m0, s78, 17408
  s_add_u32 s74, s73, 32768
  buffer_load_dwordx4 v4, s[16:19], s74 offen lds
  s_add_u32 m0, s78, 18432
  s_add_u32 s74, s73, 131072
  buffer_load_dwordx4 v4, s[16:19], s74 offen lds
  s_add_u32 m0, s78, 19456
  s_add_u32 s74, s73, 163840
  buffer_load_dwordx4 v4, s[16:19], s74 offen lds
  s_xor_b32 s73, s59, 2621440
  s_add_u32 s73, s73, s58
  s_add_u32 m0, s78, 20480
  s_add_u32 s74, s73, 0
  buffer_load_dwordx4 v4, s[16:19], s74 offen lds
  s_add_u32 m0, s78, 21504
  s_add_u32 s74, s73, 32768
  buffer_load_dwordx4 v4, s[16:19], s74 offen lds
  s_add_u32 m0, s78, 22528
  s_add_u32 s74, s73, 131072
  buffer_load_dwordx4 v4, s[16:19], s74 offen lds
  s_add_u32 m0, s78, 23552
  s_add_u32 s74, s73, 163840
  buffer_load_dwordx4 v4, s[16:19], s74 offen lds
  s_xor_b32 s73, s87, 1572864
  s_add_u32 s73, s73, s86
  s_cmp_eq_u32 s88, 2
  s_cselect_b32 s73, s73, 268435456
  buffer_load_dword v31, v30, s[20:23], s73 offen
  s_xor_b32 s73, s87, 2097152
  s_add_u32 s73, s73, s89
  s_cmp_eq_u32 s90, 6
  s_cselect_b32 s73, s73, 268435456
  buffer_load_dword v31, v30, s[20:23], s73 offen
  s_xor_b32 s73, s59, 3145728
  s_add_u32 s73, s73, s58
  s_add_u32 m0, s78, 24576
  s_add_u32 s74, s73, 0
  buffer_load_dwordx4 v4, s[16:19], s74 offen lds
  s_add_u32 m0, s78, 25600
  s_add_u32 s74, s73, 32768
  buffer_load_dwordx4 v4, s[16:19], s74 offen lds
  s_add_u32 m0, s78, 26624
  s_add_u32 s74, s73, 131072
  buffer_load_dwordx4 v4, s[16:19], s74 offen lds
  s_add_u32 m0, s78, 27648
  s_add_u32 s74, s73, 163840
  buffer_load_dwordx4 v4, s[16:19], s74 offen lds
  s_xor_b32 s73, s59, 3670016
  s_add_u32 s73, s73, s58
  s_add_u32 m0, s78, 28672
  s_add_u32 s74, s73, 0
  buffer_load_dwordx4 v4, s[16:19], s74 offen lds
  s_add_u32 m0, s78, 29696
  s_add_u32 s74, s73, 32768
  buffer_load_dwordx4 v4, s[16:19], s74 offen lds
  s_add_u32 m0, s78, 30720
  s_add_u32 s74, s73, 131072
  buffer_load_dwordx4 v4, s[16:19], s74 offen lds
  s_add_u32 m0, s78, 31744
  s_add_u32 s74, s73, 163840
  buffer_load_dwordx4 v4, s[16:19], s74 offen lds
  s_xor_b32 s73, s59, 524288
  s_add_u32 s73, s73, s58
  s_add_u32 m0, s78, 32768
  s_add_u32 s74, s73, 0
  buffer_load_dwordx4 v4, s[20:23], s74 offen lds
  s_add_u32 m0, s78, 33792
  s_add_u32 s74, s73, 32768
  buffer_load_dwordx4 v4, s[20:23], s74 offen lds
  s_add_u32 m0, s78, 34816
  s_add_u32 s74, s73, 131072
  buffer_load_dwordx4 v4, s[20:23], s74 offen lds
  s_add_u32 m0, s78, 35840
  s_add_u32 s74, s73, 163840
  buffer_load_dwordx4 v4, s[20:23], s74 offen lds
  v_lshrrev_b32 v23, 4, v22
  v_and_b32 v25, 3, v22
  v_lshlrev_b32 v7, 9, v23
  v_lshl_add_u32 v7, v25, 3, v7
  v_add_u32 v7, s78, v7
  v_bfe_u32 v24, v22, 2, 1
  v_lshl_add_u32 v8, v24, 7, v7
  v_bfe_u32 v24, v22, 3, 1
  v_lshl_add_u32 v8, v24, 5, v8
  s_and_b32 s73, s5, 1
  v_xor_b32 v24, s73, v24
  v_lshlrev_b32 v24, 6, v24
  v_lshl_add_u32 v23, v23, 10, v24
  v_bfe_u32 v24, v22, 2, 2
  v_lshl_add_u32 v7, v24, 6, v7
  v_lshl_add_u32 v23, v24, 7, v23
  s_and_b32 s73, s5, 2
  s_mul_i32 s73, s73, 40960
  v_add_u32 v23, s73, v23
  v_lshl_add_u32 v20, v25, 4, v23
  v_bfe_u32 v24, v22, 1, 1
  v_lshl_add_u32 v18, v24, 5, v23
  v_and_b32 v24, 1, v22
  v_lshl_add_u32 v18, v24, 3, v18
  v_add_u32 v19, 40960, v18
  v_add_u32 v21, 40960, v20
  v_lshlrev_b32 v0, 4, v22
  v_add_u32 v0, s78, v0
  v_mov_b32 v1, 0x4444
  v_mov_b32 v23, 0xeeee
  v_cndmask_b32 v1, v1, v23, s[80:81]
  v_and_b32 v23, 1, v22
  v_lshlrev_b32 v23, 4, v23
  v_mov_b32 v24, 0x3f80
  v_lshlrev_b32 v24, v23, v24
  v_bfe_u32 v23, v22, 1, 2
  v_bfe_u32 v25, v22, 4, 1
  v_lshlrev_b32 v25, 1, v25
  v_sub_u32 v23, v23, v25
  v_cmp_eq_u32 vcc, 0, v23
  s_nop 1
  v_cndmask_b32 v2, 0, v24, vcc
  v_cmp_eq_u32 vcc, 1, v23
  s_nop 1
  v_cndmask_b32 v3, 0, v24, vcc
  s_lshr_b32 s73, s78, 1
  s_sub_u32 s66, s66, s73
  s_lshl_b32 s73, s56, 6
  s_and_b32 s73, s73, 512
  s_add_u32 s92, s92, s73
  s_xor_b32 s74, s73, 512
  s_add_u32 s101, s66, s74
  s_add_u32 s66, s66, s73
  s_and_b32 s73, s5, 1
  s_lshl_b32 s73, s73, 8
  s_add_u32 s92, s92, s73
  s_bitcmp1_b32 s5, 0
  s_cbranch_scc1 WODD_55
  s_waitcnt vmcnt(18)
  s_barrier
  ds_read_b64_tr_b16 v[112:113], v18 offset:16384
  ds_read_b64_tr_b16 v[114:115], v18 offset:16896
  ds_read_b64_tr_b16 v[116:117], v19 offset:16384
  ds_read_b64_tr_b16 v[118:119], v19 offset:16896
  ds_read_b64_tr_b16 v[120:121], v18 offset:16400
  ds_read_b64_tr_b16 v[122:123], v18 offset:16912
  ds_read_b64_tr_b16 v[124:125], v19 offset:16400
  ds_read_b64_tr_b16 v[126:127], v19 offset:16912
  s_waitcnt vmcnt(14)
  s_waitcnt lgkmcnt(0)
  s_barrier
  s_xor_b32 s73, s87, 3145728
  s_add_u32 s73, s73, s86
  s_cmp_eq_u32 s88, 3
  s_cselect_b32 s73, s73, 268435456
  buffer_load_dword v31, v30, s[20:23], s73 offen
  s_xor_b32 s73, s59, 1572864
  s_add_u32 s73, s73, s58
  s_add_u32 m0, s78, 36864
  s_add_u32 s74, s73, 0
  buffer_load_dwordx4 v4, s[20:23], s74 offen lds
  s_add_u32 m0, s78, 37888
  s_add_u32 s74, s73, 32768
  buffer_load_dwordx4 v4, s[20:23], s74 offen lds
  s_add_u32 m0, s78, 38912
  s_add_u32 s74, s73, 131072
  buffer_load_dwordx4 v4, s[20:23], s74 offen lds
  s_add_u32 m0, s78, 39936
  s_add_u32 s74, s73, 163840
  buffer_load_dwordx4 v4, s[20:23], s74 offen lds
  ds_read_b64_tr_b16 v[128:129], v18 offset:20480
  ds_read_b64_tr_b16 v[130:131], v18 offset:20992
  ds_read_b64_tr_b16 v[132:133], v19 offset:20480
  ds_read_b64_tr_b16 v[134:135], v19 offset:20992
  ds_read_b64_tr_b16 v[136:137], v18 offset:20496
  ds_read_b64_tr_b16 v[138:139], v18 offset:21008
  ds_read_b64_tr_b16 v[140:141], v19 offset:20496
  ds_read_b64_tr_b16 v[142:143], v19 offset:21008
  s_waitcnt vmcnt(13)
  s_waitcnt lgkmcnt(0)
  s_barrier
  s_xor_b32 s73, s87, 3670016
  s_add_u32 s73, s73, s89
  s_cmp_eq_u32 s90, 14
  s_cselect_b32 s73, s73, 268435456
  buffer_load_dword v31, v30, s[20:23], s73 offen
  s_xor_b32 s73, s59, 2097152
  s_add_u32 s73, s73, s58
  s_add_u32 m0, s78, 0
  s_add_u32 s74, s73, 0
  buffer_load_dwordx4 v4, s[20:23], s74 offen lds
  s_add_u32 m0, s78, 1024
  s_add_u32 s74, s73, 32768
  buffer_load_dwordx4 v4, s[20:23], s74 offen lds
  s_add_u32 m0, s78, 2048
  s_add_u32 s74, s73, 131072
  buffer_load_dwordx4 v4, s[20:23], s74 offen lds
  s_add_u32 m0, s78, 3072
  s_add_u32 s74, s73, 163840
  buffer_load_dwordx4 v4, s[20:23], s74 offen lds
  ds_read_b64_tr_b16 v[144:145], v18 offset:24576
  ds_read_b64_tr_b16 v[146:147], v18 offset:25088
  ds_read_b64_tr_b16 v[148:149], v19 offset:24576
  ds_read_b64_tr_b16 v[150:151], v19 offset:25088
  ds_read_b64_tr_b16 v[152:153], v18 offset:24592
  ds_read_b64_tr_b16 v[154:155], v18 offset:25104
  ds_read_b64_tr_b16 v[156:157], v19 offset:24592
  ds_read_b64_tr_b16 v[158:159], v19 offset:25104
  s_waitcnt vmcnt(14)
  s_waitcnt lgkmcnt(0)
  s_barrier
  s_xor_b32 s73, s59, 2621440
  s_add_u32 s73, s73, s58
  s_add_u32 m0, s78, 4096
  s_add_u32 s74, s73, 0
  buffer_load_dwordx4 v4, s[20:23], s74 offen lds
  s_add_u32 m0, s78, 5120
  s_add_u32 s74, s73, 32768
  buffer_load_dwordx4 v4, s[20:23], s74 offen lds
  s_add_u32 m0, s78, 6144
  s_add_u32 s74, s73, 131072
  buffer_load_dwordx4 v4, s[20:23], s74 offen lds
  s_add_u32 m0, s78, 7168
  s_add_u32 s74, s73, 163840
  buffer_load_dwordx4 v4, s[20:23], s74 offen lds
  ds_read_b64_tr_b16 v[160:161], v18 offset:28672
  ds_read_b64_tr_b16 v[162:163], v18 offset:29184
  ds_read_b64_tr_b16 v[164:165], v19 offset:28672
  ds_read_b64_tr_b16 v[166:167], v19 offset:29184
  ds_read_b64_tr_b16 v[168:169], v18 offset:28688
  ds_read_b64_tr_b16 v[170:171], v18 offset:29200
  ds_read_b64_tr_b16 v[172:173], v19 offset:28688
  ds_read_b64_tr_b16 v[174:175], v19 offset:29200
  s_waitcnt vmcnt(14)
  s_waitcnt lgkmcnt(0)
  s_barrier
  s_xor_b32 s73, s87, 524288
  s_add_u32 s73, s73, s86
  s_cmp_eq_u32 s88, 6
  s_cselect_b32 s73, s73, 268435456
  buffer_load_dword v31, v30, s[24:27], s73 offen
  s_xor_b32 s73, s59, 3145728
  s_add_u32 s73, s73, s58
  s_add_u32 m0, s78, 8192
  s_add_u32 s74, s73, 0
  buffer_load_dwordx4 v4, s[20:23], s74 offen lds
  s_add_u32 m0, s78, 9216
  s_add_u32 s74, s73, 32768
  buffer_load_dwordx4 v4, s[20:23], s74 offen lds
  s_add_u32 m0, s78, 10240
  s_add_u32 s74, s73, 131072
  buffer_load_dwordx4 v4, s[20:23], s74 offen lds
  s_add_u32 m0, s78, 11264
  s_add_u32 s74, s73, 163840
  buffer_load_dwordx4 v4, s[20:23], s74 offen lds
  ds_read_b64_tr_b16 v[192:193], v18 offset:32768
  ds_read_b64_tr_b16 v[194:195], v18 offset:33280
  ds_read_b64_tr_b16 v[196:197], v19 offset:32768
  ds_read_b64_tr_b16 v[198:199], v19 offset:33280
  ds_read_b64_tr_b16 v[200:201], v18 offset:32784
  ds_read_b64_tr_b16 v[202:203], v18 offset:33296
  ds_read_b64_tr_b16 v[204:205], v19 offset:32784
  ds_read_b64_tr_b16 v[206:207], v19 offset:33296
  s_waitcnt vmcnt(14)
  s_waitcnt lgkmcnt(0)
  s_barrier
  s_xor_b32 s73, s87, 1048576
  s_add_u32 s73, s73, s89
  s_cmp_eq_u32 s90, 22
  s_cselect_b32 s73, s73, 268435456
  buffer_load_dword v31, v30, s[24:27], s73 offen
  s_xor_b32 s73, s59, 3670016
  s_add_u32 s73, s73, s58
  s_add_u32 m0, s78, 12288
  s_add_u32 s74, s73, 0
  buffer_load_dwordx4 v4, s[20:23], s74 offen lds
  s_add_u32 m0, s78, 13312
  s_add_u32 s74, s73, 32768
  buffer_load_dwordx4 v4, s[20:23], s74 offen lds
  s_add_u32 m0, s78, 14336
  s_add_u32 s74, s73, 131072
  buffer_load_dwordx4 v4, s[20:23], s74 offen lds
  s_add_u32 m0, s78, 15360
  s_add_u32 s74, s73, 163840
  buffer_load_dwordx4 v4, s[20:23], s74 offen lds
  ds_read_b64_tr_b16 v[208:209], v18 offset:36864
  ds_read_b64_tr_b16 v[210:211], v18 offset:37376
  ds_read_b64_tr_b16 v[212:213], v19 offset:36864
  ds_read_b64_tr_b16 v[214:215], v19 offset:37376
  ds_read_b64_tr_b16 v[216:217], v18 offset:36880
  ds_read_b64_tr_b16 v[218:219], v18 offset:37392
  ds_read_b64_tr_b16 v[220:221], v19 offset:36880
  ds_read_b64_tr_b16 v[222:223], v19 offset:37392
  s_waitcnt vmcnt(14)
  s_waitcnt lgkmcnt(0)
  s_barrier
  s_xor_b32 s73, s59, 0
  s_add_u32 s73, s73, s58
  s_add_u32 m0, s78, 16384
  s_add_u32 s74, s73, 0
  buffer_load_dwordx4 v4, s[24:27], s74 offen lds
  s_add_u32 m0, s78, 17408
  s_add_u32 s74, s73, 32768
  buffer_load_dwordx4 v4, s[24:27], s74 offen lds
  s_add_u32 m0, s78, 18432
  s_add_u32 s74, s73, 131072
  buffer_load_dwordx4 v4, s[24:27], s74 offen lds
  s_add_u32 m0, s78, 19456
  s_add_u32 s74, s73, 163840
  buffer_load_dwordx4 v4, s[24:27], s74 offen lds
  ds_read_b64_tr_b16 v[224:225], v18 offset:0
  ds_read_b64_tr_b16 v[226:227], v18 offset:512
  ds_read_b64_tr_b16 v[228:229], v19 offset:0
  ds_read_b64_tr_b16 v[230:231], v19 offset:512
  ds_read_b64_tr_b16 v[232:233], v18 offset:16
  ds_read_b64_tr_b16 v[234:235], v18 offset:528
  ds_read_b64_tr_b16 v[236:237], v19 offset:16
  ds_read_b64_tr_b16 v[238:239], v19 offset:528
  s_waitcnt vmcnt(14)
  s_waitcnt lgkmcnt(0)
  s_barrier
  s_add_u32 s73, s86, 4194304
  s_cmp_eq_u32 s88, 7
  s_cselect_b32 s73, s73, 268435456
  buffer_load_dword v31, v30, s[24:27], s73 offen
  s_xor_b32 s73, s59, 524288
  s_add_u32 s73, s73, s58
  s_add_u32 m0, s78, 20480
  s_add_u32 s74, s73, 0
  buffer_load_dwordx4 v4, s[24:27], s74 offen lds
  s_add_u32 m0, s78, 21504
  s_add_u32 s74, s73, 32768
  buffer_load_dwordx4 v4, s[24:27], s74 offen lds
  s_add_u32 m0, s78, 22528
  s_add_u32 s74, s73, 131072
  buffer_load_dwordx4 v4, s[24:27], s74 offen lds
  s_add_u32 m0, s78, 23552
  s_add_u32 s74, s73, 163840
  buffer_load_dwordx4 v4, s[24:27], s74 offen lds
  ds_read_b64_tr_b16 v[240:241], v18 offset:4096
  ds_read_b64_tr_b16 v[242:243], v18 offset:4608
  ds_read_b64_tr_b16 v[244:245], v19 offset:4096
  ds_read_b64_tr_b16 v[246:247], v19 offset:4608
  ds_read_b64_tr_b16 v[248:249], v18 offset:4112
  ds_read_b64_tr_b16 v[250:251], v18 offset:4624
  ds_read_b64_tr_b16 v[252:253], v19 offset:4112
  ds_read_b64_tr_b16 v[254:255], v19 offset:4624
  s_waitcnt vmcnt(14)
  s_waitcnt lgkmcnt(0)
  s_barrier
  s_xor_b32 s73, s59, 1048576
  s_add_u32 s73, s73, s58
  s_add_u32 m0, s78, 24576
  s_add_u32 s74, s73, 0
  buffer_load_dwordx4 v4, s[24:27], s74 offen lds
  s_add_u32 m0, s78, 25600
  s_add_u32 s74, s73, 32768
  buffer_load_dwordx4 v4, s[24:27], s74 offen lds
  s_add_u32 m0, s78, 26624
  s_add_u32 s74, s73, 131072
  buffer_load_dwordx4 v4, s[24:27], s74 offen lds
  s_add_u32 m0, s78, 27648
  s_add_u32 s74, s73, 163840
  buffer_load_dwordx4 v4, s[24:27], s74 offen lds
  ds_read_b64_tr_b16 a[0:1], v18 offset:8192
  ds_read_b64_tr_b16 a[2:3], v18 offset:8704
  ds_read_b64_tr_b16 a[4:5], v19 offset:8192
  ds_read_b64_tr_b16 a[6:7], v19 offset:8704
  ds_read_b64_tr_b16 a[8:9], v18 offset:8208
  ds_read_b64_tr_b16 a[10:11], v18 offset:8720
  ds_read_b64_tr_b16 a[12:13], v19 offset:8208
  ds_read_b64_tr_b16 a[14:15], v19 offset:8720
  s_waitcnt vmcnt(13)
  s_waitcnt lgkmcnt(0)
  s_barrier
  s_xor_b32 s73, s59, 1572864
  s_add_u32 s73, s73, s58
  s_add_u32 m0, s78, 28672
  s_add_u32 s74, s73, 0
  buffer_load_dwordx4 v4, s[24:27], s74 offen lds
  s_add_u32 m0, s78, 29696
  s_add_u32 s74, s73, 32768
  buffer_load_dwordx4 v4, s[24:27], s74 offen lds
  s_add_u32 m0, s78, 30720
  s_add_u32 s74, s73, 131072
  buffer_load_dwordx4 v4, s[24:27], s74 offen lds
  s_add_u32 m0, s78, 31744
  s_add_u32 s74, s73, 163840
  buffer_load_dwordx4 v4, s[24:27], s74 offen lds
  ds_read_b64_tr_b16 a[16:17], v18 offset:12288
  ds_read_b64_tr_b16 a[18:19], v18 offset:12800
  ds_read_b64_tr_b16 a[20:21], v19 offset:12288
  ds_read_b64_tr_b16 a[22:23], v19 offset:12800
  ds_read_b64_tr_b16 a[24:25], v18 offset:12304
  ds_read_b64_tr_b16 a[26:27], v18 offset:12816
  ds_read_b64_tr_b16 a[28:29], v19 offset:12304
  ds_read_b64_tr_b16 a[30:31], v19 offset:12816
  s_waitcnt vmcnt(13)
  s_waitcnt lgkmcnt(0)
  s_barrier
  s_add_u32 s73, s58, 4194304
  s_add_u32 m0, s78, 32768
  s_add_u32 s74, s73, 0
  buffer_load_dwordx4 v4, s[24:27], s74 offen lds
  s_add_u32 m0, s78, 33792
  s_add_u32 s74, s73, 32768
  buffer_load_dwordx4 v4, s[24:27], s74 offen lds
  s_add_u32 m0, s78, 34816
  s_add_u32 s74, s73, 131072
  buffer_load_dwordx4 v4, s[24:27], s74 offen lds
  s_add_u32 m0, s78, 35840
  s_add_u32 s74, s73, 163840
  buffer_load_dwordx4 v4, s[24:27], s74 offen lds
  ds_read_b64_tr_b16 a[32:33], v20 offset:16384
  ds_read_b64_tr_b16 a[34:35], v20 offset:16896
  ds_read_b64_tr_b16 a[36:37], v21 offset:16384
  ds_read_b64_tr_b16 a[38:39], v21 offset:16896
  ds_read_b64_tr_b16 a[40:41], v20 offset:16392
  ds_read_b64_tr_b16 a[42:43], v20 offset:16904
  ds_read_b64_tr_b16 a[44:45], v21 offset:16392
  ds_read_b64_tr_b16 a[46:47], v21 offset:16904
  s_waitcnt vmcnt(12)
  s_waitcnt lgkmcnt(0)
  s_barrier
  s_xor_b32 s73, s5, 0
  s_mul_i32 s73, s73, 36864
  s_lshl_b32 s74, s5, 8
  s_add_u32 s73, s73, s74
  s_add_u32 s73, s73, s63
  s_add_u32 m0, s78, 36864
  s_add_u32 s74, s73, 0
  buffer_load_dwordx4 v5, s[28:31], s74 offen lds
  s_add_u32 m0, s78, 37888
  s_add_u32 s74, s73, 9216
  buffer_load_dwordx4 v5, s[28:31], s74 offen lds
  s_add_u32 m0, s78, 38912
  s_add_u32 s74, s73, 18432
  buffer_load_dwordx4 v5, s[28:31], s74 offen lds
  s_add_u32 m0, s78, 39936
  s_add_u32 s74, s73, 27648
  buffer_load_dwordx4 v5, s[28:31], s74 offen lds
  ds_read_b64_tr_b16 a[48:49], v20 offset:20480
  ds_read_b64_tr_b16 a[50:51], v20 offset:20992
  ds_read_b64_tr_b16 a[52:53], v21 offset:20480
  ds_read_b64_tr_b16 a[54:55], v21 offset:20992
  ds_read_b64_tr_b16 a[56:57], v20 offset:20488
  ds_read_b64_tr_b16 a[58:59], v20 offset:21000
  ds_read_b64_tr_b16 a[60:61], v21 offset:20488
  ds_read_b64_tr_b16 a[62:63], v21 offset:21000
  s_waitcnt vmcnt(12)
  s_waitcnt lgkmcnt(0)
  s_barrier
  s_xor_b32 s73, s5, 1
  s_mul_i32 s73, s73, 36864
  s_lshl_b32 s74, s5, 8
  s_add_u32 s73, s73, s74
  s_add_u32 s73, s73, s63
  s_add_u32 m0, s78, 0
  s_add_u32 s74, s73, 0
  buffer_load_dwordx4 v5, s[28:31], s74 offen lds
  s_add_u32 m0, s78, 1024
  s_add_u32 s74, s73, 9216
  buffer_load_dwordx4 v5, s[28:31], s74 offen lds
  s_add_u32 m0, s78, 2048
  s_add_u32 s74, s73, 18432
  buffer_load_dwordx4 v5, s[28:31], s74 offen lds
  s_add_u32 m0, s78, 3072
  s_add_u32 s74, s73, 27648
  buffer_load_dwordx4 v5, s[28:31], s74 offen lds
  ds_read_b64_tr_b16 a[80:81], v20 offset:24576
  ds_read_b64_tr_b16 a[82:83], v20 offset:25088
  ds_read_b64_tr_b16 a[84:85], v21 offset:24576
  ds_read_b64_tr_b16 a[86:87], v21 offset:25088
  ds_read_b64_tr_b16 a[88:89], v20 offset:24584
  ds_read_b64_tr_b16 a[90:91], v20 offset:25096
  ds_read_b64_tr_b16 a[92:93], v21 offset:24584
  ds_read_b64_tr_b16 a[94:95], v21 offset:25096
  s_waitcnt vmcnt(12)
  s_waitcnt lgkmcnt(0)
  s_barrier
  s_xor_b32 s73, s5, 2
  s_mul_i32 s73, s73, 36864
  s_lshl_b32 s74, s5, 8
  s_add_u32 s73, s73, s74
  s_add_u32 s73, s73, s63
  s_add_u32 m0, s78, 4096
  s_add_u32 s74, s73, 0
  buffer_load_dwordx4 v5, s[28:31], s74 offen lds
  s_add_u32 m0, s78, 5120
  s_add_u32 s74, s73, 9216
  buffer_load_dwordx4 v5, s[28:31], s74 offen lds
  s_add_u32 m0, s78, 6144
  s_add_u32 s74, s73, 18432
  buffer_load_dwordx4 v5, s[28:31], s74 offen lds
  s_add_u32 m0, s78, 7168
  s_add_u32 s74, s73, 27648
  buffer_load_dwordx4 v5, s[28:31], s74 offen lds
  ds_read_b64_tr_b16 a[96:97], v20 offset:28672
  ds_read_b64_tr_b16 a[98:99], v20 offset:29184
  ds_read_b64_tr_b16 a[100:101], v21 offset:28672
  ds_read_b64_tr_b16 a[102:103], v21 offset:29184
  ds_read_b64_tr_b16 a[104:105], v20 offset:28680
  ds_read_b64_tr_b16 a[106:107], v20 offset:29192
  ds_read_b64_tr_b16 a[108:109], v21 offset:28680
  ds_read_b64_tr_b16 a[110:111], v21 offset:29192
  s_waitcnt vmcnt(12)
  s_waitcnt lgkmcnt(0)
  s_barrier
  s_xor_b32 s73, s5, 3
  s_mul_i32 s73, s73, 36864
  s_lshl_b32 s74, s5, 8
  s_add_u32 s73, s73, s74
  s_add_u32 s73, s73, s63
  s_add_u32 m0, s78, 8192
  s_add_u32 s74, s73, 0
  buffer_load_dwordx4 v5, s[28:31], s74 offen lds
  s_add_u32 m0, s78, 9216
  s_add_u32 s74, s73, 9216
  buffer_load_dwordx4 v5, s[28:31], s74 offen lds
  s_add_u32 m0, s78, 10240
  s_add_u32 s74, s73, 18432
  buffer_load_dwordx4 v5, s[28:31], s74 offen lds
  s_add_u32 m0, s78, 11264
  s_add_u32 s74, s73, 27648
  buffer_load_dwordx4 v5, s[28:31], s74 offen lds
  ds_read_b64_tr_b16 a[64:65], v20 offset:32768
  ds_read_b64_tr_b16 a[66:67], v20 offset:33280
  ds_read_b64_tr_b16 a[68:69], v21 offset:32768
  ds_read_b64_tr_b16 a[70:71], v21 offset:33280
  ds_read_b64_tr_b16 a[72:73], v20 offset:32776
  ds_read_b64_tr_b16 a[74:75], v20 offset:33288
  ds_read_b64_tr_b16 a[76:77], v21 offset:32776
  ds_read_b64_tr_b16 a[78:79], v21 offset:33288
  s_waitcnt vmcnt(12)
  s_waitcnt lgkmcnt(0)
  s_barrier
  s_xor_b32 s73, s5, 0
  s_mul_i32 s73, s73, 36864
  s_lshl_b32 s74, s5, 8
  s_add_u32 s73, s73, s74
  s_add_u32 s73, s73, s63
  s_add_u32 m0, s78, 12288
  s_add_u32 s74, s73, 128
  buffer_load_dwordx4 v5, s[28:31], s74 offen lds
  s_add_u32 m0, s78, 13312
  s_add_u32 s74, s73, 9344
  buffer_load_dwordx4 v5, s[28:31], s74 offen lds
  s_add_u32 m0, s78, 14336
  s_add_u32 s74, s73, 18560
  buffer_load_dwordx4 v5, s[28:31], s74 offen lds
  s_add_u32 m0, s78, 15360
  s_add_u32 s74, s73, 27776
  buffer_load_dwordx4 v5, s[28:31], s74 offen lds
  ds_read_b64_tr_b16 a[112:113], v8 offset:36864
  ds_read_b64_tr_b16 a[114:115], v8 offset:37120
  ds_read_b64_tr_b16 a[116:117], v8 offset:38912
  ds_read_b64_tr_b16 a[118:119], v8 offset:39168
  ds_read_b64_tr_b16 a[120:121], v8 offset:36928
  ds_read_b64_tr_b16 a[122:123], v8 offset:37184
  ds_read_b64_tr_b16 a[124:125], v8 offset:38976
  ds_read_b64_tr_b16 a[126:127], v8 offset:39232
  s_waitcnt vmcnt(12)
  s_waitcnt lgkmcnt(0)
  s_barrier
  s_xor_b32 s73, s5, 1
  s_mul_i32 s73, s73, 36864
  s_lshl_b32 s74, s5, 8
  s_add_u32 s73, s73, s74
  s_add_u32 s73, s73, s63
  s_add_u32 m0, s78, 16384
  s_add_u32 s74, s73, 128
  buffer_load_dwordx4 v5, s[28:31], s74 offen lds
  s_add_u32 m0, s78, 17408
  s_add_u32 s74, s73, 9344
  buffer_load_dwordx4 v5, s[28:31], s74 offen lds
  s_add_u32 m0, s78, 18432
  s_add_u32 s74, s73, 18560
  buffer_load_dwordx4 v5, s[28:31], s74 offen lds
  s_add_u32 m0, s78, 19456
  s_add_u32 s74, s73, 27776
  buffer_load_dwordx4 v5, s[28:31], s74 offen lds
  ds_read_b64_tr_b16 a[128:129], v8 offset:0
  ds_read_b64_tr_b16 a[130:131], v8 offset:256
  ds_read_b64_tr_b16 a[132:133], v8 offset:2048
  ds_read_b64_tr_b16 a[134:135], v8 offset:2304
  ds_read_b64_tr_b16 a[136:137], v8 offset:64
  ds_read_b64_tr_b16 a[138:139], v8 offset:320
  ds_read_b64_tr_b16 a[140:141], v8 offset:2112
  ds_read_b64_tr_b16 a[142:143], v8 offset:2368
  s_waitcnt vmcnt(12)
  s_waitcnt lgkmcnt(0)
  s_barrier
  s_xor_b32 s73, s87, 0
  s_add_u32 s73, s73, s86
  s_cmp_eq_u32 s88, 4
  s_cselect_b32 s73, s73, 268435456
  buffer_load_dword v31, v30, s[16:19], s73 offen
  s_xor_b32 s73, s5, 2
  s_mul_i32 s73, s73, 36864
  s_lshl_b32 s74, s5, 8
  s_add_u32 s73, s73, s74
  s_add_u32 s73, s73, s63
  s_add_u32 m0, s78, 20480
  s_add_u32 s74, s73, 128
  buffer_load_dwordx4 v5, s[28:31], s74 offen lds
  s_add_u32 m0, s78, 21504
  s_add_u32 s74, s73, 9344
  buffer_load_dwordx4 v5, s[28:31], s74 offen lds
  s_add_u32 m0, s78, 22528
  s_add_u32 s74, s73, 18560
  buffer_load_dwordx4 v5, s[28:31], s74 offen lds
  s_add_u32 m0, s78, 23552
  s_add_u32 s74, s73, 27776
  buffer_load_dwordx4 v5, s[28:31], s74 offen lds
  ds_read_b64_tr_b16 a[144:145], v8 offset:4096
  ds_read_b64_tr_b16 a[146:147], v8 offset:4352
  ds_read_b64_tr_b16 a[148:149], v8 offset:6144
  ds_read_b64_tr_b16 a[150:151], v8 offset:6400
  ds_read_b64_tr_b16 a[152:153], v8 offset:4160
  ds_read_b64_tr_b16 a[154:155], v8 offset:4416
  ds_read_b64_tr_b16 a[156:157], v8 offset:6208
  ds_read_b64_tr_b16 a[158:159], v8 offset:6464
  s_waitcnt vmcnt(13)
  s_waitcnt lgkmcnt(0)
  s_barrier
  s_xor_b32 s73, s87, 524288
  s_add_u32 s73, s73, s89
  s_cmp_eq_u32 s90, 30
  s_cselect_b32 s73, s73, 268435456
  buffer_load_dword v31, v30, s[16:19], s73 offen
  s_xor_b32 s73, s5, 3
  s_mul_i32 s73, s73, 36864
  s_lshl_b32 s74, s5, 8
  s_add_u32 s73, s73, s74
  s_add_u32 s73, s73, s63
  s_add_u32 m0, s78, 24576
  s_add_u32 s74, s73, 128
  buffer_load_dwordx4 v5, s[28:31], s74 offen lds
  s_add_u32 m0, s78, 25600
  s_add_u32 s74, s73, 9344
  buffer_load_dwordx4 v5, s[28:31], s74 offen lds
  s_add_u32 m0, s78, 26624
  s_add_u32 s74, s73, 18560
  buffer_load_dwordx4 v5, s[28:31], s74 offen lds
  s_add_u32 m0, s78, 27648
  s_add_u32 s74, s73, 27776
  buffer_load_dwordx4 v5, s[28:31], s74 offen lds
  ds_read_b64_tr_b16 a[160:161], v8 offset:8192
  ds_read_b64_tr_b16 a[162:163], v8 offset:8448
  ds_read_b64_tr_b16 a[164:165], v8 offset:10240
  ds_read_b64_tr_b16 a[166:167], v8 offset:10496
  ds_read_b64_tr_b16 a[168:169], v8 offset:8256
  ds_read_b64_tr_b16 a[170:171], v8 offset:8512
  ds_read_b64_tr_b16 a[172:173], v8 offset:10304
  ds_read_b64_tr_b16 a[174:175], v8 offset:10560
  s_waitcnt vmcnt(14)
  s_waitcnt lgkmcnt(0)
  s_barrier
  s_xor_b32 s73, s87, 1048576
  s_add_u32 s73, s73, s86
  s_cmp_eq_u32 s88, 2
  s_cselect_b32 s73, s73, 268435456
  buffer_load_dword v31, v30, s[20:23], s73 offen
  s_lshl_b32 s73, s5, 5
  s_add_u32 s73, s73, s63
  s_add_u32 m0, s78, 28672
  s_add_u32 s74, s73, 1024
  buffer_load_dwordx4 v6, s[28:31], s74 offen lds
  s_add_u32 m0, s78, 29696
  s_add_u32 s74, s73, 10240
  buffer_load_dwordx4 v6, s[28:31], s74 offen lds
  s_add_u32 m0, s78, 30720
  s_add_u32 s74, s73, 19456
  buffer_load_dwordx4 v6, s[28:31], s74 offen lds
  s_add_u32 m0, s78, 31744
  s_add_u32 s74, s73, 28672
  buffer_load_dwordx4 v6, s[28:31], s74 offen lds
  ds_read_b64_tr_b16 a[176:177], v8 offset:12288
  ds_read_b64_tr_b16 a[178:179], v8 offset:12544
  ds_read_b64_tr_b16 a[180:181], v8 offset:14336
  ds_read_b64_tr_b16 a[182:183], v8 offset:14592
  ds_read_b64_tr_b16 a[184:185], v8 offset:12352
  ds_read_b64_tr_b16 a[186:187], v8 offset:12608
  ds_read_b64_tr_b16 a[188:189], v8 offset:14400
  ds_read_b64_tr_b16 a[190:191], v8 offset:14656
  s_waitcnt vmcnt(15)
  s_waitcnt lgkmcnt(0)
  s_barrier
  s_xor_b32 s73, s87, 1048576
  s_add_u32 s73, s73, s89
  s_cmp_eq_u32 s90, 38
  s_cselect_b32 s73, s73, 268435456
  buffer_load_dword v31, v30, s[16:19], s73 offen
  s_xor_b32 s73, s59, 0
  s_add_u32 s73, s73, s58
  s_add_u32 m0, s78, 32768
  s_add_u32 s74, s73, 0
  buffer_load_dwordx4 v4, s[16:19], s74 offen lds
  s_add_u32 m0, s78, 33792
  s_add_u32 s74, s73, 32768
  buffer_load_dwordx4 v4, s[16:19], s74 offen lds
  s_add_u32 m0, s78, 34816
  s_add_u32 s74, s73, 131072
  buffer_load_dwordx4 v4, s[16:19], s74 offen lds
  s_add_u32 m0, s78, 35840
  s_add_u32 s74, s73, 163840
  buffer_load_dwordx4 v4, s[16:19], s74 offen lds
  ds_read_b64_tr_b16 a[192:193], v8 offset:16384
  ds_read_b64_tr_b16 a[194:195], v8 offset:16640
  ds_read_b64_tr_b16 a[196:197], v8 offset:18432
  ds_read_b64_tr_b16 a[198:199], v8 offset:18688
  ds_read_b64_tr_b16 a[200:201], v8 offset:16448
  ds_read_b64_tr_b16 a[202:203], v8 offset:16704
  ds_read_b64_tr_b16 a[204:205], v8 offset:18496
  ds_read_b64_tr_b16 a[206:207], v8 offset:18752
  s_waitcnt vmcnt(15)
  s_waitcnt lgkmcnt(0)
  s_barrier
  s_xor_b32 s73, s87, 1572864
  s_add_u32 s73, s73, s86
  s_cmp_eq_u32 s88, 3
  s_cselect_b32 s73, s73, 268435456
  buffer_load_dword v31, v30, s[16:19], s73 offen
  s_xor_b32 s73, s59, 524288
  s_add_u32 s73, s73, s58
  s_add_u32 m0, s78, 36864
  s_add_u32 s74, s73, 0
  buffer_load_dwordx4 v4, s[16:19], s74 offen lds
  s_add_u32 m0, s78, 37888
  s_add_u32 s74, s73, 32768
  buffer_load_dwordx4 v4, s[16:19], s74 offen lds
  s_add_u32 m0, s78, 38912
  s_add_u32 s74, s73, 131072
  buffer_load_dwordx4 v4, s[16:19], s74 offen lds
  s_add_u32 m0, s78, 39936
  s_add_u32 s74, s73, 163840
  buffer_load_dwordx4 v4, s[16:19], s74 offen lds
  ds_read_b64_tr_b16 a[208:209], v8 offset:20480
  ds_read_b64_tr_b16 a[210:211], v8 offset:20736
  ds_read_b64_tr_b16 a[212:213], v8 offset:22528
  ds_read_b64_tr_b16 a[214:215], v8 offset:22784
  ds_read_b64_tr_b16 a[216:217], v8 offset:20544
  ds_read_b64_tr_b16 a[218:219], v8 offset:20800
  ds_read_b64_tr_b16 a[220:221], v8 offset:22592
  ds_read_b64_tr_b16 a[222:223], v8 offset:22848
  s_waitcnt vmcnt(15)
  s_waitcnt lgkmcnt(0)
  s_barrier
  s_xor_b32 s73, s87, 0
  s_add_u32 s73, s73, s89
  s_cmp_eq_u32 s90, 46
  s_cselect_b32 s73, s73, 268435456
  buffer_load_dword v31, v30, s[20:23], s73 offen
  s_xor_b32 s73, s59, 1048576
  s_add_u32 s73, s73, s58
  s_add_u32 m0, s78, 0
  s_add_u32 s74, s73, 0
  buffer_load_dwordx4 v4, s[20:23], s74 offen lds
  s_add_u32 m0, s78, 1024
  s_add_u32 s74, s73, 32768
  buffer_load_dwordx4 v4, s[20:23], s74 offen lds
  s_add_u32 m0, s78, 2048
  s_add_u32 s74, s73, 131072
  buffer_load_dwordx4 v4, s[20:23], s74 offen lds
  s_add_u32 m0, s78, 3072
  s_add_u32 s74, s73, 163840
  buffer_load_dwordx4 v4, s[20:23], s74 offen lds
  ds_read_b64_tr_b16 a[224:225], v8 offset:24576
  ds_read_b64_tr_b16 a[226:227], v8 offset:24832
  ds_read_b64_tr_b16 a[228:229], v8 offset:26624
  ds_read_b64_tr_b16 a[230:231], v8 offset:26880
  ds_read_b64_tr_b16 a[232:233], v8 offset:24640
  ds_read_b64_tr_b16 a[234:235], v8 offset:24896
  ds_read_b64_tr_b16 a[236:237], v8 offset:26688
  ds_read_b64_tr_b16 a[238:239], v8 offset:26944
  s_waitcnt vmcnt(15)
  s_waitcnt lgkmcnt(0)
  s_barrier
  s_add_u32 s73, s86, 4194304
  s_cmp_eq_u32 s88, 6
  s_cselect_b32 s73, s73, 268435456
  buffer_load_dword v31, v30, s[16:19], s73 offen
  s_xor_b32 s73, s59, 1048576
  s_add_u32 s73, s73, s58
  s_add_u32 m0, s78, 4096
  s_add_u32 s74, s73, 0
  buffer_load_dwordx4 v4, s[16:19], s74 offen lds
  s_add_u32 m0, s78, 5120
  s_add_u32 s74, s73, 32768
  buffer_load_dwordx4 v4, s[16:19], s74 offen lds
  s_add_u32 m0, s78, 6144
  s_add_u32 s74, s73, 131072
  buffer_load_dwordx4 v4, s[16:19], s74 offen lds
  s_add_u32 m0, s78, 7168
  s_add_u32 s74, s73, 163840
  buffer_load_dwordx4 v4, s[16:19], s74 offen lds
  ds_read_b64_tr_b16 a[240:241], v7 offset:28672
  ds_read_b64_tr_b16 a[242:243], v7 offset:28928
  ds_read_b64_tr_b16 a[244:245], v7 offset:30720
  ds_read_b64_tr_b16 a[246:247], v7 offset:30976
  ds_read_b64_tr_b16 a[248:249], v7 offset:28704
  ds_read_b64_tr_b16 a[250:251], v7 offset:28960
  ds_read_b64_tr_b16 a[252:253], v7 offset:30752
  ds_read_b64_tr_b16 a[254:255], v7 offset:31008
  s_waitcnt vmcnt(15)
  s_waitcnt lgkmcnt(0)
  s_barrier
  s_xor_b32 s73, s59, 1572864
  s_add_u32 s73, s73, s58
  s_add_u32 m0, s78, 8192
  s_add_u32 s74, s73, 0
  buffer_load_dwordx4 v4, s[16:19], s74 offen lds
  s_add_u32 m0, s78, 9216
  s_add_u32 s74, s73, 32768
  buffer_load_dwordx4 v4, s[16:19], s74 offen lds
  s_add_u32 m0, s78, 10240
  s_add_u32 s74, s73, 131072
  buffer_load_dwordx4 v4, s[16:19], s74 offen lds
  s_add_u32 m0, s78, 11264
  s_add_u32 s74, s73, 163840
  buffer_load_dwordx4 v4, s[16:19], s74 offen lds
  ds_read_b64_tr_b16 v[32:33], v18 offset:32768
  ds_read_b64_tr_b16 v[34:35], v18 offset:33280
  ds_read_b64_tr_b16 v[36:37], v19 offset:32768
  ds_read_b64_tr_b16 v[38:39], v19 offset:33280
  ds_read_b64_tr_b16 v[40:41], v18 offset:32784
  ds_read_b64_tr_b16 v[42:43], v18 offset:33296
  ds_read_b64_tr_b16 v[44:45], v19 offset:32784
  ds_read_b64_tr_b16 v[46:47], v19 offset:33296
  s_waitcnt vmcnt(14)
  s_waitcnt lgkmcnt(0)
  s_barrier
  s_xor_b32 s73, s87, 2097152
  s_add_u32 s73, s73, s86
  s_cmp_eq_u32 s88, 7
  s_cselect_b32 s73, s73, 268435456
  buffer_load_dword v31, v30, s[24:27], s73 offen
  s_xor_b32 s73, s59, 0
  s_add_u32 s73, s73, s58
  s_add_u32 m0, s78, 12288
  s_add_u32 s74, s73, 0
  buffer_load_dwordx4 v4, s[20:23], s74 offen lds
  s_add_u32 m0, s78, 13312
  s_add_u32 s74, s73, 32768
  buffer_load_dwordx4 v4, s[20:23], s74 offen lds
  s_add_u32 m0, s78, 14336
  s_add_u32 s74, s73, 131072
  buffer_load_dwordx4 v4, s[20:23], s74 offen lds
  s_add_u32 m0, s78, 15360
  s_add_u32 s74, s73, 163840
  buffer_load_dwordx4 v4, s[20:23], s74 offen lds
  ds_read_b64_tr_b16 v[48:49], v18 offset:36864
  ds_read_b64_tr_b16 v[50:51], v18 offset:37376
  ds_read_b64_tr_b16 v[52:53], v19 offset:36864
  ds_read_b64_tr_b16 v[54:55], v19 offset:37376
  ds_read_b64_tr_b16 v[56:57], v18 offset:36880
  ds_read_b64_tr_b16 v[58:59], v18 offset:37392
  ds_read_b64_tr_b16 v[60:61], v19 offset:36880
  ds_read_b64_tr_b16 v[62:63], v19 offset:37392
  s_waitcnt vmcnt(14)
  s_waitcnt lgkmcnt(0)
  s_barrier
  s_xor_b32 s73, s87, 3145728
  s_add_u32 s73, s73, s89
  s_cmp_eq_u32 s90, 54
  s_cselect_b32 s73, s73, 268435456
  buffer_load_dword v31, v30, s[24:27], s73 offen
  s_add_u32 s73, s58, 4194304
  s_add_u32 m0, s78, 16384
  s_add_u32 s74, s73, 0
  buffer_load_dwordx4 v4, s[16:19], s74 offen lds
  s_add_u32 m0, s78, 17408
  s_add_u32 s74, s73, 32768
  buffer_load_dwordx4 v4, s[16:19], s74 offen lds
  s_add_u32 m0, s78, 18432
  s_add_u32 s74, s73, 131072
  buffer_load_dwordx4 v4, s[16:19], s74 offen lds
  s_add_u32 m0, s78, 19456
  s_add_u32 s74, s73, 163840
  buffer_load_dwordx4 v4, s[16:19], s74 offen lds
  ds_read_b64_tr_b16 v[64:65], v18 offset:0
  ds_read_b64_tr_b16 v[66:67], v18 offset:512
  ds_read_b64_tr_b16 v[68:69], v19 offset:0
  ds_read_b64_tr_b16 v[70:71], v19 offset:512
  ds_read_b64_tr_b16 v[72:73], v18 offset:16
  ds_read_b64_tr_b16 v[74:75], v18 offset:528
  ds_read_b64_tr_b16 v[76:77], v19 offset:16
  ds_read_b64_tr_b16 v[78:79], v19 offset:528
  s_waitcnt vmcnt(14)
  s_waitcnt lgkmcnt(0)
  s_barrier
  s_xor_b32 s73, s87, 2621440
  s_add_u32 s73, s73, s86
  s_cmp_eq_u32 s88, 5
  s_cselect_b32 s73, s73, 268435456
  buffer_load_dword v31, v30, s[24:27], s73 offen
  s_add_u32 s73, s58, 4194304
  s_add_u32 m0, s78, 20480
  s_add_u32 s74, s73, 0
  buffer_load_dwordx4 v4, s[20:23], s74 offen lds
  s_add_u32 m0, s78, 21504
  s_add_u32 s74, s73, 32768
  buffer_load_dwordx4 v4, s[20:23], s74 offen lds
  s_add_u32 m0, s78, 22528
  s_add_u32 s74, s73, 131072
  buffer_load_dwordx4 v4, s[20:23], s74 offen lds
  s_add_u32 m0, s78, 23552
  s_add_u32 s74, s73, 163840
  buffer_load_dwordx4 v4, s[20:23], s74 offen lds
  buffer_load_dword v26, off, s[48:51], 0 offset:64 sc1
  buffer_load_dword v27, off, s[48:51], 0 offset:0 sc1
  ds_read_b64_tr_b16 v[80:81], v18 offset:4096
  ds_read_b64_tr_b16 v[82:83], v18 offset:4608
  ds_read_b64_tr_b16 v[84:85], v19 offset:4096
  ds_read_b64_tr_b16 v[86:87], v19 offset:4608
  ds_read_b64_tr_b16 v[88:89], v18 offset:4112
  ds_read_b64_tr_b16 v[90:91], v18 offset:4624
  ds_read_b64_tr_b16 v[92:93], v19 offset:4112
  ds_read_b64_tr_b16 v[94:95], v19 offset:4624
  s_waitcnt vmcnt(17)
  s_waitcnt lgkmcnt(0)
  s_barrier
  s_xor_b32 s73, s59, 2097152
  s_add_u32 s73, s73, s58
  s_add_u32 m0, s78, 24576
  s_add_u32 s74, s73, 0
  buffer_load_dwordx4 v4, s[24:27], s74 offen lds
  s_add_u32 m0, s78, 25600
  s_add_u32 s74, s73, 32768
  buffer_load_dwordx4 v4, s[24:27], s74 offen lds
  s_add_u32 m0, s78, 26624
  s_add_u32 s74, s73, 131072
  buffer_load_dwordx4 v4, s[24:27], s74 offen lds
  s_add_u32 m0, s78, 27648
  s_add_u32 s74, s73, 163840
  buffer_load_dwordx4 v4, s[24:27], s74 offen lds
  ds_write_b128 v0, v[32:35] offset:4096
  ds_write_b128 v0, v[36:39] offset:5120
  ds_write_b128 v0, v[40:43] offset:6144
  ds_write_b128 v0, v[44:47] offset:7168
  ds_read_b64_tr_b16 v[96:97], v18 offset:8192
  ds_read_b64_tr_b16 v[98:99], v18 offset:8704
  ds_read_b64_tr_b16 v[100:101], v19 offset:8192
  ds_read_b64_tr_b16 v[102:103], v19 offset:8704
  ds_read_b64_tr_b16 v[104:105], v18 offset:8208
  ds_read_b64_tr_b16 v[106:107], v18 offset:8720
  ds_read_b64_tr_b16 v[108:109], v19 offset:8208
  ds_read_b64_tr_b16 v[110:111], v19 offset:8720
  s_waitcnt vmcnt(16)
  s_waitcnt lgkmcnt(0)
  s_barrier
  s_xor_b32 s73, s59, 3145728
  s_add_u32 s73, s73, s58
  s_add_u32 m0, s78, 28672
  s_add_u32 s74, s73, 0
  buffer_load_dwordx4 v4, s[24:27], s74 offen lds
  s_add_u32 m0, s78, 29696
  s_add_u32 s74, s73, 32768
  buffer_load_dwordx4 v4, s[24:27], s74 offen lds
  s_add_u32 m0, s78, 30720
  s_add_u32 s74, s73, 131072
  buffer_load_dwordx4 v4, s[24:27], s74 offen lds
  s_add_u32 m0, s78, 31744
  s_add_u32 s74, s73, 163840
  buffer_load_dwordx4 v4, s[24:27], s74 offen lds
  ds_write_b128 v0, v[48:51] offset:8192
  ds_write_b128 v0, v[52:55] offset:9216
  ds_write_b128 v0, v[56:59] offset:10240
  ds_write_b128 v0, v[60:63] offset:11264
  ds_read_b64_tr_b16 v[176:177], v18 offset:12288
  ds_read_b64_tr_b16 v[178:179], v18 offset:12800
  ds_read_b64_tr_b16 v[180:181], v19 offset:12288
  ds_read_b64_tr_b16 v[182:183], v19 offset:12800
  ds_read_b64_tr_b16 v[184:185], v18 offset:12304
  ds_read_b64_tr_b16 v[186:187], v18 offset:12816
  ds_read_b64_tr_b16 v[188:189], v19 offset:12304
  ds_read_b64_tr_b16 v[190:191], v19 offset:12816
  s_waitcnt vmcnt(15)
  s_waitcnt lgkmcnt(0)
  s_barrier
  s_xor_b32 s73, s59, 2621440
  s_add_u32 s73, s73, s58
  s_add_u32 m0, s78, 32768
  s_add_u32 s74, s73, 0
  buffer_load_dwordx4 v4, s[24:27], s74 offen lds
  s_add_u32 m0, s78, 33792
  s_add_u32 s74, s73, 32768
  buffer_load_dwordx4 v4, s[24:27], s74 offen lds
  s_add_u32 m0, s78, 34816
  s_add_u32 s74, s73, 131072
  buffer_load_dwordx4 v4, s[24:27], s74 offen lds
  s_add_u32 m0, s78, 35840
  s_add_u32 s74, s73, 163840
  buffer_load_dwordx4 v4, s[24:27], s74 offen lds
  ds_write_b128 v0, v[64:67] offset:12288
  ds_write_b128 v0, v[68:71] offset:13312
  ds_write_b128 v0, v[72:75] offset:14336
  ds_write_b128 v0, v[76:79] offset:15360
  ds_read_b64_tr_b16 v[32:33], v18 offset:16384
  ds_read_b64_tr_b16 v[34:35], v18 offset:16896
  ds_read_b64_tr_b16 v[36:37], v19 offset:16384
  ds_read_b64_tr_b16 v[38:39], v19 offset:16896
  ds_read_b64_tr_b16 v[40:41], v18 offset:16400
  ds_read_b64_tr_b16 v[42:43], v18 offset:16912
  ds_read_b64_tr_b16 v[44:45], v19 offset:16400
  ds_read_b64_tr_b16 v[46:47], v19 offset:16912
  s_waitcnt vmcnt(14)
  s_waitcnt lgkmcnt(0)
  s_barrier
  s_xor_b32 s73, s59, 3670016
  s_add_u32 s73, s73, s58
  s_add_u32 m0, s78, 36864
  s_add_u32 s74, s73, 0
  buffer_load_dwordx4 v4, s[24:27], s74 offen lds
  s_add_u32 m0, s78, 37888
  s_add_u32 s74, s73, 32768
  buffer_load_dwordx4 v4, s[24:27], s74 offen lds
  s_add_u32 m0, s78, 38912
  s_add_u32 s74, s73, 131072
  buffer_load_dwordx4 v4, s[24:27], s74 offen lds
  s_add_u32 m0, s78, 39936
  s_add_u32 s74, s73, 163840
  buffer_load_dwordx4 v4, s[24:27], s74 offen lds
  v_and_b32 v23, 7, v22
  v_mul_u32_u24 v23, 1152, v23
  v_lshrrev_b32 v24, 3, v22
  v_lshl_add_u32 v23, v24, 4, v23
  s_lshl_b32 s73, s5, 8
  buffer_load_dwordx4 v[4:7], v23, s[12:15], s73 offen
  buffer_load_dwordx4 v[8:11], v23, s[12:15], s73 offen offset:128
  buffer_load_dwordx4 v[12:15], v23, s[12:15], 0 offen offset:1024
  s_waitcnt vmcnt(19)
  v_readfirstlane_b32 s6, v26
  v_readfirstlane_b32 s79, v27
  s_cmp_ge_u32 s6, 32
  s_cselect_b32 s73, s70, 268435456
  buffer_load_dwordx2 v[28:29], off, s[52:55], s73 sc1
  ds_write_b128 v0, v[32:35] offset:16384
  ds_write_b128 v0, v[36:39] offset:17408
  ds_write_b128 v0, v[40:43] offset:18432
  ds_write_b128 v0, v[44:47] offset:19456
  ds_read_b64_tr_b16 v[48:49], v18 offset:20480
  ds_read_b64_tr_b16 v[50:51], v18 offset:20992
  ds_read_b64_tr_b16 v[52:53], v19 offset:20480
  ds_read_b64_tr_b16 v[54:55], v19 offset:20992
  ds_read_b64_tr_b16 v[56:57], v18 offset:20496
  ds_read_b64_tr_b16 v[58:59], v18 offset:21008
  ds_read_b64_tr_b16 v[60:61], v19 offset:20496
  ds_read_b64_tr_b16 v[62:63], v19 offset:21008
  s_waitcnt vmcnt(16)
  s_waitcnt lgkmcnt(0)
  s_barrier
  ds_write_b128 v0, v[48:51] offset:20480
  ds_write_b128 v0, v[52:55] offset:21504
  ds_write_b128 v0, v[56:59] offset:22528
  ds_write_b128 v0, v[60:63] offset:23552
  ds_read_b64_tr_b16 v[64:65], v20 offset:24576
  ds_read_b64_tr_b16 v[66:67], v20 offset:25088
  ds_read_b64_tr_b16 v[68:69], v21 offset:24576
  ds_read_b64_tr_b16 v[70:71], v21 offset:25088
  ds_read_b64_tr_b16 v[72:73], v20 offset:24584
  ds_read_b64_tr_b16 v[74:75], v20 offset:25096
  ds_read_b64_tr_b16 v[76:77], v21 offset:24584
  ds_read_b64_tr_b16 v[78:79], v21 offset:25096
  s_waitcnt vmcnt(12)
  s_waitcnt lgkmcnt(0)
  s_barrier
  ds_write_b128 v0, v[64:67] offset:24576
  ds_write_b128 v0, v[68:71] offset:25600
  ds_write_b128 v0, v[72:75] offset:26624
  ds_write_b128 v0, v[76:79] offset:27648
  ds_read_b64_tr_b16 v[32:33], v20 offset:28672
  ds_read_b64_tr_b16 v[34:35], v20 offset:29184
  ds_read_b64_tr_b16 v[36:37], v21 offset:28672
  ds_read_b64_tr_b16 v[38:39], v21 offset:29184
  ds_read_b64_tr_b16 v[40:41], v20 offset:28680
  ds_read_b64_tr_b16 v[42:43], v20 offset:29192
  ds_read_b64_tr_b16 v[44:45], v21 offset:28680
  ds_read_b64_tr_b16 v[46:47], v21 offset:29192
  s_waitcnt vmcnt(8)
  s_waitcnt lgkmcnt(0)
  s_barrier
  ds_write_b128 v0, v[32:35] offset:28672
  ds_write_b128 v0, v[36:39] offset:29696
  ds_write_b128 v0, v[40:43] offset:30720
  ds_write_b128 v0, v[44:47] offset:31744
  ds_read_b64_tr_b16 v[48:49], v20 offset:32768
  ds_read_b64_tr_b16 v[50:51], v20 offset:33280
  ds_read_b64_tr_b16 v[52:53], v21 offset:32768
  ds_read_b64_tr_b16 v[54:55], v21 offset:33280
  ds_read_b64_tr_b16 v[56:57], v20 offset:32776
  ds_read_b64_tr_b16 v[58:59], v20 offset:33288
  ds_read_b64_tr_b16 v[60:61], v21 offset:32776
  ds_read_b64_tr_b16 v[62:63], v21 offset:33288
  s_waitcnt vmcnt(4)
  s_waitcnt lgkmcnt(0)
  s_barrier
  ds_write_b128 v0, v[48:51] offset:32768
  ds_write_b128 v0, v[52:55] offset:33792
  ds_write_b128 v0, v[56:59] offset:34816
  ds_write_b128 v0, v[60:63] offset:35840
  ds_read_b64_tr_b16 v[64:65], v20 offset:36864
  ds_read_b64_tr_b16 v[66:67], v20 offset:37376
  ds_read_b64_tr_b16 v[68:69], v21 offset:36864
  ds_read_b64_tr_b16 v[70:71], v21 offset:37376
  ds_read_b64_tr_b16 v[72:73], v20 offset:36872
  ds_read_b64_tr_b16 v[74:75], v20 offset:37384
  ds_read_b64_tr_b16 v[76:77], v21 offset:36872
  ds_read_b64_tr_b16 v[78:79], v21 offset:37384
  s_waitcnt lgkmcnt(0)
  s_barrier
  ds_write_b128 v0, v[64:67] offset:36864
  ds_write_b128 v0, v[68:71] offset:37888
  ds_write_b128 v0, v[72:75] offset:38912
  ds_write_b128 v0, v[76:79] offset:39936
  s_branch WDONE_56
WODD_55:
  s_waitcnt vmcnt(18)
  s_barrier
  ds_read_b64_tr_b16 v[144:145], v18 offset:16384
  ds_read_b64_tr_b16 v[146:147], v18 offset:16896
  ds_read_b64_tr_b16 v[148:149], v19 offset:16384
  ds_read_b64_tr_b16 v[150:151], v19 offset:16896
  ds_read_b64_tr_b16 v[152:153], v18 offset:16400
  ds_read_b64_tr_b16 v[154:155], v18 offset:16912
  ds_read_b64_tr_b16 v[156:157], v19 offset:16400
  ds_read_b64_tr_b16 v[158:159], v19 offset:16912
  s_waitcnt vmcnt(14)
  s_waitcnt lgkmcnt(0)
  s_barrier
  s_xor_b32 s73, s87, 3145728
  s_add_u32 s73, s73, s86
  s_cmp_eq_u32 s88, 3
  s_cselect_b32 s73, s73, 268435456
  buffer_load_dword v31, v30, s[20:23], s73 offen
  s_xor_b32 s73, s59, 1572864
  s_add_u32 s73, s73, s58
  s_add_u32 m0, s78, 36864
  s_add_u32 s74, s73, 0
  buffer_load_dwordx4 v4, s[20:23], s74 offen lds
  s_add_u32 m0, s78, 37888
  s_add_u32 s74, s73, 32768
  buffer_load_dwordx4 v4, s[20:23], s74 offen lds
  s_add_u32 m0, s78, 38912
  s_add_u32 s74, s73, 131072
  buffer_load_dwordx4 v4, s[20:23], s74 offen lds
  s_add_u32 m0, s78, 39936
  s_add_u32 s74, s73, 163840
  buffer_load_dwordx4 v4, s[20:23], s74 offen lds
  ds_read_b64_tr_b16 v[160:161], v18 offset:20480
  ds_read_b64_tr_b16 v[162:163], v18 offset:20992
  ds_read_b64_tr_b16 v[164:165], v19 offset:20480
  ds_read_b64_tr_b16 v[166:167], v19 offset:20992
  ds_read_b64_tr_b16 v[168:169], v18 offset:20496
  ds_read_b64_tr_b16 v[170:171], v18 offset:21008
  ds_read_b64_tr_b16 v[172:173], v19 offset:20496
  ds_read_b64_tr_b16 v[174:175], v19 offset:21008
  s_waitcnt vmcnt(13)
  s_waitcnt lgkmcnt(0)
  s_barrier
  s_xor_b32 s73, s87, 3670016
  s_add_u32 s73, s73, s89
  s_cmp_eq_u32 s90, 14
  s_cselect_b32 s73, s73, 268435456
  buffer_load_dword v31, v30, s[20:23], s73 offen
  s_xor_b32 s73, s59, 2097152
  s_add_u32 s73, s73, s58
  s_add_u32 m0, s78, 0
  s_add_u32 s74, s73, 0
  buffer_load_dwordx4 v4, s[20:23], s74 offen lds
  s_add_u32 m0, s78, 1024
  s_add_u32 s74, s73, 32768
  buffer_load_dwordx4 v4, s[20:23], s74 offen lds
  s_add_u32 m0, s78, 2048
  s_add_u32 s74, s73, 131072
  buffer_load_dwordx4 v4, s[20:23], s74 offen lds
  s_add_u32 m0, s78, 3072
  s_add_u32 s74, s73, 163840
  buffer_load_dwordx4 v4, s[20:23], s74 offen lds
  ds_read_b64_tr_b16 v[112:113], v18 offset:24576
  ds_read_b64_tr_b16 v[114:115], v18 offset:25088
  ds_read_b64_tr_b16 v[116:117], v19 offset:24576
  ds_read_b64_tr_b16 v[118:119], v19 offset:25088
  ds_read_b64_tr_b16 v[120:121], v18 offset:24592
  ds_read_b64_tr_b16 v[122:123], v18 offset:25104
  ds_read_b64_tr_b16 v[124:125], v19 offset:24592
  ds_read_b64_tr_b16 v[126:127], v19 offset:25104
  s_waitcnt vmcnt(14)
  s_waitcnt lgkmcnt(0)
  s_barrier
  s_xor_b32 s73, s59, 2621440
  s_add_u32 s73, s73, s58
  s_add_u32 m0, s78, 4096
  s_add_u32 s74, s73, 0
  buffer_load_dwordx4 v4, s[20:23], s74 offen lds
  s_add_u32 m0, s78, 5120
  s_add_u32 s74, s73, 32768
  buffer_load_dwordx4 v4, s[20:23], s74 offen lds
  s_add_u32 m0, s78, 6144
  s_add_u32 s74, s73, 131072
  buffer_load_dwordx4 v4, s[20:23], s74 offen lds
  s_add_u32 m0, s78, 7168
  s_add_u32 s74, s73, 163840
  buffer_load_dwordx4 v4, s[20:23], s74 offen lds
  ds_read_b64_tr_b16 v[128:129], v18 offset:28672
  ds_read_b64_tr_b16 v[130:131], v18 offset:29184
  ds_read_b64_tr_b16 v[132:133], v19 offset:28672
  ds_read_b64_tr_b16 v[134:135], v19 offset:29184
  ds_read_b64_tr_b16 v[136:137], v18 offset:28688
  ds_read_b64_tr_b16 v[138:139], v18 offset:29200
  ds_read_b64_tr_b16 v[140:141], v19 offset:28688
  ds_read_b64_tr_b16 v[142:143], v19 offset:29200
  s_waitcnt vmcnt(14)
  s_waitcnt lgkmcnt(0)
  s_barrier
  s_xor_b32 s73, s87, 524288
  s_add_u32 s73, s73, s86
  s_cmp_eq_u32 s88, 6
  s_cselect_b32 s73, s73, 268435456
  buffer_load_dword v31, v30, s[24:27], s73 offen
  s_xor_b32 s73, s59, 3145728
  s_add_u32 s73, s73, s58
  s_add_u32 m0, s78, 8192
  s_add_u32 s74, s73, 0
  buffer_load_dwordx4 v4, s[20:23], s74 offen lds
  s_add_u32 m0, s78, 9216
  s_add_u32 s74, s73, 32768
  buffer_load_dwordx4 v4, s[20:23], s74 offen lds
  s_add_u32 m0, s78, 10240
  s_add_u32 s74, s73, 131072
  buffer_load_dwordx4 v4, s[20:23], s74 offen lds
  s_add_u32 m0, s78, 11264
  s_add_u32 s74, s73, 163840
  buffer_load_dwordx4 v4, s[20:23], s74 offen lds
  ds_read_b64_tr_b16 v[208:209], v18 offset:32768
  ds_read_b64_tr_b16 v[210:211], v18 offset:33280
  ds_read_b64_tr_b16 v[212:213], v19 offset:32768
  ds_read_b64_tr_b16 v[214:215], v19 offset:33280
  ds_read_b64_tr_b16 v[216:217], v18 offset:32784
  ds_read_b64_tr_b16 v[218:219], v18 offset:33296
  ds_read_b64_tr_b16 v[220:221], v19 offset:32784
  ds_read_b64_tr_b16 v[222:223], v19 offset:33296
  s_waitcnt vmcnt(14)
  s_waitcnt lgkmcnt(0)
  s_barrier
  s_xor_b32 s73, s87, 1048576
  s_add_u32 s73, s73, s89
  s_cmp_eq_u32 s90, 22
  s_cselect_b32 s73, s73, 268435456
  buffer_load_dword v31, v30, s[24:27], s73 offen
  s_xor_b32 s73, s59, 3670016
  s_add_u32 s73, s73, s58
  s_add_u32 m0, s78, 12288
  s_add_u32 s74, s73, 0
  buffer_load_dwordx4 v4, s[20:23], s74 offen lds
  s_add_u32 m0, s78, 13312
  s_add_u32 s74, s73, 32768
  buffer_load_dwordx4 v4, s[20:23], s74 offen lds
  s_add_u32 m0, s78, 14336
  s_add_u32 s74, s73, 131072
  buffer_load_dwordx4 v4, s[20:23], s74 offen lds
  s_add_u32 m0, s78, 15360
  s_add_u32 s74, s73, 163840
  buffer_load_dwordx4 v4, s[20:23], s74 offen lds
  ds_read_b64_tr_b16 v[192:193], v18 offset:36864
  ds_read_b64_tr_b16 v[194:195], v18 offset:37376
  ds_read_b64_tr_b16 v[196:197], v19 offset:36864
  ds_read_b64_tr_b16 v[198:199], v19 offset:37376
  ds_read_b64_tr_b16 v[200:201], v18 offset:36880
  ds_read_b64_tr_b16 v[202:203], v18 offset:37392
  ds_read_b64_tr_b16 v[204:205], v19 offset:36880
  ds_read_b64_tr_b16 v[206:207], v19 offset:37392
  s_waitcnt vmcnt(14)
  s_waitcnt lgkmcnt(0)
  s_barrier
  s_xor_b32 s73, s59, 0
  s_add_u32 s73, s73, s58
  s_add_u32 m0, s78, 16384
  s_add_u32 s74, s73, 0
  buffer_load_dwordx4 v4, s[24:27], s74 offen lds
  s_add_u32 m0, s78, 17408
  s_add_u32 s74, s73, 32768
  buffer_load_dwordx4 v4, s[24:27], s74 offen lds
  s_add_u32 m0, s78, 18432
  s_add_u32 s74, s73, 131072
  buffer_load_dwordx4 v4, s[24:27], s74 offen lds
  s_add_u32 m0, s78, 19456
  s_add_u32 s74, s73, 163840
  buffer_load_dwordx4 v4, s[24:27], s74 offen lds
  ds_read_b64_tr_b16 a[0:1], v18 offset:0
  ds_read_b64_tr_b16 a[2:3], v18 offset:512
  ds_read_b64_tr_b16 a[4:5], v19 offset:0
  ds_read_b64_tr_b16 a[6:7], v19 offset:512
  ds_read_b64_tr_b16 a[8:9], v18 offset:16
  ds_read_b64_tr_b16 a[10:11], v18 offset:528
  ds_read_b64_tr_b16 a[12:13], v19 offset:16
  ds_read_b64_tr_b16 a[14:15], v19 offset:528
  s_waitcnt vmcnt(14)
  s_waitcnt lgkmcnt(0)
  s_barrier
  s_add_u32 s73, s86, 4194304
  s_cmp_eq_u32 s88, 7
  s_cselect_b32 s73, s73, 268435456
  buffer_load_dword v31, v30, s[24:27], s73 offen
  s_xor_b32 s73, s59, 524288
  s_add_u32 s73, s73, s58
  s_add_u32 m0, s78, 20480
  s_add_u32 s74, s73, 0
  buffer_load_dwordx4 v4, s[24:27], s74 offen lds
  s_add_u32 m0, s78, 21504
  s_add_u32 s74, s73, 32768
  buffer_load_dwordx4 v4, s[24:27], s74 offen lds
  s_add_u32 m0, s78, 22528
  s_add_u32 s74, s73, 131072
  buffer_load_dwordx4 v4, s[24:27], s74 offen lds
  s_add_u32 m0, s78, 23552
  s_add_u32 s74, s73, 163840
  buffer_load_dwordx4 v4, s[24:27], s74 offen lds
  ds_read_b64_tr_b16 a[16:17], v18 offset:4096
  ds_read_b64_tr_b16 a[18:19], v18 offset:4608
  ds_read_b64_tr_b16 a[20:21], v19 offset:4096
  ds_read_b64_tr_b16 a[22:23], v19 offset:4608
  ds_read_b64_tr_b16 a[24:25], v18 offset:4112
  ds_read_b64_tr_b16 a[26:27], v18 offset:4624
  ds_read_b64_tr_b16 a[28:29], v19 offset:4112
  ds_read_b64_tr_b16 a[30:31], v19 offset:4624
  s_waitcnt vmcnt(14)
  s_waitcnt lgkmcnt(0)
  s_barrier
  s_xor_b32 s73, s59, 1048576
  s_add_u32 s73, s73, s58
  s_add_u32 m0, s78, 24576
  s_add_u32 s74, s73, 0
  buffer_load_dwordx4 v4, s[24:27], s74 offen lds
  s_add_u32 m0, s78, 25600
  s_add_u32 s74, s73, 32768
  buffer_load_dwordx4 v4, s[24:27], s74 offen lds
  s_add_u32 m0, s78, 26624
  s_add_u32 s74, s73, 131072
  buffer_load_dwordx4 v4, s[24:27], s74 offen lds
  s_add_u32 m0, s78, 27648
  s_add_u32 s74, s73, 163840
  buffer_load_dwordx4 v4, s[24:27], s74 offen lds
  ds_read_b64_tr_b16 v[224:225], v18 offset:8192
  ds_read_b64_tr_b16 v[226:227], v18 offset:8704
  ds_read_b64_tr_b16 v[228:229], v19 offset:8192
  ds_read_b64_tr_b16 v[230:231], v19 offset:8704
  ds_read_b64_tr_b16 v[232:233], v18 offset:8208
  ds_read_b64_tr_b16 v[234:235], v18 offset:8720
  ds_read_b64_tr_b16 v[236:237], v19 offset:8208
  ds_read_b64_tr_b16 v[238:239], v19 offset:8720
  s_waitcnt vmcnt(13)
  s_waitcnt lgkmcnt(0)
  s_barrier
  s_xor_b32 s73, s59, 1572864
  s_add_u32 s73, s73, s58
  s_add_u32 m0, s78, 28672
  s_add_u32 s74, s73, 0
  buffer_load_dwordx4 v4, s[24:27], s74 offen lds
  s_add_u32 m0, s78, 29696
  s_add_u32 s74, s73, 32768
  buffer_load_dwordx4 v4, s[24:27], s74 offen lds
  s_add_u32 m0, s78, 30720
  s_add_u32 s74, s73, 131072
  buffer_load_dwordx4 v4, s[24:27], s74 offen lds
  s_add_u32 m0, s78, 31744
  s_add_u32 s74, s73, 163840
  buffer_load_dwordx4 v4, s[24:27], s74 offen lds
  ds_read_b64_tr_b16 v[240:241], v18 offset:12288
  ds_read_b64_tr_b16 v[242:243], v18 offset:12800
  ds_read_b64_tr_b16 v[244:245], v19 offset:12288
  ds_read_b64_tr_b16 v[246:247], v19 offset:12800
  ds_read_b64_tr_b16 v[248:249], v18 offset:12304
  ds_read_b64_tr_b16 v[250:251], v18 offset:12816
  ds_read_b64_tr_b16 v[252:253], v19 offset:12304
  ds_read_b64_tr_b16 v[254:255], v19 offset:12816
  s_waitcnt vmcnt(13)
  s_waitcnt lgkmcnt(0)
  s_barrier
  s_add_u32 s73, s58, 4194304
  s_add_u32 m0, s78, 32768
  s_add_u32 s74, s73, 0
  buffer_load_dwordx4 v4, s[24:27], s74 offen lds
  s_add_u32 m0, s78, 33792
  s_add_u32 s74, s73, 32768
  buffer_load_dwordx4 v4, s[24:27], s74 offen lds
  s_add_u32 m0, s78, 34816
  s_add_u32 s74, s73, 131072
  buffer_load_dwordx4 v4, s[24:27], s74 offen lds
  s_add_u32 m0, s78, 35840
  s_add_u32 s74, s73, 163840
  buffer_load_dwordx4 v4, s[24:27], s74 offen lds
  ds_read_b64_tr_b16 a[80:81], v20 offset:16384
  ds_read_b64_tr_b16 a[82:83], v20 offset:16896
  ds_read_b64_tr_b16 a[84:85], v21 offset:16384
  ds_read_b64_tr_b16 a[86:87], v21 offset:16896
  ds_read_b64_tr_b16 a[88:89], v20 offset:16392
  ds_read_b64_tr_b16 a[90:91], v20 offset:16904
  ds_read_b64_tr_b16 a[92:93], v21 offset:16392
  ds_read_b64_tr_b16 a[94:95], v21 offset:16904
  s_waitcnt vmcnt(12)
  s_waitcnt lgkmcnt(0)
  s_barrier
  s_xor_b32 s73, s5, 0
  s_mul_i32 s73, s73, 36864
  s_lshl_b32 s74, s5, 8
  s_add_u32 s73, s73, s74
  s_add_u32 s73, s73, s63
  s_add_u32 m0, s78, 36864
  s_add_u32 s74, s73, 0
  buffer_load_dwordx4 v5, s[28:31], s74 offen lds
  s_add_u32 m0, s78, 37888
  s_add_u32 s74, s73, 9216
  buffer_load_dwordx4 v5, s[28:31], s74 offen lds
  s_add_u32 m0, s78, 38912
  s_add_u32 s74, s73, 18432
  buffer_load_dwordx4 v5, s[28:31], s74 offen lds
  s_add_u32 m0, s78, 39936
  s_add_u32 s74, s73, 27648
  buffer_load_dwordx4 v5, s[28:31], s74 offen lds
  ds_read_b64_tr_b16 a[96:97], v20 offset:20480
  ds_read_b64_tr_b16 a[98:99], v20 offset:20992
  ds_read_b64_tr_b16 a[100:101], v21 offset:20480
  ds_read_b64_tr_b16 a[102:103], v21 offset:20992
  ds_read_b64_tr_b16 a[104:105], v20 offset:20488
  ds_read_b64_tr_b16 a[106:107], v20 offset:21000
  ds_read_b64_tr_b16 a[108:109], v21 offset:20488
  ds_read_b64_tr_b16 a[110:111], v21 offset:21000
  s_waitcnt vmcnt(12)
  s_waitcnt lgkmcnt(0)
  s_barrier
  s_xor_b32 s73, s5, 1
  s_mul_i32 s73, s73, 36864
  s_lshl_b32 s74, s5, 8
  s_add_u32 s73, s73, s74
  s_add_u32 s73, s73, s63
  s_add_u32 m0, s78, 0
  s_add_u32 s74, s73, 0
  buffer_load_dwordx4 v5, s[28:31], s74 offen lds
  s_add_u32 m0, s78, 1024
  s_add_u32 s74, s73, 9216
  buffer_load_dwordx4 v5, s[28:31], s74 offen lds
  s_add_u32 m0, s78, 2048
  s_add_u32 s74, s73, 18432
  buffer_load_dwordx4 v5, s[28:31], s74 offen lds
  s_add_u32 m0, s78, 3072
  s_add_u32 s74, s73, 27648
  buffer_load_dwordx4 v5, s[28:31], s74 offen lds
  ds_read_b64_tr_b16 a[32:33], v20 offset:24576
  ds_read_b64_tr_b16 a[34:35], v20 offset:25088
  ds_read_b64_tr_b16 a[36:37], v21 offset:24576
  ds_read_b64_tr_b16 a[38:39], v21 offset:25088
  ds_read_b64_tr_b16 a[40:41], v20 offset:24584
  ds_read_b64_tr_b16 a[42:43], v20 offset:25096
  ds_read_b64_tr_b16 a[44:45], v21 offset:24584
  ds_read_b64_tr_b16 a[46:47], v21 offset:25096
  s_waitcnt vmcnt(12)
  s_waitcnt lgkmcnt(0)
  s_barrier
  s_xor_b32 s73, s5, 2
  s_mul_i32 s73, s73, 36864
  s_lshl_b32 s74, s5, 8
  s_add_u32 s73, s73, s74
  s_add_u32 s73, s73, s63
  s_add_u32 m0, s78, 4096
  s_add_u32 s74, s73, 0
  buffer_load_dwordx4 v5, s[28:31], s74 offen lds
  s_add_u32 m0, s78, 5120
  s_add_u32 s74, s73, 9216
  buffer_load_dwordx4 v5, s[28:31], s74 offen lds
  s_add_u32 m0, s78, 6144
  s_add_u32 s74, s73, 18432
  buffer_load_dwordx4 v5, s[28:31], s74 offen lds
  s_add_u32 m0, s78, 7168
  s_add_u32 s74, s73, 27648
  buffer_load_dwordx4 v5, s[28:31], s74 offen lds
  ds_read_b64_tr_b16 a[48:49], v20 offset:28672
  ds_read_b64_tr_b16 a[50:51], v20 offset:29184
  ds_read_b64_tr_b16 a[52:53], v21 offset:28672
  ds_read_b64_tr_b16 a[54:55], v21 offset:29184
  ds_read_b64_tr_b16 a[56:57], v20 offset:28680
  ds_read_b64_tr_b16 a[58:59], v20 offset:29192
  ds_read_b64_tr_b16 a[60:61], v21 offset:28680
  ds_read_b64_tr_b16 a[62:63], v21 offset:29192
  s_waitcnt vmcnt(12)
  s_waitcnt lgkmcnt(0)
  s_barrier
  s_xor_b32 s73, s5, 3
  s_mul_i32 s73, s73, 36864
  s_lshl_b32 s74, s5, 8
  s_add_u32 s73, s73, s74
  s_add_u32 s73, s73, s63
  s_add_u32 m0, s78, 8192
  s_add_u32 s74, s73, 0
  buffer_load_dwordx4 v5, s[28:31], s74 offen lds
  s_add_u32 m0, s78, 9216
  s_add_u32 s74, s73, 9216
  buffer_load_dwordx4 v5, s[28:31], s74 offen lds
  s_add_u32 m0, s78, 10240
  s_add_u32 s74, s73, 18432
  buffer_load_dwordx4 v5, s[28:31], s74 offen lds
  s_add_u32 m0, s78, 11264
  s_add_u32 s74, s73, 27648
  buffer_load_dwordx4 v5, s[28:31], s74 offen lds
  ds_read_b64_tr_b16 a[64:65], v20 offset:32768
  ds_read_b64_tr_b16 a[66:67], v20 offset:33280
  ds_read_b64_tr_b16 a[68:69], v21 offset:32768
  ds_read_b64_tr_b16 a[70:71], v21 offset:33280
  ds_read_b64_tr_b16 a[72:73], v20 offset:32776
  ds_read_b64_tr_b16 a[74:75], v20 offset:33288
  ds_read_b64_tr_b16 a[76:77], v21 offset:32776
  ds_read_b64_tr_b16 a[78:79], v21 offset:33288
  s_waitcnt vmcnt(12)
  s_waitcnt lgkmcnt(0)
  s_barrier
  s_xor_b32 s73, s5, 0
  s_mul_i32 s73, s73, 36864
  s_lshl_b32 s74, s5, 8
  s_add_u32 s73, s73, s74
  s_add_u32 s73, s73, s63
  s_add_u32 m0, s78, 12288
  s_add_u32 s74, s73, 128
  buffer_load_dwordx4 v5, s[28:31], s74 offen lds
  s_add_u32 m0, s78, 13312
  s_add_u32 s74, s73, 9344
  buffer_load_dwordx4 v5, s[28:31], s74 offen lds
  s_add_u32 m0, s78, 14336
  s_add_u32 s74, s73, 18560
  buffer_load_dwordx4 v5, s[28:31], s74 offen lds
  s_add_u32 m0, s78, 15360
  s_add_u32 s74, s73, 27776
  buffer_load_dwordx4 v5, s[28:31], s74 offen lds
  ds_read_b64_tr_b16 a[112:113], v8 offset:36864
  ds_read_b64_tr_b16 a[114:115], v8 offset:37120
  ds_read_b64_tr_b16 a[116:117], v8 offset:38912
  ds_read_b64_tr_b16 a[118:119], v8 offset:39168
  ds_read_b64_tr_b16 a[120:121], v8 offset:36928
  ds_read_b64_tr_b16 a[122:123], v8 offset:37184
  ds_read_b64_tr_b16 a[124:125], v8 offset:38976
  ds_read_b64_tr_b16 a[126:127], v8 offset:39232
  s_waitcnt vmcnt(12)
  s_waitcnt lgkmcnt(0)
  s_barrier
  s_xor_b32 s73, s5, 1
  s_mul_i32 s73, s73, 36864
  s_lshl_b32 s74, s5, 8
  s_add_u32 s73, s73, s74
  s_add_u32 s73, s73, s63
  s_add_u32 m0, s78, 16384
  s_add_u32 s74, s73, 128
  buffer_load_dwordx4 v5, s[28:31], s74 offen lds
  s_add_u32 m0, s78, 17408
  s_add_u32 s74, s73, 9344
  buffer_load_dwordx4 v5, s[28:31], s74 offen lds
  s_add_u32 m0, s78, 18432
  s_add_u32 s74, s73, 18560
  buffer_load_dwordx4 v5, s[28:31], s74 offen lds
  s_add_u32 m0, s78, 19456
  s_add_u32 s74, s73, 27776
  buffer_load_dwordx4 v5, s[28:31], s74 offen lds
  ds_read_b64_tr_b16 a[128:129], v8 offset:0
  ds_read_b64_tr_b16 a[130:131], v8 offset:256
  ds_read_b64_tr_b16 a[132:133], v8 offset:2048
  ds_read_b64_tr_b16 a[134:135], v8 offset:2304
  ds_read_b64_tr_b16 a[136:137], v8 offset:64
  ds_read_b64_tr_b16 a[138:139], v8 offset:320
  ds_read_b64_tr_b16 a[140:141], v8 offset:2112
  ds_read_b64_tr_b16 a[142:143], v8 offset:2368
  s_waitcnt vmcnt(12)
  s_waitcnt lgkmcnt(0)
  s_barrier
  s_xor_b32 s73, s87, 0
  s_add_u32 s73, s73, s86
  s_cmp_eq_u32 s88, 4
  s_cselect_b32 s73, s73, 268435456
  buffer_load_dword v31, v30, s[16:19], s73 offen
  s_xor_b32 s73, s5, 2
  s_mul_i32 s73, s73, 36864
  s_lshl_b32 s74, s5, 8
  s_add_u32 s73, s73, s74
  s_add_u32 s73, s73, s63
  s_add_u32 m0, s78, 20480
  s_add_u32 s74, s73, 128
  buffer_load_dwordx4 v5, s[28:31], s74 offen lds
  s_add_u32 m0, s78, 21504
  s_add_u32 s74, s73, 9344
  buffer_load_dwordx4 v5, s[28:31], s74 offen lds
  s_add_u32 m0, s78, 22528
  s_add_u32 s74, s73, 18560
  buffer_load_dwordx4 v5, s[28:31], s74 offen lds
  s_add_u32 m0, s78, 23552
  s_add_u32 s74, s73, 27776
  buffer_load_dwordx4 v5, s[28:31], s74 offen lds
  ds_read_b64_tr_b16 a[144:145], v8 offset:4096
  ds_read_b64_tr_b16 a[146:147], v8 offset:4352
  ds_read_b64_tr_b16 a[148:149], v8 offset:6144
  ds_read_b64_tr_b16 a[150:151], v8 offset:6400
  ds_read_b64_tr_b16 a[152:153], v8 offset:4160
  ds_read_b64_tr_b16 a[154:155], v8 offset:4416
  ds_read_b64_tr_b16 a[156:157], v8 offset:6208
  ds_read_b64_tr_b16 a[158:159], v8 offset:6464
  s_waitcnt vmcnt(13)
  s_waitcnt lgkmcnt(0)
  s_barrier
  s_xor_b32 s73, s87, 524288
  s_add_u32 s73, s73, s89
  s_cmp_eq_u32 s90, 30
  s_cselect_b32 s73, s73, 268435456
  buffer_load_dword v31, v30, s[16:19], s73 offen
  s_xor_b32 s73, s5, 3
  s_mul_i32 s73, s73, 36864
  s_lshl_b32 s74, s5, 8
  s_add_u32 s73, s73, s74
  s_add_u32 s73, s73, s63
  s_add_u32 m0, s78, 24576
  s_add_u32 s74, s73, 128
  buffer_load_dwordx4 v5, s[28:31], s74 offen lds
  s_add_u32 m0, s78, 25600
  s_add_u32 s74, s73, 9344
  buffer_load_dwordx4 v5, s[28:31], s74 offen lds
  s_add_u32 m0, s78, 26624
  s_add_u32 s74, s73, 18560
  buffer_load_dwordx4 v5, s[28:31], s74 offen lds
  s_add_u32 m0, s78, 27648
  s_add_u32 s74, s73, 27776
  buffer_load_dwordx4 v5, s[28:31], s74 offen lds
  ds_read_b64_tr_b16 a[160:161], v8 offset:8192
  ds_read_b64_tr_b16 a[162:163], v8 offset:8448
  ds_read_b64_tr_b16 a[164:165], v8 offset:10240
  ds_read_b64_tr_b16 a[166:167], v8 offset:10496
  ds_read_b64_tr_b16 a[168:169], v8 offset:8256
  ds_read_b64_tr_b16 a[170:171], v8 offset:8512
  ds_read_b64_tr_b16 a[172:173], v8 offset:10304
  ds_read_b64_tr_b16 a[174:175], v8 offset:10560
  s_waitcnt vmcnt(14)
  s_waitcnt lgkmcnt(0)
  s_barrier
  s_xor_b32 s73, s87, 1048576
  s_add_u32 s73, s73, s86
  s_cmp_eq_u32 s88, 2
  s_cselect_b32 s73, s73, 268435456
  buffer_load_dword v31, v30, s[20:23], s73 offen
  s_lshl_b32 s73, s5, 5
  s_add_u32 s73, s73, s63
  s_add_u32 m0, s78, 28672
  s_add_u32 s74, s73, 1024
  buffer_load_dwordx4 v6, s[28:31], s74 offen lds
  s_add_u32 m0, s78, 29696
  s_add_u32 s74, s73, 10240
  buffer_load_dwordx4 v6, s[28:31], s74 offen lds
  s_add_u32 m0, s78, 30720
  s_add_u32 s74, s73, 19456
  buffer_load_dwordx4 v6, s[28:31], s74 offen lds
  s_add_u32 m0, s78, 31744
  s_add_u32 s74, s73, 28672
  buffer_load_dwordx4 v6, s[28:31], s74 offen lds
  ds_read_b64_tr_b16 a[176:177], v8 offset:12288
  ds_read_b64_tr_b16 a[178:179], v8 offset:12544
  ds_read_b64_tr_b16 a[180:181], v8 offset:14336
  ds_read_b64_tr_b16 a[182:183], v8 offset:14592
  ds_read_b64_tr_b16 a[184:185], v8 offset:12352
  ds_read_b64_tr_b16 a[186:187], v8 offset:12608
  ds_read_b64_tr_b16 a[188:189], v8 offset:14400
  ds_read_b64_tr_b16 a[190:191], v8 offset:14656
  s_waitcnt vmcnt(15)
  s_waitcnt lgkmcnt(0)
  s_barrier
  s_xor_b32 s73, s87, 1048576
  s_add_u32 s73, s73, s89
  s_cmp_eq_u32 s90, 38
  s_cselect_b32 s73, s73, 268435456
  buffer_load_dword v31, v30, s[16:19], s73 offen
  s_xor_b32 s73, s59, 0
  s_add_u32 s73, s73, s58
  s_add_u32 m0, s78, 32768
  s_add_u32 s74, s73, 0
  buffer_load_dwordx4 v4, s[16:19], s74 offen lds
  s_add_u32 m0, s78, 33792
  s_add_u32 s74, s73, 32768
  buffer_load_dwordx4 v4, s[16:19], s74 offen lds
  s_add_u32 m0, s78, 34816
  s_add_u32 s74, s73, 131072
  buffer_load_dwordx4 v4, s[16:19], s74 offen lds
  s_add_u32 m0, s78, 35840
  s_add_u32 s74, s73, 163840
  buffer_load_dwordx4 v4, s[16:19], s74 offen lds
  ds_read_b64_tr_b16 a[192:193], v8 offset:16384
  ds_read_b64_tr_b16 a[194:195], v8 offset:16640
  ds_read_b64_tr_b16 a[196:197], v8 offset:18432
  ds_read_b64_tr_b16 a[198:199], v8 offset:18688
  ds_read_b64_tr_b16 a[200:201], v8 offset:16448
  ds_read_b64_tr_b16 a[202:203], v8 offset:16704
  ds_read_b64_tr_b16 a[204:205], v8 offset:18496
  ds_read_b64_tr_b16 a[206:207], v8 offset:18752
  s_waitcnt vmcnt(15)
  s_waitcnt lgkmcnt(0)
  s_barrier
  s_xor_b32 s73, s87, 1572864
  s_add_u32 s73, s73, s86
  s_cmp_eq_u32 s88, 3
  s_cselect_b32 s73, s73, 268435456
  buffer_load_dword v31, v30, s[16:19], s73 offen
  s_xor_b32 s73, s59, 524288
  s_add_u32 s73, s73, s58
  s_add_u32 m0, s78, 36864
  s_add_u32 s74, s73, 0
  buffer_load_dwordx4 v4, s[16:19], s74 offen lds
  s_add_u32 m0, s78, 37888
  s_add_u32 s74, s73, 32768
  buffer_load_dwordx4 v4, s[16:19], s74 offen lds
  s_add_u32 m0, s78, 38912
  s_add_u32 s74, s73, 131072
  buffer_load_dwordx4 v4, s[16:19], s74 offen lds
  s_add_u32 m0, s78, 39936
  s_add_u32 s74, s73, 163840
  buffer_load_dwordx4 v4, s[16:19], s74 offen lds
  ds_read_b64_tr_b16 a[208:209], v8 offset:20480
  ds_read_b64_tr_b16 a[210:211], v8 offset:20736
  ds_read_b64_tr_b16 a[212:213], v8 offset:22528
  ds_read_b64_tr_b16 a[214:215], v8 offset:22784
  ds_read_b64_tr_b16 a[216:217], v8 offset:20544
  ds_read_b64_tr_b16 a[218:219], v8 offset:20800
  ds_read_b64_tr_b16 a[220:221], v8 offset:22592
  ds_read_b64_tr_b16 a[222:223], v8 offset:22848
  s_waitcnt vmcnt(15)
  s_waitcnt lgkmcnt(0)
  s_barrier
  s_xor_b32 s73, s87, 0
  s_add_u32 s73, s73, s89
  s_cmp_eq_u32 s90, 46
  s_cselect_b32 s73, s73, 268435456
  buffer_load_dword v31, v30, s[20:23], s73 offen
  s_xor_b32 s73, s59, 1048576
  s_add_u32 s73, s73, s58
  s_add_u32 m0, s78, 0
  s_add_u32 s74, s73, 0
  buffer_load_dwordx4 v4, s[20:23], s74 offen lds
  s_add_u32 m0, s78, 1024
  s_add_u32 s74, s73, 32768
  buffer_load_dwordx4 v4, s[20:23], s74 offen lds
  s_add_u32 m0, s78, 2048
  s_add_u32 s74, s73, 131072
  buffer_load_dwordx4 v4, s[20:23], s74 offen lds
  s_add_u32 m0, s78, 3072
  s_add_u32 s74, s73, 163840
  buffer_load_dwordx4 v4, s[20:23], s74 offen lds
  ds_read_b64_tr_b16 a[224:225], v8 offset:24576
  ds_read_b64_tr_b16 a[226:227], v8 offset:24832
  ds_read_b64_tr_b16 a[228:229], v8 offset:26624
  ds_read_b64_tr_b16 a[230:231], v8 offset:26880
  ds_read_b64_tr_b16 a[232:233], v8 offset:24640
  ds_read_b64_tr_b16 a[234:235], v8 offset:24896
  ds_read_b64_tr_b16 a[236:237], v8 offset:26688
  ds_read_b64_tr_b16 a[238:239], v8 offset:26944
  s_waitcnt vmcnt(15)
  s_waitcnt lgkmcnt(0)
  s_barrier
  s_add_u32 s73, s86, 4194304
  s_cmp_eq_u32 s88, 6
  s_cselect_b32 s73, s73, 268435456
  buffer_load_dword v31, v30, s[16:19], s73 offen
  s_xor_b32 s73, s59, 1048576
  s_add_u32 s73, s73, s58
  s_add_u32 m0, s78, 4096
  s_add_u32 s74, s73, 0
  buffer_load_dwordx4 v4, s[16:19], s74 offen lds
  s_add_u32 m0, s78, 5120
  s_add_u32 s74, s73, 32768
  buffer_load_dwordx4 v4, s[16:19], s74 offen lds
  s_add_u32 m0, s78, 6144
  s_add_u32 s74, s73, 131072
  buffer_load_dwordx4 v4, s[16:19], s74 offen lds
  s_add_u32 m0, s78, 7168
  s_add_u32 s74, s73, 163840
  buffer_load_dwordx4 v4, s[16:19], s74 offen lds
  ds_read_b64_tr_b16 a[240:241], v7 offset:28672
  ds_read_b64_tr_b16 a[242:243], v7 offset:28928
  ds_read_b64_tr_b16 a[244:245], v7 offset:30720
  ds_read_b64_tr_b16 a[246:247], v7 offset:30976
  ds_read_b64_tr_b16 a[248:249], v7 offset:28704
  ds_read_b64_tr_b16 a[250:251], v7 offset:28960
  ds_read_b64_tr_b16 a[252:253], v7 offset:30752
  ds_read_b64_tr_b16 a[254:255], v7 offset:31008
  s_waitcnt vmcnt(15)
  s_waitcnt lgkmcnt(0)
  s_barrier
  s_xor_b32 s73, s59, 1572864
  s_add_u32 s73, s73, s58
  s_add_u32 m0, s78, 8192
  s_add_u32 s74, s73, 0
  buffer_load_dwordx4 v4, s[16:19], s74 offen lds
  s_add_u32 m0, s78, 9216
  s_add_u32 s74, s73, 32768
  buffer_load_dwordx4 v4, s[16:19], s74 offen lds
  s_add_u32 m0, s78, 10240
  s_add_u32 s74, s73, 131072
  buffer_load_dwordx4 v4, s[16:19], s74 offen lds
  s_add_u32 m0, s78, 11264
  s_add_u32 s74, s73, 163840
  buffer_load_dwordx4 v4, s[16:19], s74 offen lds
  ds_read_b64_tr_b16 v[80:81], v18 offset:32768
  ds_read_b64_tr_b16 v[82:83], v18 offset:33280
  ds_read_b64_tr_b16 v[84:85], v19 offset:32768
  ds_read_b64_tr_b16 v[86:87], v19 offset:33280
  ds_read_b64_tr_b16 v[88:89], v18 offset:32784
  ds_read_b64_tr_b16 v[90:91], v18 offset:33296
  ds_read_b64_tr_b16 v[92:93], v19 offset:32784
  ds_read_b64_tr_b16 v[94:95], v19 offset:33296
  s_waitcnt vmcnt(14)
  s_waitcnt lgkmcnt(0)
  s_barrier
  s_xor_b32 s73, s87, 2097152
  s_add_u32 s73, s73, s86
  s_cmp_eq_u32 s88, 7
  s_cselect_b32 s73, s73, 268435456
  buffer_load_dword v31, v30, s[24:27], s73 offen
  s_xor_b32 s73, s59, 0
  s_add_u32 s73, s73, s58
  s_add_u32 m0, s78, 12288
  s_add_u32 s74, s73, 0
  buffer_load_dwordx4 v4, s[20:23], s74 offen lds
  s_add_u32 m0, s78, 13312
  s_add_u32 s74, s73, 32768
  buffer_load_dwordx4 v4, s[20:23], s74 offen lds
  s_add_u32 m0, s78, 14336
  s_add_u32 s74, s73, 131072
  buffer_load_dwordx4 v4, s[20:23], s74 offen lds
  s_add_u32 m0, s78, 15360
  s_add_u32 s74, s73, 163840
  buffer_load_dwordx4 v4, s[20:23], s74 offen lds
  ds_read_b64_tr_b16 v[96:97], v18 offset:36864
  ds_read_b64_tr_b16 v[98:99], v18 offset:37376
  ds_read_b64_tr_b16 v[100:101], v19 offset:36864
  ds_read_b64_tr_b16 v[102:103], v19 offset:37376
  ds_read_b64_tr_b16 v[104:105], v18 offset:36880
  ds_read_b64_tr_b16 v[106:107], v18 offset:37392
  ds_read_b64_tr_b16 v[108:109], v19 offset:36880
  ds_read_b64_tr_b16 v[110:111], v19 offset:37392
  s_waitcnt vmcnt(14)
  s_waitcnt lgkmcnt(0)
  s_barrier
  s_xor_b32 s73, s87, 3145728
  s_add_u32 s73, s73, s89
  s_cmp_eq_u32 s90, 54
  s_cselect_b32 s73, s73, 268435456
  buffer_load_dword v31, v30, s[24:27], s73 offen
  s_add_u32 s73, s58, 4194304
  s_add_u32 m0, s78, 16384
  s_add_u32 s74, s73, 0
  buffer_load_dwordx4 v4, s[16:19], s74 offen lds
  s_add_u32 m0, s78, 17408
  s_add_u32 s74, s73, 32768
  buffer_load_dwordx4 v4, s[16:19], s74 offen lds
  s_add_u32 m0, s78, 18432
  s_add_u32 s74, s73, 131072
  buffer_load_dwordx4 v4, s[16:19], s74 offen lds
  s_add_u32 m0, s78, 19456
  s_add_u32 s74, s73, 163840
  buffer_load_dwordx4 v4, s[16:19], s74 offen lds
  ds_read_b64_tr_b16 v[176:177], v18 offset:0
  ds_read_b64_tr_b16 v[178:179], v18 offset:512
  ds_read_b64_tr_b16 v[180:181], v19 offset:0
  ds_read_b64_tr_b16 v[182:183], v19 offset:512
  ds_read_b64_tr_b16 v[184:185], v18 offset:16
  ds_read_b64_tr_b16 v[186:187], v18 offset:528
  ds_read_b64_tr_b16 v[188:189], v19 offset:16
  ds_read_b64_tr_b16 v[190:191], v19 offset:528
  s_waitcnt vmcnt(14)
  s_waitcnt lgkmcnt(0)
  s_barrier
  s_xor_b32 s73, s87, 2621440
  s_add_u32 s73, s73, s86
  s_cmp_eq_u32 s88, 5
  s_cselect_b32 s73, s73, 268435456
  buffer_load_dword v31, v30, s[24:27], s73 offen
  s_add_u32 s73, s58, 4194304
  s_add_u32 m0, s78, 20480
  s_add_u32 s74, s73, 0
  buffer_load_dwordx4 v4, s[20:23], s74 offen lds
  s_add_u32 m0, s78, 21504
  s_add_u32 s74, s73, 32768
  buffer_load_dwordx4 v4, s[20:23], s74 offen lds
  s_add_u32 m0, s78, 22528
  s_add_u32 s74, s73, 131072
  buffer_load_dwordx4 v4, s[20:23], s74 offen lds
  s_add_u32 m0, s78, 23552
  s_add_u32 s74, s73, 163840
  buffer_load_dwordx4 v4, s[20:23], s74 offen lds
  buffer_load_dword v26, off, s[48:51], 0 offset:64 sc1
  buffer_load_dword v27, off, s[48:51], 0 offset:0 sc1
  ds_read_b64_tr_b16 v[32:33], v18 offset:4096
  ds_read_b64_tr_b16 v[34:35], v18 offset:4608
  ds_read_b64_tr_b16 v[36:37], v19 offset:4096
  ds_read_b64_tr_b16 v[38:39], v19 offset:4608
  ds_read_b64_tr_b16 v[40:41], v18 offset:4112
  ds_read_b64_tr_b16 v[42:43], v18 offset:4624
  ds_read_b64_tr_b16 v[44:45], v19 offset:4112
  ds_read_b64_tr_b16 v[46:47], v19 offset:4624
  s_waitcnt vmcnt(17)
  s_waitcnt lgkmcnt(0)
  s_barrier
  s_xor_b32 s73, s59, 2097152
  s_add_u32 s73, s73, s58
  s_add_u32 m0, s78, 24576
  s_add_u32 s74, s73, 0
  buffer_load_dwordx4 v4, s[24:27], s74 offen lds
  s_add_u32 m0, s78, 25600
  s_add_u32 s74, s73, 32768
  buffer_load_dwordx4 v4, s[24:27], s74 offen lds
  s_add_u32 m0, s78, 26624
  s_add_u32 s74, s73, 131072
  buffer_load_dwordx4 v4, s[24:27], s74 offen lds
  s_add_u32 m0, s78, 27648
  s_add_u32 s74, s73, 163840
  buffer_load_dwordx4 v4, s[24:27], s74 offen lds
  ds_write_b128 v0, v[32:35] offset:4096
  ds_write_b128 v0, v[36:39] offset:5120
  ds_write_b128 v0, v[40:43] offset:6144
  ds_write_b128 v0, v[44:47] offset:7168
  ds_read_b64_tr_b16 v[48:49], v18 offset:8192
  ds_read_b64_tr_b16 v[50:51], v18 offset:8704
  ds_read_b64_tr_b16 v[52:53], v19 offset:8192
  ds_read_b64_tr_b16 v[54:55], v19 offset:8704
  ds_read_b64_tr_b16 v[56:57], v18 offset:8208
  ds_read_b64_tr_b16 v[58:59], v18 offset:8720
  ds_read_b64_tr_b16 v[60:61], v19 offset:8208
  ds_read_b64_tr_b16 v[62:63], v19 offset:8720
  s_waitcnt vmcnt(16)
  s_waitcnt lgkmcnt(0)
  s_barrier
  s_xor_b32 s73, s59, 3145728
  s_add_u32 s73, s73, s58
  s_add_u32 m0, s78, 28672
  s_add_u32 s74, s73, 0
  buffer_load_dwordx4 v4, s[24:27], s74 offen lds
  s_add_u32 m0, s78, 29696
  s_add_u32 s74, s73, 32768
  buffer_load_dwordx4 v4, s[24:27], s74 offen lds
  s_add_u32 m0, s78, 30720
  s_add_u32 s74, s73, 131072
  buffer_load_dwordx4 v4, s[24:27], s74 offen lds
  s_add_u32 m0, s78, 31744
  s_add_u32 s74, s73, 163840
  buffer_load_dwordx4 v4, s[24:27], s74 offen lds
  ds_write_b128 v0, v[48:51] offset:8192
  ds_write_b128 v0, v[52:55] offset:9216
  ds_write_b128 v0, v[56:59] offset:10240
  ds_write_b128 v0, v[60:63] offset:11264
  ds_read_b64_tr_b16 v[64:65], v18 offset:12288
  ds_read_b64_tr_b16 v[66:67], v18 offset:12800
  ds_read_b64_tr_b16 v[68:69], v19 offset:12288
  ds_read_b64_tr_b16 v[70:71], v19 offset:12800
  ds_read_b64_tr_b16 v[72:73], v18 offset:12304
  ds_read_b64_tr_b16 v[74:75], v18 offset:12816
  ds_read_b64_tr_b16 v[76:77], v19 offset:12304
  ds_read_b64_tr_b16 v[78:79], v19 offset:12816
  s_waitcnt vmcnt(15)
  s_waitcnt lgkmcnt(0)
  s_barrier
  s_xor_b32 s73, s59, 2621440
  s_add_u32 s73, s73, s58
  s_add_u32 m0, s78, 32768
  s_add_u32 s74, s73, 0
  buffer_load_dwordx4 v4, s[24:27], s74 offen lds
  s_add_u32 m0, s78, 33792
  s_add_u32 s74, s73, 32768
  buffer_load_dwordx4 v4, s[24:27], s74 offen lds
  s_add_u32 m0, s78, 34816
  s_add_u32 s74, s73, 131072
  buffer_load_dwordx4 v4, s[24:27], s74 offen lds
  s_add_u32 m0, s78, 35840
  s_add_u32 s74, s73, 163840
  buffer_load_dwordx4 v4, s[24:27], s74 offen lds
  ds_write_b128 v0, v[64:67] offset:12288
  ds_write_b128 v0, v[68:71] offset:13312
  ds_write_b128 v0, v[72:75] offset:14336
  ds_write_b128 v0, v[76:79] offset:15360
  ds_read_b64_tr_b16 v[32:33], v18 offset:16384
  ds_read_b64_tr_b16 v[34:35], v18 offset:16896
  ds_read_b64_tr_b16 v[36:37], v19 offset:16384
  ds_read_b64_tr_b16 v[38:39], v19 offset:16896
  ds_read_b64_tr_b16 v[40:41], v18 offset:16400
  ds_read_b64_tr_b16 v[42:43], v18 offset:16912
  ds_read_b64_tr_b16 v[44:45], v19 offset:16400
  ds_read_b64_tr_b16 v[46:47], v19 offset:16912
  s_waitcnt vmcnt(14)
  s_waitcnt lgkmcnt(0)
  s_barrier
  s_xor_b32 s73, s59, 3670016
  s_add_u32 s73, s73, s58
  s_add_u32 m0, s78, 36864
  s_add_u32 s74, s73, 0
  buffer_load_dwordx4 v4, s[24:27], s74 offen lds
  s_add_u32 m0, s78, 37888
  s_add_u32 s74, s73, 32768
  buffer_load_dwordx4 v4, s[24:27], s74 offen lds
  s_add_u32 m0, s78, 38912
  s_add_u32 s74, s73, 131072
  buffer_load_dwordx4 v4, s[24:27], s74 offen lds
  s_add_u32 m0, s78, 39936
  s_add_u32 s74, s73, 163840
  buffer_load_dwordx4 v4, s[24:27], s74 offen lds
  v_and_b32 v23, 7, v22
  v_mul_u32_u24 v23, 1152, v23
  v_lshrrev_b32 v24, 3, v22
  v_lshl_add_u32 v23, v24, 4, v23
  s_lshl_b32 s73, s5, 8
  buffer_load_dwordx4 v[4:7], v23, s[12:15], s73 offen
  buffer_load_dwordx4 v[8:11], v23, s[12:15], s73 offen offset:128
  buffer_load_dwordx4 v[12:15], v23, s[12:15], 0 offen offset:1024
  s_waitcnt vmcnt(19)
  v_readfirstlane_b32 s6, v26
  v_readfirstlane_b32 s79, v27
  s_cmp_ge_u32 s6, 32
  s_cselect_b32 s73, s70, 268435456
  buffer_load_dwordx2 v[28:29], off, s[52:55], s73 sc1
  ds_write_b128 v0, v[32:35] offset:16384
  ds_write_b128 v0, v[36:39] offset:17408
  ds_write_b128 v0, v[40:43] offset:18432
  ds_write_b128 v0, v[44:47] offset:19456
  ds_read_b64_tr_b16 v[48:49], v18 offset:20480
  ds_read_b64_tr_b16 v[50:51], v18 offset:20992
  ds_read_b64_tr_b16 v[52:53], v19 offset:20480
  ds_read_b64_tr_b16 v[54:55], v19 offset:20992
  ds_read_b64_tr_b16 v[56:57], v18 offset:20496
  ds_read_b64_tr_b16 v[58:59], v18 offset:21008
  ds_read_b64_tr_b16 v[60:61], v19 offset:20496
  ds_read_b64_tr_b16 v[62:63], v19 offset:21008
  s_waitcnt vmcnt(16)
  s_waitcnt lgkmcnt(0)
  s_barrier
  ds_write_b128 v0, v[48:51] offset:20480
  ds_write_b128 v0, v[52:55] offset:21504
  ds_write_b128 v0, v[56:59] offset:22528
  ds_write_b128 v0, v[60:63] offset:23552
  ds_read_b64_tr_b16 v[64:65], v20 offset:24576
  ds_read_b64_tr_b16 v[66:67], v20 offset:25088
  ds_read_b64_tr_b16 v[68:69], v21 offset:24576
  ds_read_b64_tr_b16 v[70:71], v21 offset:25088
  ds_read_b64_tr_b16 v[72:73], v20 offset:24584
  ds_read_b64_tr_b16 v[74:75], v20 offset:25096
  ds_read_b64_tr_b16 v[76:77], v21 offset:24584
  ds_read_b64_tr_b16 v[78:79], v21 offset:25096
  s_waitcnt vmcnt(12)
  s_waitcnt lgkmcnt(0)
  s_barrier
  ds_read_b64_tr_b16 v[32:33], v20 offset:28672
  ds_read_b64_tr_b16 v[34:35], v20 offset:29184
  ds_read_b64_tr_b16 v[36:37], v21 offset:28672
  ds_read_b64_tr_b16 v[38:39], v21 offset:29184
  ds_read_b64_tr_b16 v[40:41], v20 offset:28680
  ds_read_b64_tr_b16 v[42:43], v20 offset:29192
  ds_read_b64_tr_b16 v[44:45], v21 offset:28680
  ds_read_b64_tr_b16 v[46:47], v21 offset:29192
  s_waitcnt vmcnt(8)
  s_waitcnt lgkmcnt(0)
  s_barrier
  ds_write_b128 v0, v[64:67] offset:28672
  ds_write_b128 v0, v[68:71] offset:29696
  ds_write_b128 v0, v[72:75] offset:30720
  ds_write_b128 v0, v[76:79] offset:31744
  ds_write_b128 v0, v[32:35] offset:24576
  ds_write_b128 v0, v[36:39] offset:25600
  ds_write_b128 v0, v[40:43] offset:26624
  ds_write_b128 v0, v[44:47] offset:27648
  ds_read_b64_tr_b16 v[48:49], v20 offset:32768
  ds_read_b64_tr_b16 v[50:51], v20 offset:33280
  ds_read_b64_tr_b16 v[52:53], v21 offset:32768
  ds_read_b64_tr_b16 v[54:55], v21 offset:33280
  ds_read_b64_tr_b16 v[56:57], v20 offset:32776
  ds_read_b64_tr_b16 v[58:59], v20 offset:33288
  ds_read_b64_tr_b16 v[60:61], v21 offset:32776
  ds_read_b64_tr_b16 v[62:63], v21 offset:33288
  s_waitcnt vmcnt(4)
  s_waitcnt lgkmcnt(0)
  s_barrier
  ds_read_b64_tr_b16 v[64:65], v20 offset:36864
  ds_read_b64_tr_b16 v[66:67], v20 offset:37376
  ds_read_b64_tr_b16 v[68:69], v21 offset:36864
  ds_read_b64_tr_b16 v[70:71], v21 offset:37376
  ds_read_b64_tr_b16 v[72:73], v20 offset:36872
  ds_read_b64_tr_b16 v[74:75], v20 offset:37384
  ds_read_b64_tr_b16 v[76:77], v21 offset:36872
  ds_read_b64_tr_b16 v[78:79], v21 offset:37384
  s_waitcnt lgkmcnt(0)
  s_barrier
  ds_write_b128 v0, v[48:51] offset:36864
  ds_write_b128 v0, v[52:55] offset:37888
  ds_write_b128 v0, v[56:59] offset:38912
  ds_write_b128 v0, v[60:63] offset:39936
  ds_write_b128 v0, v[64:67] offset:32768
  ds_write_b128 v0, v[68:71] offset:33792
  ds_write_b128 v0, v[72:75] offset:34816
  ds_write_b128 v0, v[76:79] offset:35840
WDONE_56:
  s_waitcnt lgkmcnt(0)
  ds_read_b128 v[56:59], v0 offset:4096
  ds_read_b128 v[60:63], v0 offset:5120
  ds_read_b128 v[64:67], v0 offset:6144
  ds_read_b128 v[68:71], v0 offset:7168
  s_xor_b32 s67, s67, 524288
  s_xor_b32 s68, s68, 524288
  s_waitcnt vmcnt(0)
  v_min_u32 v28, v28, v29
  s_nop 0
  v_readfirstlane_b32 s71, v28
  ds_read_b128 v[16:19], v0 offset:8192
  ds_read_b128 v[20:23], v0 offset:9216
  ds_read_b128 v[24:27], v0 offset:10240
  ds_read_b128 v[28:31], v0 offset:11264
  ds_read_b128 v[32:35], v0 offset:16384
  ds_read_b128 v[36:39], v0 offset:17408
  ds_read_b128 v[72:75], v0 offset:18432
  ds_read_b128 v[76:79], v0 offset:19456
  s_cmp_ge_u32 s6, 32
  s_cbranch_scc1 CIN_57
  s_mov_b32 s73, 1048576
POLLD_58:
  buffer_load_dword v44, off, s[48:51], 0 offset:64 sc1
  s_waitcnt vmcnt(0)
  v_readfirstlane_b32 s74, v44
  s_sub_u32 s73, s73, 1
  s_cbranch_scc1 POLLE_59
  s_cmp_lt_u32 s74, 32
  s_cbranch_scc1 POLLD_58
POLLE_59:
CIN_57:
  s_add_u32 s73, s57, 1
  s_min_u32 s73, s73, 64
FP_61:
  s_cmp_ge_u32 s71, s73
  s_cbranch_scc1 FOK_60
  buffer_load_dwordx2 v[44:45], off, s[52:55], s70 sc1
  s_waitcnt vmcnt(0)
  v_min_u32 v44, v44, v45
  s_nop 0
  v_readfirstlane_b32 s71, v44
  s_sub_i32 s72, s72, 1
  s_cmp_ge_i32 s72, 0
  s_cbranch_scc1 FP_61
FOK_60:
  s_add_u32 m0, s78, 1024
  s_mul_i32 s95, s5, -284672
  s_lshr_b32 s73, s5, 1
  s_mul_i32 s73, s73, 16769024
  s_add_u32 s95, s95, s73
  s_sub_u32 s95, s95, 2176
  s_waitcnt vmcnt(0) lgkmcnt(0)
  s_add_u32 s94, s65, s95
  s_add_u32 s94, s94, 0
  s_add_u32 s73, s57, 1
  s_cmp_ge_u32 s71, s73
  s_cselect_b32 s94, s94, 268435456
  v_lshlrev_b32 v54, 3, v0
  s_mov_b32 exec_hi, 0
  buffer_load_dword v54, s[52:55], s94 offen offset:2176 sc1 lds
  s_mov_b64 exec, -1
  s_add_u32 s94, s65, s95
  s_add_u32 s94, s94, 262144
  s_add_u32 s73, s57, 2
  s_cmp_ge_u32 s71, s73
  s_cselect_b32 s94, s94, 268435456
  s_xor_b32 s73, s92, 524288
  s_add_u32 s73, s73, s64
  s_sub_u32 s74, s73, 65536
  s_andn2_b32 s74, s74, 768
  s_sub_u32 s77, s70, 2432
  s_cmp_ge_u32 s71, 64
  s_cselect_b32 s77, 268435456, s77
  v_mov_b64 v[40:41], 0
  v_mov_b64 v[42:43], 0
  v_mov_b64 v[44:45], 0
  v_mov_b64 v[46:47], 0
  v_mov_b64 v[48:49], 0
  v_mov_b64 v[50:51], 0
  v_mov_b64 v[52:53], 0
  s_and_b32 s58, s5, 2
  s_lshl_b32 s58, s58, 1
  s_add_u32 s58, s58, s5
  s_lshl_b32 s58, s58, 10
  s_add_u32 s58, s58, s64
  s_add_u32 s58, s58, 109051904
  s_mul_i32 s59, s5, -9728
  s_add_u32 s59, s59, 109056000
  s_mul_i32 s90, s5, 30720
  s_mov_b32 s88, 0x3f80
  s_mov_b32 s89, 0
  s_barrier
  s_mov_b32 s96, 0xaaaaaaaa
  s_mov_b32 s97, 0xaaaaaaaa
  s_lshl_b32 s63, s5, 8
  v_subrev_u32 v54, s63, v0
  s_lshl_b32 s63, s5, 4
  s_lshl_b64 exec, 0xffff, s63
  ds_write_b128 v54, v[12:15] offset:3584
  s_mov_b64 exec, -1
  ds_write_b128 v0, v[4:7]
  ds_write_b128 v0, v[8:11] offset:1024
  s_waitcnt lgkmcnt(2)
  v_mov_b64 v[54:55], 0
  v_bfe_u32 v15, v0, 8, 2
  v_mul_u32_u24 v15, 40960, v15
  v_and_b32 v13, 0xf0, v0
  v_add_u32 v13, v13, v15
  s_mov_b32 s78, -120
  s_cmp_lt_u32 s79, 32
  s_cbranch_scc1 CSLOW_63
  v_smfmac_f32_16x16x64_bf16 v[40:43], v[4:7], v[56:63], v1
  v_smfmac_f32_16x16x64_bf16 v[44:47], v[4:7], v[64:71], v1
  s_branch CGO_65
MP_66:
  s_waitcnt vmcnt(4) lgkmcnt(0)
  v_max3_u32 v15, v12, v4, v5
  v_max3_u32 v15, v6, v7, v15
  ds_write_b128 v0, v[4:7]
  v_cmp_eq_u32 vcc, -1, v15
  ds_write_b32 v14, v12 offset:3584
  s_cbranch_vccnz MR_67
ME_70:
  s_mov_b64 exec, -1
  v_smfmac_f32_16x16x64_bf16 v[40:43], v[4:7], v[56:63], v1
  v_mov_b32 v51, 0
  v_smfmac_f32_16x16x64_bf16 v[44:47], v[4:7], v[64:71], v1
  s_waitcnt vmcnt(3)
MQ_68:
  v_max3_u32 v15, v8, v9, v10
  v_max_u32 v15, v11, v15
  ds_write_b128 v0, v[8:11] offset:1024
  v_cmp_eq_u32 vcc, -1, v15
  s_cbranch_vccnz MS_69
CGO_65:
  s_mov_b64 exec, -1
  v_smfmac_f32_16x16x64_bf16 v[40:43], v[8:11], v[16:23], v1
  v_smfmac_f32_16x16x64_bf16 v[44:47], v[8:11], v[24:31], v1
  v_add_u32 v20, s60, v0
  v_smfmac_f32_16x16x64_bf16 v[52:55], v[4:7], v[184:191], v1
  ds_read_b128 v[64:67], v0 offset:22528
  ds_read_b128 v[68:71], v0 offset:23552
  v_add_u32 v28, s61, v0
  s_waitcnt lgkmcnt(2)
  s_barrier
  s_waitcnt vmcnt(0)
  ds_read_b128 v[12:15], v13 offset:3584
  ds_read_b128 v[16:19], v20
  v_smfmac_f32_16x16x64_bf16 v[48:51], v[4:7], v[176:183], v1
  ds_read_b128 v[56:59], v0 offset:20480
  ds_read_b128 v[60:63], v0 offset:21504
  ds_read_b128 v[20:23], v20 offset:1024
  v_smfmac_f32_16x16x64_bf16 v[52:55], v[8:11], v[200:207], v1
  ds_read_b128 v[24:27], v28
  v_smfmac_f32_16x16x64_bf16 v[48:51], v[8:11], v[192:199], v1
  s_waitcnt lgkmcnt(5)
  v_smfmac_f32_16x16x64_bf16 v[44:47], v[12:15], v[72:79], v1
  buffer_load_dwordx4 v[72:75], v0, s[52:55], s65 offen sc1
  v_smfmac_f32_16x16x64_bf16 v[40:43], v[12:15], v[32:39], v1
  ds_read_b128 v[28:31], v28 offset:1024
  v_add_u32 v36, s62, v0
  s_waitcnt lgkmcnt(3)
  v_smfmac_f32_16x16x64_bf16 v[48:51], v[12:15], v[56:63], v1
  ds_read_b128 v[32:35], v36
  buffer_load_dwordx4 v[76:79], v0, s[52:55], s65 offen offset:1024 sc1
  v_smfmac_f32_16x16x64_bf16 v[52:55], v[12:15], v[64:71], v1
  ds_read_b128 v[36:39], v36 offset:1024
  v_lshlrev_b32 v57, 3, v0
  v_smfmac_f32_16x16x64_bf16 v[40:43], v[16:19], v[80:87], v1
  ds_read_b128 v[64:67], v0 offset:14336
  v_smfmac_f32_16x16x64_bf16 v[44:47], v[16:19], v[88:95], v1
  ds_read_b128 v[68:71], v0 offset:15360
  s_waitcnt lgkmcnt(6)
  v_smfmac_f32_16x16x64_bf16 v[40:43], v[20:23], v[96:103], v1
  v_smfmac_f32_16x16x64_bf16 v[44:47], v[20:23], v[104:111], v1
  s_mov_b64 exec, 0xffff
  buffer_load_dword v57, s[52:55], s94 offen offset:2176 sc1 lds
  s_mov_b64 exec, 1
  s_waitcnt lgkmcnt(5)
  v_smfmac_f32_16x16x64_bf16 v[40:43], v[24:27], v[112:119], v1
  buffer_load_dwordx4 off, s[52:55], s77 offset:2432 sc1 lds
  s_mov_b64 exec, -1
  v_smfmac_f32_16x16x64_bf16 v[44:47], v[24:27], v[120:127], v1
  v_mov_b32 v58, s57
  s_waitcnt lgkmcnt(4)
  v_smfmac_f32_16x16x64_bf16 v[40:43], v[28:31], v[128:135], v1
  buffer_store_dword v58, off, s[52:55], s93 offset:8 sc1
  v_smfmac_f32_16x16x64_bf16 v[44:47], v[28:31], v[136:143], v1
  ds_read_b128 v[56:59], v0 offset:12288
  s_waitcnt lgkmcnt(4)
  v_smfmac_f32_16x16x64_bf16 v[40:43], v[32:35], v[144:151], v1
  ds_read_b128 v[60:63], v0 offset:13312
  v_smfmac_f32_16x16x64_bf16 v[44:47], v[32:35], v[152:159], v1
  s_waitcnt lgkmcnt(4)
  v_smfmac_f32_16x16x64_bf16 v[40:43], v[36:39], v[160:167], v1
  v_smfmac_f32_16x16x64_bf16 v[44:47], v[36:39], v[168:175], v1
  s_waitcnt lgkmcnt(0)
  v_smfmac_f32_16x16x64_bf16 v[48:51], v[16:19], v[56:63], v1
  v_cvt_pk_bf16_f32 v40, v40, v41
  v_cvt_pk_bf16_f32 v41, v42, v43
  v_smfmac_f32_16x16x64_bf16 v[52:55], v[16:19], v[64:71], v1
  v_cvt_pk_bf16_f32 v44, v44, v45
  v_cvt_pk_bf16_f32 v45, v46, v47
  v_mfma_f32_16x16x16_bf16 v[40:43], v[40:41], v[2:3], 0
  v_and_b32 v56, 0x3ff, v0
  v_mfma_f32_16x16x16_bf16 v[44:47], v[44:45], v[2:3], 0
  v_add_u32 v64, 81920, v56
  v_smfmac_f32_16x16x64_bf16 v[48:51], v[20:23], v[208:215], v1
  v_cvt_pk_bf16_f32 v40, v40, v41
  v_cvt_pk_bf16_f32 v41, v42, v43
  v_smfmac_f32_16x16x64_bf16 v[48:51], v[24:27], v[224:231], v1
  v_cvt_pk_bf16_f32 v42, v44, v45
  v_cvt_pk_bf16_f32 v43, v46, v47
  v_smfmac_f32_16x16x64_bf16 v[48:51], v[28:31], v[240:247], v1
  v_mov_b64 v[44:45], 0
  s_waitcnt vmcnt(4)
  v_mfma_f32_16x16x32_bf16 v[72:75], v[72:75], v[40:43], 0
  v_mov_b64 v[46:47], 0
  s_waitcnt vmcnt(3)
  v_mfma_f32_16x16x32_bf16 v[76:79], v[76:79], v[40:43], 0
  v_smfmac_f32_16x16x64_bf16 v[48:51], v[32:35], a[0:7], v1
  v_smfmac_f32_16x16x64_bf16 v[48:51], v[36:39], a[16:23], v1
  v_cndmask_b32 v72, v72, v76, s[80:81]
  v_cndmask_b32 v73, v73, v77, s[80:81]
  v_smfmac_f32_16x16x64_bf16 v[52:55], v[20:23], v[216:223], v1
  v_cndmask_b32 v74, v74, v78, s[80:81]
  v_cndmask_b32 v75, v75, v79, s[80:81]
  v_smfmac_f32_16x16x64_bf16 v[52:55], v[24:27], v[232:239], v1
  ds_write_b128 v0, v[72:75] offset:2048
  v_cvt_pk_bf16_f32 v48, v48, v49
  v_smfmac_f32_16x16x64_bf16 v[52:55], v[28:31], v[248:255], v1
  v_cvt_pk_bf16_f32 v49, v50, v51
  v_mov_b64 v[76:77], -1
  v_smfmac_f32_16x16x64_bf16 v[52:55], v[32:35], a[8:15], v1
  v_mov_b64 v[78:79], -1
  v_mfma_f32_16x16x16_bf16 v[48:51], v[48:49], v[2:3], 0
  buffer_store_dwordx4 v[76:79], v0, s[52:55], s74 offen
  s_add_u32 s74, s74, 32768
  v_smfmac_f32_16x16x64_bf16 v[52:55], v[36:39], a[24:31], v1
  v_smfmac_f32_16x16x64_bf16 v[44:47], v[4:7], a[32:39], v1
  v_cvt_pk_bf16_f32 v48, v48, v49
  s_waitcnt lgkmcnt(0)
  s_barrier
  ds_read_b128 v[60:63], v56 offset:43008
  v_cvt_pk_bf16_f32 v52, v52, v53
  v_cvt_pk_bf16_f32 v53, v54, v55
  ds_read_b128 v[56:59], v56 offset:2048
  ds_read_b128 v[68:71], v64 offset:43008
  v_mfma_f32_16x16x16_bf16 v[52:55], v[52:53], v[2:3], 0
  ds_read_b128 v[64:67], v64 offset:2048
  v_cvt_pk_bf16_f32 v49, v50, v51
  buffer_store_dwordx4 v[76:79], v0, s[52:55], s74 offen
  v_smfmac_f32_16x16x64_bf16 v[44:47], v[8:11], a[48:55], v1
  buffer_load_dwordx4 v[72:75], v0, s[52:55], s7 offen sc1
  v_smfmac_f32_16x16x64_bf16 v[44:47], v[12:15], a[64:71], v1
  v_cvt_pk_bf16_f32 v50, v52, v53
  v_cvt_pk_bf16_f32 v51, v54, v55
  s_mov_b64 exec, 0xffff
  buffer_store_dwordx4 v[76:79], v0, s[52:55], s73 offen
  s_mov_b64 exec, -1
  v_mfma_f32_16x16x32_bf16 v[40:43], v[48:51], v[40:43], 0
  v_mov_b64 v[76:77], 0
  v_mov_b64 v[78:79], 0
  v_smfmac_f32_16x16x64_bf16 v[44:47], v[16:19], a[80:87], v1
  s_waitcnt lgkmcnt(2)
  v_add_f32 v56, v56, v60
  v_add_f32 v57, v57, v61
  v_smfmac_f32_16x16x64_bf16 v[76:79], v[4:7], a[40:47], v1
  ds_write_b128 v0, v[40:43] offset:3072
  v_add_f32 v58, v58, v62
  v_add_f32 v59, v59, v63
  v_smfmac_f32_16x16x64_bf16 v[76:79], v[8:11], a[56:63], v1
  buffer_load_dwordx4 v[52:55], v0, s[52:55], s7 offen offset:1024 sc1
  s_waitcnt lgkmcnt(1)
  v_add_f32 v64, v64, v68
  v_add_f32 v65, v65, v69
  ds_read_b128 v[4:7], v0 offset:26624
  ds_read_b128 v[8:11], v0 offset:27648
  v_add_f32 v66, v66, v70
  v_add_f32 v67, v67, v71
  v_smfmac_f32_16x16x64_bf16 v[76:79], v[12:15], a[72:79], v1
  v_add_f32 v56, v56, v64
  v_add_f32 v57, v57, v65
  v_lshlrev_b32 v60, 3, v0
  v_smfmac_f32_16x16x64_bf16 v[76:79], v[16:19], a[88:95], v1
  s_mov_b64 exec, 0xffff0000
  buffer_load_dword v60, s[52:55], s94 offen offset:2176 sc1 lds
  s_mov_b64 exec, -1
  v_add_f32 v58, v58, v66
  v_add_f32 v59, v59, v67
  ds_read_b128 v[64:67], v0 offset:24576
  ds_read_b128 v[68:71], v0 offset:25600
  v_smfmac_f32_16x16x64_bf16 v[44:47], v[20:23], a[96:103], v1
  v_bfe_u32 v62, v0, 7, 1
  v_and_b32 v63, 0x3ff, v0
  v_smfmac_f32_16x16x64_bf16 v[76:79], v[20:23], a[104:111], v1
  v_mad_i32_i24 v63, v62, s78, v63
  ds_read_b128 v[12:15], v0 offset:32768
  ds_read_b128 v[16:19], v0 offset:33792
  s_waitcnt lgkmcnt(6)
  s_barrier
  ds_read2st64_b64 v[40:43], v63 offset0:6 offset1:86
  ds_read2st64_b64 v[20:23], v63 offset0:166 offset1:246
  s_waitcnt lgkmcnt(6)
  v_smfmac_f32_16x16x64_bf16 v[76:79], v[24:27], v[4:11], v1
  buffer_store_dwordx4 v[48:51], v0, s[52:55], s100 offen sc1
  s_waitcnt lgkmcnt(4)
  v_smfmac_f32_16x16x64_bf16 v[44:47], v[24:27], v[64:71], v1
  ds_read_b128 v[4:7], v0 offset:28672
  v_max3_f32 v62, v56, v57, v58
  s_waitcnt lgkmcnt(3)
  v_smfmac_f32_16x16x64_bf16 v[44:47], v[28:31], v[12:19], v1
  ds_read_b128 v[64:67], v0 offset:34816
  ds_read_b128 v[68:71], v0 offset:35840
  s_waitcnt lgkmcnt(4)
  v_add_f32 v60, v40, v42
  v_add_f32 v61, v41, v43
  v_max_f32 v62, v62, v59
  s_waitcnt lgkmcnt(3)
  v_add_f32 v60, v60, v20
  v_add_f32 v61, v61, v21
  ds_read_b128 v[8:11], v0 offset:29696
  v_add_f32 v60, v60, v22
  v_add_f32 v61, v61, v23
  v_max3_f32 v62, v60, v61, v62
  ds_read_b128 v[12:15], v0 offset:30720
  ds_read_b128 v[16:19], v0 offset:31744
  v_max_f32_dpp v62, v62, v62 row_ror:8 row_mask:0xf bank_mask:0xf
  v_mov_b32 v63, v62
  s_waitcnt lgkmcnt(3)
  v_smfmac_f32_16x16x64_bf16 v[76:79], v[28:31], v[64:71], v1
  v_permlane16_swap_b32 v62, v63
  v_max_f32 v62, v62, v63
  v_mov_b32 v63, v62
  ds_read_b128 v[64:67], v0 offset:36864
  ds_read_b128 v[68:71], v0 offset:37888
  v_permlane32_swap_b32 v62, v63
  v_max_f32 v62, v62, v63
  s_waitcnt lgkmcnt(4)
  v_smfmac_f32_16x16x64_bf16 v[44:47], v[32:35], v[4:11], v1
  v_mul_f32 v62, s76, v62
  ds_read_b128 v[4:7], v0 offset:38912
  ds_read_b128 v[8:11], v0 offset:39936
  v_fma_f32 v56, v56, s76, -v62
  v_fma_f32 v57, v57, s76, -v62
  v_fma_f32 v58, v58, s76, -v62
  v_fma_f32 v59, v59, s76, -v62
  v_fma_f32 v60, v60, s76, -v62
  v_fma_f32 v61, v61, s76, -v62
  s_waitcnt lgkmcnt(4)
  v_smfmac_f32_16x16x64_bf16 v[76:79], v[32:35], v[12:19], v1
  v_exp_f32 v56, v56
  v_exp_f32 v57, v57
  v_exp_f32 v58, v58
  s_waitcnt lgkmcnt(2)
  v_smfmac_f32_16x16x64_bf16 v[44:47], v[36:39], v[64:71], v1
  v_exp_f32 v59, v59
  s_waitcnt lgkmcnt(0)
  v_smfmac_f32_16x16x64_bf16 v[76:79], v[36:39], v[4:11], v1
  v_exp_f32 v60, v60
  v_exp_f32 v61, v61
  v_cvt_pk_bf16_f32 v56, v56, v57
  v_cvt_pk_bf16_f32 v57, v58, v59
  v_mov_b64 v[20:21], s[82:83]
  v_mov_b64 v[22:23], s[82:83]
  v_cvt_pk_bf16_f32 v60, v60, v61
  v_mov_b32_dpp v58, v56 row_ror:8 row_mask:0xf bank_mask:0xf
  v_mov_b32_dpp v59, v57 row_ror:8 row_mask:0xf bank_mask:0xf
  v_mov_b32_dpp v61, v60 row_ror:8 row_mask:0xf bank_mask:0xf
  v_mov_b64 v[40:41], s[84:85]
  v_mfma_f32_16x16x32_bf16 v[36:39], v[20:23], v[56:59], 0
  v_cvt_pk_bf16_f32 v44, v44, v45
  v_cvt_pk_bf16_f32 v45, v46, v47
  s_waitcnt vmcnt(4)
  v_mfma_f32_16x16x32_bf16 v[72:75], v[72:75], v[56:59], 0
  v_cvt_pk_bf16_f32 v46, v76, v77
  v_cvt_pk_bf16_f32 v47, v78, v79
  s_waitcnt vmcnt(2)
  v_mfma_f32_16x16x32_bf16 v[52:55], v[52:55], v[56:59], 0
  v_and_b32 v8, 0xffffff7f, v0
  v_mfma_f32_16x16x16_bf16 v[36:39], v[40:41], v[60:61], v[36:39]
  v_add_u32 v64, s62, v8
  v_mov_b64 v[16:17], 0
  v_mfma_f32_16x16x16_bf16 v[72:75], v[44:45], v[60:61], v[72:75]
  v_add_u32 v56, s60, v8
  v_mov_b64 v[18:19], 0
  s_add_u32 s74, s57, 1
  v_mov_b32 v50, s74
  s_cmp_ge_u32 s57, 58
  s_cselect_b32 s73, s93, 268435456
  v_mfma_f32_16x16x16_bf16 v[52:55], v[46:47], v[60:61], v[52:55]
  buffer_store_dwordx4 v[44:47], v0, s[52:55], s100 offen offset:1024 sc1
  buffer_store_dword v50, off, s[52:55], s73 offset:8 sc1
  v_rcp_f32 v36, v36
  v_add_u32 v60, s61, v8
  v_cndmask_b32 v68, v8, v56, s[80:81]
  v_mul_f32 v72, v36, v72
  v_mul_f32 v73, v36, v73
  v_mul_f32 v74, v36, v74
  v_mul_f32 v75, v36, v75
  v_cvt_pk_bf16_f32 v72, v72, v73
  v_cvt_pk_bf16_f32 v73, v74, v75
  v_mul_f32 v52, v36, v52
  v_mul_f32 v53, v36, v53
  v_mul_f32 v54, v36, v54
  v_mul_f32 v55, v36, v55
  v_cvt_pk_bf16_f32 v74, v52, v53
  v_cvt_pk_bf16_f32 v75, v54, v55
  ds_write_b128 v0, v[72:75]
  s_cmp_eq_u32 s57, 63
  s_cbranch_scc1 CEND_62
  v_cndmask_b32 v76, v60, v64, s[80:81]
  v_mov_b32_dpp v72, v72 row_ror:8 row_mask:0xf bank_mask:0xc
  v_mov_b32_dpp v73, v73 row_ror:8 row_mask:0xf bank_mask:0xc
  v_mov_b32_dpp v74, v74 row_ror:8 row_mask:0xf bank_mask:0xc
  v_mov_b32_dpp v75, v75 row_ror:8 row_mask:0xf bank_mask:0xc
  v_mov_b64 v[20:21], 0
  v_mov_b64 v[22:23], 0
  v_mov_b64 v[24:25], 0
  v_mov_b64 v[26:27], 0
  v_mov_b64 v[28:29], 0
  v_mov_b64 v[30:31], 0
  v_mov_b64 v[32:33], 0
  v_mov_b64 v[34:35], 0
  v_lshrrev_b32 v9, 1, v0
  v_bfe_u32 v11, v0, 9, 1
  v_and_b32 v10, 0xf8, v9
  v_lshl_add_u32 v10, v11, 2, v10
  s_waitcnt lgkmcnt(0)
  s_barrier
  ds_read_b128 v[56:59], v56
  v_smfmac_f32_16x16x64_bf16 v[16:19], v[72:75], a[112:119], v1
  ds_read_b128 v[60:63], v60
  v_smfmac_f32_16x16x64_bf16 v[20:23], v[72:75], a[120:127], v1
  ds_read_b128 v[64:67], v64
  v_smfmac_f32_16x16x64_bf16 v[24:27], v[72:75], a[176:183], v1
  ds_read_b128 v[68:71], v68
  ds_read_b128 v[76:79], v76
  v_smfmac_f32_16x16x64_bf16 v[28:31], v[72:75], a[184:191], v1
  s_waitcnt lgkmcnt(4)
  v_smfmac_f32_16x16x64_bf16 v[16:19], v[56:59], a[128:135], v1
  v_and_b32 v49, 0x70, v0
  s_waitcnt lgkmcnt(3)
  v_smfmac_f32_16x16x64_bf16 v[16:19], v[60:63], a[144:151], v1
  v_bfe_u32 v50, v0, 7, 3
  s_waitcnt lgkmcnt(2)
  v_smfmac_f32_16x16x64_bf16 v[16:19], v[64:67], a[160:167], v1
  v_lshl_add_u32 v48, v50, 10, v49
  s_waitcnt lgkmcnt(1)
  v_smfmac_f32_16x16x64_bf16 v[32:35], v[68:71], a[240:247], v1
  v_bfe_u32 v49, v0, 4, 2
  s_waitcnt lgkmcnt(0)
  v_smfmac_f32_16x16x64_bf16 v[32:35], v[76:79], a[248:255], v1
  v_cvt_pk_bf16_f32 v16, v16, v17
  v_smfmac_f32_16x16x64_bf16 v[20:23], v[56:59], a[136:143], v1
  v_cvt_pk_bf16_f32 v17, v18, v19
  buffer_store_dwordx2 v[16:17], v9, s[52:55], s66 offen
  s_add_u32 s66, s66, 32768
  v_smfmac_f32_16x16x64_bf16 v[20:23], v[60:63], a[152:159], v1
  v_permlane32_swap_b32 v32, v34
  v_smfmac_f32_16x16x64_bf16 v[20:23], v[64:67], a[168:175], v1
  v_permlane32_swap_b32 v33, v35
  v_smfmac_f32_16x16x64_bf16 v[24:27], v[56:59], a[192:199], v1
  v_add_f32 v32, v32, v34
  v_add_f32 v33, v33, v35
  v_smfmac_f32_16x16x64_bf16 v[24:27], v[60:63], a[208:215], v1
  v_cvt_pk_bf16_f32 v32, v32, v33
  buffer_store_dword v32, v10, s[52:55], s92 offen
  v_cvt_pk_bf16_f32 v20, v20, v21
  v_smfmac_f32_16x16x64_bf16 v[24:27], v[64:67], a[224:231], v1
  v_cvt_pk_bf16_f32 v21, v22, v23
  buffer_store_dwordx2 v[20:21], v9, s[52:55], s101 offen
  s_add_u32 s101, s101, 32768
  v_smfmac_f32_16x16x64_bf16 v[28:31], v[56:59], a[200:207], v1
  v_bfe_u32 v50, v0, 8, 2
  v_smfmac_f32_16x16x64_bf16 v[28:31], v[60:63], a[216:223], v1
  v_cvt_pk_bf16_f32 v24, v24, v25
  v_smfmac_f32_16x16x64_bf16 v[28:31], v[64:67], a[232:239], v1
  v_cvt_pk_bf16_f32 v25, v26, v27
  buffer_store_dwordx2 v[24:25], v9, s[52:55], s66 offen
  s_sub_u32 s66, s66, 32768
  s_nop 4
  v_cvt_pk_bf16_f32 v28, v28, v29
  v_cvt_pk_bf16_f32 v29, v30, v31
  buffer_store_dwordx2 v[28:29], v9, s[52:55], s101 offen
  s_sub_u32 s101, s101, 32768
  v_lshl_add_u32 v49, v50, 2, v49
  v_bfe_u32 v50, v0, 6, 1
  v_lshl_add_u32 v49, v50, s91, v49
  v_lshlrev_b32 v49, 2, v49
  v_bfe_u32 v50, v0, 9, 1
  v_lshrrev_b32 v51, 2, v0
  v_lshl_add_u32 v51, v50, 7, v51
  s_add_u32 s73, s57, 1
  s_and_b32 s73, s73, 3
  s_lshl_b32 s73, s73, 14
  s_add_u32 s63, s58, s73
  s_add_u32 s6, s59, s73
  s_add_u32 s56, s69, s73
  s_xor_b32 s73, s73, 0x8000
  s_add_u32 s77, s69, s73
  s_xor_b32 s67, s67, 524288
  s_xor_b32 s68, s68, 524288
  s_add_u32 s86, s67, 16384
  s_add_u32 s87, s68, 16384
  s_cmp_eq_u32 s75, 0
  s_cbranch_scc1 NR_71
  v_mov_b32 v52, -1
  ds_read_b128 v[56:59], v0 offset:4096
  ds_read_b128 v[60:63], v0 offset:5120
  ds_read_b128 v[64:67], v0 offset:6144
  ds_read_b128 v[68:71], v0 offset:7168
  ds_read_b128 v[16:19], v0 offset:8192
  ds_read_b128 v[20:23], v0 offset:9216
  buffer_store_dword v52, v49, s[52:55], s77 offen
  s_cmp_eq_u32 s5, 1
  s_cbranch_scc1 RL_73
  buffer_load_dwordx4 v[12:15], v48, s[52:55], s67 offen sc1
  buffer_load_dwordx4 v[44:47], v48, s[52:55], s68 offen sc1
  buffer_load_dwordx4 v[4:7], v48, s[52:55], s86 offen sc1
  buffer_load_dwordx4 v[8:11], v48, s[52:55], s87 offen sc1
  v_bfe_u32 v42, v0, 6, 2
  v_lshlrev_b32 v42, 4, v42
  v_lshlrev_b64 v[40:41], v42, s[88:89]
  v_mov_b64 v[42:43], v[40:41]
  s_mov_b64 exec, s[96:97]
  v_mov_b64 v[40:41], 0
  s_not_b64 exec, exec
  v_mov_b64 v[42:43], 0
  s_mov_b64 exec, -1
  ds_read_b64 v[54:55], v0 offset:3456
  s_xor_b32 s66, s66, 524288
  s_xor_b32 s101, s101, 524288
  s_xor_b32 s92, s92, 524288
  s_add_u32 s7, s7, 0x40000
  s_add_u32 s100, s100, 0x40000
  s_sub_i32 s72, s72, 1
  ds_read_b128 v[24:27], v0 offset:10240
  ds_read_b128 v[28:31], v0 offset:11264
  ds_read_b128 v[32:35], v0 offset:16384
  ds_read_b128 v[36:39], v0 offset:17408
  s_waitcnt lgkmcnt(4)
  v_min_u32 v54, v54, v55
  s_nop 0
  v_readfirstlane_b32 s73, v54
  s_max_u32 s71, s71, s73
  s_add_u32 s73, s57, 2
  s_min_u32 s73, s73, 64
FP_78:
  s_cmp_ge_u32 s71, s73
  s_cbranch_scc1 FOK_77
  buffer_load_dwordx2 v[54:55], off, s[52:55], s70 sc1
  s_waitcnt vmcnt(0)
  v_min_u32 v54, v54, v55
  s_nop 0
  v_readfirstlane_b32 s71, v54
  s_sub_i32 s72, s72, 1
  s_cmp_ge_i32 s72, 0
  s_cbranch_scc1 FP_78
FOK_77:
  s_add_u32 s94, s65, s95
  s_add_u32 s94, s94, 524288
  s_add_u32 s73, s57, 3
  s_cmp_ge_u32 s71, s73
  s_cselect_b32 s94, s94, 268435456
  s_xor_b32 s73, s92, 524288
  s_add_u32 s73, s73, s64
  s_sub_u32 s74, s73, 65536
  s_andn2_b32 s74, s74, 768
  s_add_u32 s65, s65, 0x40000
  buffer_load_dwordx4 v[12:15], v48, s[52:55], s67 offen sc1
  buffer_load_dwordx4 v[44:47], v48, s[52:55], s68 offen sc1
  buffer_load_dwordx4 v[4:7], v48, s[52:55], s86 offen sc1
  buffer_load_dwordx4 v[8:11], v48, s[52:55], s87 offen sc1
RQ_74:
  s_sub_i32 s72, s72, 1
  s_waitcnt vmcnt(7)
  v_max3_u32 v50, v12, v13, v14
  v_max3_u32 v50, v14, v15, v50
  v_mfma_f32_16x16x32_bf16 v[52:55], v[40:43], v[12:15], 0
  s_waitcnt vmcnt(6)
  v_max3_u32 v50, v44, v45, v50
  v_max3_u32 v50, v46, v47, v50
  v_mfma_f32_16x16x32_bf16 v[52:55], v[40:43], v[44:47], v[52:55]
  s_waitcnt vmcnt(5)
  v_max3_u32 v50, v4, v5, v50
  v_max3_u32 v50, v6, v7, v50
  v_mfma_f32_16x16x32_bf16 v[52:55], v[40:43], v[4:7], v[52:55]
  s_waitcnt vmcnt(4)
  v_max3_u32 v50, v8, v9, v50
  v_max3_u32 v50, v10, v11, v50
  v_mfma_f32_16x16x32_bf16 v[52:55], v[40:43], v[8:11], v[52:55]
  v_cmp_eq_u32 vcc, -1, v50
  s_cbranch_vccnz RR_76
RO_75:
  s_mov_b64 exec, -1
  s_nop 4
  v_add_f32_dpp v52, v52, v52 row_ror:8 row_mask:0xf bank_mask:0xf
  v_add_f32_dpp v53, v53, v53 row_ror:8 row_mask:0xf bank_mask:0xf
  v_cvt_pk_bf16_f32 v52, v52, v53
  buffer_store_dword v52, v49, s[52:55], s56 offen
  s_branch NJ_72
RL_73:
  ds_read_b64 v[54:55], v0 offset:3456
  s_xor_b32 s66, s66, 524288
  s_xor_b32 s101, s101, 524288
  s_xor_b32 s92, s92, 524288
  s_add_u32 s7, s7, 0x40000
  s_add_u32 s100, s100, 0x40000
  s_sub_i32 s72, s72, 1
  s_waitcnt lgkmcnt(0)
  v_min_u32 v54, v54, v55
  s_nop 0
  v_readfirstlane_b32 s73, v54
  s_max_u32 s71, s71, s73
  s_add_u32 s73, s57, 2
  s_min_u32 s73, s73, 64
FP_83:
  s_cmp_ge_u32 s71, s73
  s_cbranch_scc1 FOK_82
  buffer_load_dwordx2 v[54:55], off, s[52:55], s70 sc1
  s_waitcnt vmcnt(0)
  v_min_u32 v54, v54, v55
  s_nop 0
  v_readfirstlane_b32 s71, v54
  s_sub_i32 s72, s72, 1
  s_cmp_ge_i32 s72, 0
  s_cbranch_scc1 FP_83
FOK_82:
  buffer_load_dwordx4 v[12:15], v48, s[52:55], s67 offen sc1
  buffer_load_dwordx4 v[44:47], v48, s[52:55], s68 offen sc1
  buffer_load_dwordx4 v[4:7], v48, s[52:55], s86 offen sc1
  buffer_load_dwordx4 v[8:11], v48, s[52:55], s87 offen sc1
  v_bfe_u32 v42, v0, 6, 2
  v_lshlrev_b32 v42, 4, v42
  v_lshlrev_b64 v[40:41], v42, s[88:89]
  v_mov_b64 v[42:43], v[40:41]
  s_mov_b64 exec, s[96:97]
  v_mov_b64 v[40:41], 0
  s_not_b64 exec, exec
  v_mov_b64 v[42:43], 0
  s_mov_b64 exec, -1
  ds_read_b128 v[24:27], v0 offset:10240
  ds_read_b128 v[28:31], v0 offset:11264
  ds_read_b128 v[32:35], v0 offset:16384
  ds_read_b128 v[36:39], v0 offset:17408
  s_add_u32 s94, s65, s95
  s_add_u32 s94, s94, 524288
  s_add_u32 s73, s57, 3
  s_cmp_ge_u32 s71, s73
  s_cselect_b32 s94, s94, 268435456
  s_xor_b32 s73, s92, 524288
  s_add_u32 s73, s73, s64
  s_sub_u32 s74, s73, 65536
  s_andn2_b32 s74, s74, 768
  s_add_u32 s65, s65, 0x40000
  buffer_load_dwordx4 v[12:15], v48, s[52:55], s67 offen sc1
  buffer_load_dwordx4 v[44:47], v48, s[52:55], s68 offen sc1
  buffer_load_dwordx4 v[4:7], v48, s[52:55], s86 offen sc1
  buffer_load_dwordx4 v[8:11], v48, s[52:55], s87 offen sc1
RQ_79:
  s_sub_i32 s72, s72, 1
  s_waitcnt vmcnt(7)
  v_max3_u32 v50, v12, v13, v14
  v_max3_u32 v50, v14, v15, v50
  v_mfma_f32_16x16x32_bf16 v[52:55], v[40:43], v[12:15], 0
  s_waitcnt vmcnt(6)
  v_max3_u32 v50, v44, v45, v50
  v_max3_u32 v50, v46, v47, v50
  v_mfma_f32_16x16x32_bf16 v[52:55], v[40:43], v[44:47], v[52:55]
  s_waitcnt vmcnt(5)
  v_max3_u32 v50, v4, v5, v50
  v_max3_u32 v50, v6, v7, v50
  v_mfma_f32_16x16x32_bf16 v[52:55], v[40:43], v[4:7], v[52:55]
  s_waitcnt vmcnt(4)
  v_max3_u32 v50, v8, v9, v50
  v_max3_u32 v50, v10, v11, v50
  v_mfma_f32_16x16x32_bf16 v[52:55], v[40:43], v[8:11], v[52:55]
  v_cmp_eq_u32 vcc, -1, v50
  s_cbranch_vccnz RR_81
RO_80:
  s_mov_b64 exec, -1
  s_nop 4
  v_add_f32_dpp v52, v52, v52 row_ror:8 row_mask:0xf bank_mask:0xf
  v_add_f32_dpp v53, v53, v53 row_ror:8 row_mask:0xf bank_mask:0xf
  v_cvt_pk_bf16_f32 v52, v52, v53
  buffer_store_dword v52, v49, s[52:55], s56 offen
NJ_72:
  s_barrier
  buffer_load_dword v12, v51, s[52:55], s6 offen sc1
  buffer_load_dwordx4 v[4:7], v0, s[52:55], s63 offen sc1
  v_mov_b64 v[40:41], 0
  v_mov_b64 v[42:43], 0
  v_mov_b64 v[52:53], 0
  v_mov_b64 v[54:55], 0
  v_mov_b64 v[48:49], 0
  v_mov_b32 v50, 0
  buffer_load_dwordx4 v[8:11], v0, s[52:55], s63 offen offset:2048 sc1
  s_add_u32 s57, s57, 1
  s_sub_u32 s77, s70, 2432
  s_cmp_ge_u32 s71, 64
  s_cselect_b32 s77, 268435456, s77
  s_waitcnt vmcnt(5)
  v_lshrrev_b32 v14, 2, v0
  v_add_u32 v14, s90, v14
  v_bfe_u32 v15, v0, 8, 2
  v_mul_u32_u24 v15, 40960, v15
  v_and_b32 v13, 0xf0, v0
  v_add_u32 v13, v13, v15
  v_mov_b64 v[44:45], 0
  v_mov_b64 v[46:47], 0
  ds_read_b128 v[72:75], v0 offset:18432
  ds_read_b128 v[76:79], v0 offset:19456
  s_waitcnt lgkmcnt(0)
  buffer_load_dword v12, v51, s[52:55], s6 offen sc1
  buffer_load_dwordx4 v[4:7], v0, s[52:55], s63 offen sc1
  buffer_load_dwordx4 v[8:11], v0, s[52:55], s63 offen offset:2048 sc1
  s_branch MP_66
NR_71:
  ds_read_b64 v[54:55], v0 offset:3456
  s_xor_b32 s66, s66, 524288
  s_xor_b32 s101, s101, 524288
  s_xor_b32 s92, s92, 524288
  s_add_u32 s7, s7, 0x40000
  s_add_u32 s100, s100, 0x40000
  s_sub_i32 s72, s72, 1
  ds_read_b128 v[56:59], v0 offset:4096
  ds_read_b128 v[60:63], v0 offset:5120
  ds_read_b128 v[64:67], v0 offset:6144
  ds_read_b128 v[68:71], v0 offset:7168
  ds_read_b128 v[16:19], v0 offset:8192
  ds_read_b128 v[20:23], v0 offset:9216
  ds_read_b128 v[24:27], v0 offset:10240
  ds_read_b128 v[28:31], v0 offset:11264
  ds_read_b128 v[32:35], v0 offset:16384
  ds_read_b128 v[36:39], v0 offset:17408
  s_waitcnt lgkmcnt(10)
  v_min_u32 v54, v54, v55
  s_nop 0
  v_readfirstlane_b32 s73, v54
  s_max_u32 s71, s71, s73
  s_add_u32 s73, s57, 2
  s_min_u32 s73, s73, 64
FP_85:
  s_cmp_ge_u32 s71, s73
  s_cbranch_scc1 FOK_84
  buffer_load_dwordx2 v[54:55], off, s[52:55], s70 sc1
  s_waitcnt vmcnt(0)
  v_min_u32 v54, v54, v55
  s_nop 0
  v_readfirstlane_b32 s71, v54
  s_sub_i32 s72, s72, 1
  s_cmp_ge_i32 s72, 0
  s_cbranch_scc1 FP_85
FOK_84:
  s_add_u32 s94, s65, s95
  s_add_u32 s94, s94, 524288
  s_add_u32 s73, s57, 3
  s_cmp_ge_u32 s71, s73
  s_cselect_b32 s94, s94, 268435456
  s_xor_b32 s73, s92, 524288
  s_add_u32 s73, s73, s64
  s_sub_u32 s74, s73, 65536
  s_andn2_b32 s74, s74, 768
  s_add_u32 s65, s65, 0x40000
  s_branch NJ_72
MR_67:
  s_mov_b64 vcc, exec
MT_86:
  s_mov_b64 exec, vcc
  buffer_load_dword v12, v51, s[52:55], s6 offen sc1
  buffer_load_dwordx4 v[4:7], v0, s[52:55], s63 offen sc1
  buffer_load_dwordx4 v[8:11], v0, s[52:55], s63 offen offset:2048 sc1
  s_sub_i32 s72, s72, 1
  s_waitcnt vmcnt(3)
  v_max3_u32 v15, v12, v4, v5
  v_max3_u32 v15, v6, v7, v15
  v_max3_u32 v15, v8, v9, v15
  v_max3_u32 v15, v10, v11, v15
  ds_write_b128 v0, v[4:7]
  v_cmp_eq_u32 vcc, -1, v15
  ds_write_b32 v14, v12 offset:3584
  ds_write_b128 v0, v[8:11] offset:1024
  s_cmp_lt_i32 s72, 0
  s_cselect_b64 vcc, 0, vcc
  s_cbranch_vccnz MT_86
  s_mov_b64 exec, -1
  s_waitcnt lgkmcnt(11)
  v_smfmac_f32_16x16x64_bf16 v[40:43], v[4:7], v[56:63], v1
  v_mov_b32 v51, 0
  s_waitcnt lgkmcnt(9)
  v_smfmac_f32_16x16x64_bf16 v[44:47], v[4:7], v[64:71], v1
  s_branch CGO_65
MS_69:
  s_mov_b64 exec, vcc
  s_cmp_lt_i32 s72, 0
  s_cbranch_scc1 CGO_65
  buffer_load_dwordx4 v[8:11], v0, s[52:55], s63 offen offset:2048 sc1
  s_sub_i32 s72, s72, 1
  s_waitcnt vmcnt(1)
  s_branch MQ_68
RR_76:
  s_cmp_lt_i32 s72, 0
  s_cbranch_scc1 RO_75
  s_mov_b64 exec, vcc
  buffer_load_dwordx4 v[12:15], v48, s[52:55], s67 offen sc1
  buffer_load_dwordx4 v[44:47], v48, s[52:55], s68 offen sc1
  buffer_load_dwordx4 v[4:7], v48, s[52:55], s86 offen sc1
  buffer_load_dwordx4 v[8:11], v48, s[52:55], s87 offen sc1
  s_branch RQ_74
RR_81:
  s_cmp_lt_i32 s72, 0
  s_cbranch_scc1 RO_80
  s_mov_b64 exec, vcc
  buffer_load_dwordx4 v[12:15], v48, s[52:55], s67 offen sc1
  buffer_load_dwordx4 v[44:47], v48, s[52:55], s68 offen sc1
  buffer_load_dwordx4 v[4:7], v48, s[52:55], s86 offen sc1
  buffer_load_dwordx4 v[8:11], v48, s[52:55], s87 offen sc1
  s_branch RQ_79
CSLOW_63:
  v_smfmac_f32_16x16x64_bf16 v[40:43], v[4:7], v[56:63], v1
  v_smfmac_f32_16x16x64_bf16 v[44:47], v[4:7], v[64:71], v1
  s_branch CGO_88
MP_89:
  s_waitcnt vmcnt(4) lgkmcnt(0)
  v_max3_u32 v15, v12, v4, v5
  v_max3_u32 v15, v6, v7, v15
  ds_write_b128 v0, v[4:7]
  v_cmp_eq_u32 vcc, -1, v15
  ds_write_b32 v14, v12 offset:3584
  s_cbranch_vccnz MR_90
ME_93:
  s_mov_b64 exec, -1
  v_smfmac_f32_16x16x64_bf16 v[40:43], v[4:7], v[56:63], v1
  v_mov_b32 v51, 0
  v_smfmac_f32_16x16x64_bf16 v[44:47], v[4:7], v[64:71], v1
  s_waitcnt vmcnt(3)
MQ_91:
  v_max3_u32 v15, v8, v9, v10
  v_max_u32 v15, v11, v15
  ds_write_b128 v0, v[8:11] offset:1024
  v_cmp_eq_u32 vcc, -1, v15
  s_cbranch_vccnz MS_92
CGO_88:
  s_mov_b64 exec, -1
  v_smfmac_f32_16x16x64_bf16 v[40:43], v[8:11], v[16:23], v1
  v_smfmac_f32_16x16x64_bf16 v[44:47], v[8:11], v[24:31], v1
  v_add_u32 v20, s60, v0
  v_smfmac_f32_16x16x64_bf16 v[52:55], v[4:7], v[184:191], v1
  ds_read_b128 v[64:67], v0 offset:22528
  ds_read_b128 v[68:71], v0 offset:23552
  v_add_u32 v28, s61, v0
  s_waitcnt lgkmcnt(2)
  s_barrier
  s_waitcnt vmcnt(0)
  ds_read_b128 v[12:15], v13 offset:3584
  ds_read_b128 v[16:19], v20
  v_smfmac_f32_16x16x64_bf16 v[48:51], v[4:7], v[176:183], v1
  ds_read_b128 v[56:59], v0 offset:20480
  ds_read_b128 v[60:63], v0 offset:21504
  ds_read_b128 v[20:23], v20 offset:1024
  v_smfmac_f32_16x16x64_bf16 v[52:55], v[8:11], v[200:207], v1
  ds_read_b128 v[24:27], v28
  v_smfmac_f32_16x16x64_bf16 v[48:51], v[8:11], v[192:199], v1
  s_waitcnt lgkmcnt(5)
  v_smfmac_f32_16x16x64_bf16 v[44:47], v[12:15], v[72:79], v1
  buffer_load_dwordx4 v[72:75], v0, s[52:55], s65 offen sc1
  v_smfmac_f32_16x16x64_bf16 v[40:43], v[12:15], v[32:39], v1
  ds_read_b128 v[28:31], v28 offset:1024
  v_add_u32 v36, s62, v0
  s_waitcnt lgkmcnt(3)
  v_smfmac_f32_16x16x64_bf16 v[48:51], v[12:15], v[56:63], v1
  ds_read_b128 v[32:35], v36
  buffer_load_dwordx4 v[76:79], v0, s[52:55], s65 offen offset:1024 sc1
  v_smfmac_f32_16x16x64_bf16 v[52:55], v[12:15], v[64:71], v1
  ds_read_b128 v[36:39], v36 offset:1024
  v_lshlrev_b32 v57, 3, v0
  v_smfmac_f32_16x16x64_bf16 v[40:43], v[16:19], v[80:87], v1
  ds_read_b128 v[64:67], v0 offset:14336
  v_smfmac_f32_16x16x64_bf16 v[44:47], v[16:19], v[88:95], v1
  ds_read_b128 v[68:71], v0 offset:15360
  s_waitcnt lgkmcnt(6)
  v_smfmac_f32_16x16x64_bf16 v[40:43], v[20:23], v[96:103], v1
  v_smfmac_f32_16x16x64_bf16 v[44:47], v[20:23], v[104:111], v1
  s_mov_b64 exec, 0xffff
  buffer_load_dword v57, s[52:55], s94 offen offset:2176 sc1 lds
  s_mov_b64 exec, 1
  s_waitcnt lgkmcnt(5)
  v_smfmac_f32_16x16x64_bf16 v[40:43], v[24:27], v[112:119], v1
  buffer_load_dwordx4 off, s[52:55], s77 offset:2432 sc1 lds
  s_mov_b64 exec, -1
  v_smfmac_f32_16x16x64_bf16 v[44:47], v[24:27], v[120:127], v1
  v_mov_b32 v58, s57
  s_waitcnt lgkmcnt(4)
  v_smfmac_f32_16x16x64_bf16 v[40:43], v[28:31], v[128:135], v1
  buffer_store_dword v58, off, s[52:55], s93 offset:8 sc1
  v_smfmac_f32_16x16x64_bf16 v[44:47], v[28:31], v[136:143], v1
  ds_read_b128 v[56:59], v0 offset:12288
  s_waitcnt lgkmcnt(4)
  v_smfmac_f32_16x16x64_bf16 v[40:43], v[32:35], v[144:151], v1
  ds_read_b128 v[60:63], v0 offset:13312
  v_smfmac_f32_16x16x64_bf16 v[44:47], v[32:35], v[152:159], v1
  s_waitcnt lgkmcnt(4)
  v_smfmac_f32_16x16x64_bf16 v[40:43], v[36:39], v[160:167], v1
  v_smfmac_f32_16x16x64_bf16 v[44:47], v[36:39], v[168:175], v1
  s_waitcnt lgkmcnt(0)
  v_smfmac_f32_16x16x64_bf16 v[48:51], v[16:19], v[56:63], v1
  v_cvt_pk_bf16_f32 v40, v40, v41
  v_cvt_pk_bf16_f32 v41, v42, v43
  v_smfmac_f32_16x16x64_bf16 v[52:55], v[16:19], v[64:71], v1
  v_cvt_pk_bf16_f32 v44, v44, v45
  v_cvt_pk_bf16_f32 v45, v46, v47
  v_mfma_f32_16x16x16_bf16 v[40:43], v[40:41], v[2:3], 0
  v_and_b32 v56, 0x3ff, v0
  v_mfma_f32_16x16x16_bf16 v[44:47], v[44:45], v[2:3], 0
  v_add_u32 v64, 81920, v56
  v_smfmac_f32_16x16x64_bf16 v[48:51], v[20:23], v[208:215], v1
  v_cvt_pk_bf16_f32 v40, v40, v41
  v_cvt_pk_bf16_f32 v41, v42, v43
  v_smfmac_f32_16x16x64_bf16 v[48:51], v[24:27], v[224:231], v1
  v_cvt_pk_bf16_f32 v42, v44, v45
  v_cvt_pk_bf16_f32 v43, v46, v47
  v_smfmac_f32_16x16x64_bf16 v[48:51], v[28:31], v[240:247], v1
  v_mov_b64 v[44:45], 0
  s_waitcnt vmcnt(4)
  v_mfma_f32_16x16x32_bf16 v[72:75], v[72:75], v[40:43], 0
  v_mov_b64 v[46:47], 0
  s_waitcnt vmcnt(3)
  v_mfma_f32_16x16x32_bf16 v[76:79], v[76:79], v[40:43], 0
  v_smfmac_f32_16x16x64_bf16 v[48:51], v[32:35], a[0:7], v1
  v_smfmac_f32_16x16x64_bf16 v[48:51], v[36:39], a[16:23], v1
  v_cndmask_b32 v72, v72, v76, s[80:81]
  v_cndmask_b32 v73, v73, v77, s[80:81]
  v_smfmac_f32_16x16x64_bf16 v[52:55], v[20:23], v[216:223], v1
  v_cndmask_b32 v74, v74, v78, s[80:81]
  v_cndmask_b32 v75, v75, v79, s[80:81]
  v_smfmac_f32_16x16x64_bf16 v[52:55], v[24:27], v[232:239], v1
  ds_write_b128 v0, v[72:75] offset:2048
  v_cvt_pk_bf16_f32 v48, v48, v49
  v_smfmac_f32_16x16x64_bf16 v[52:55], v[28:31], v[248:255], v1
  v_cvt_pk_bf16_f32 v49, v50, v51
  v_mov_b64 v[76:77], -1
  v_smfmac_f32_16x16x64_bf16 v[52:55], v[32:35], a[8:15], v1
  v_mov_b64 v[78:79], -1
  v_mfma_f32_16x16x16_bf16 v[48:51], v[48:49], v[2:3], 0
  buffer_store_dwordx4 v[76:79], v0, s[52:55], s74 offen sc1
  s_add_u32 s74, s74, 32768
  v_smfmac_f32_16x16x64_bf16 v[52:55], v[36:39], a[24:31], v1
  v_smfmac_f32_16x16x64_bf16 v[44:47], v[4:7], a[32:39], v1
  v_cvt_pk_bf16_f32 v48, v48, v49
  s_waitcnt lgkmcnt(0)
  s_barrier
  ds_read_b128 v[60:63], v56 offset:43008
  v_cvt_pk_bf16_f32 v52, v52, v53
  v_cvt_pk_bf16_f32 v53, v54, v55
  ds_read_b128 v[56:59], v56 offset:2048
  ds_read_b128 v[68:71], v64 offset:43008
  v_mfma_f32_16x16x16_bf16 v[52:55], v[52:53], v[2:3], 0
  ds_read_b128 v[64:67], v64 offset:2048
  v_cvt_pk_bf16_f32 v49, v50, v51
  buffer_store_dwordx4 v[76:79], v0, s[52:55], s74 offen sc1
  v_smfmac_f32_16x16x64_bf16 v[44:47], v[8:11], a[48:55], v1
  buffer_load_dwordx4 v[72:75], v0, s[52:55], s7 offen sc1
  v_smfmac_f32_16x16x64_bf16 v[44:47], v[12:15], a[64:71], v1
  v_cvt_pk_bf16_f32 v50, v52, v53
  v_cvt_pk_bf16_f32 v51, v54, v55
  s_mov_b64 exec, 0xffff
  buffer_store_dwordx4 v[76:79], v0, s[52:55], s73 offen sc1
  s_mov_b64 exec, -1
  v_mfma_f32_16x16x32_bf16 v[40:43], v[48:51], v[40:43], 0
  v_mov_b64 v[76:77], 0
  v_mov_b64 v[78:79], 0
  v_smfmac_f32_16x16x64_bf16 v[44:47], v[16:19], a[80:87], v1
  s_waitcnt lgkmcnt(2)
  v_add_f32 v56, v56, v60
  v_add_f32 v57, v57, v61
  v_smfmac_f32_16x16x64_bf16 v[76:79], v[4:7], a[40:47], v1
  ds_write_b128 v0, v[40:43] offset:3072
  v_add_f32 v58, v58, v62
  v_add_f32 v59, v59, v63
  v_smfmac_f32_16x16x64_bf16 v[76:79], v[8:11], a[56:63], v1
  buffer_load_dwordx4 v[52:55], v0, s[52:55], s7 offen offset:1024 sc1
  s_waitcnt lgkmcnt(1)
  v_add_f32 v64, v64, v68
  v_add_f32 v65, v65, v69
  ds_read_b128 v[4:7], v0 offset:26624
  ds_read_b128 v[8:11], v0 offset:27648
  v_add_f32 v66, v66, v70
  v_add_f32 v67, v67, v71
  v_smfmac_f32_16x16x64_bf16 v[76:79], v[12:15], a[72:79], v1
  v_add_f32 v56, v56, v64
  v_add_f32 v57, v57, v65
  v_lshlrev_b32 v60, 3, v0
  v_smfmac_f32_16x16x64_bf16 v[76:79], v[16:19], a[88:95], v1
  s_mov_b64 exec, 0xffff0000
  buffer_load_dword v60, s[52:55], s94 offen offset:2176 sc1 lds
  s_mov_b64 exec, -1
  v_add_f32 v58, v58, v66
  v_add_f32 v59, v59, v67
  ds_read_b128 v[64:67], v0 offset:24576
  ds_read_b128 v[68:71], v0 offset:25600
  v_smfmac_f32_16x16x64_bf16 v[44:47], v[20:23], a[96:103], v1
  v_bfe_u32 v62, v0, 7, 1
  v_and_b32 v63, 0x3ff, v0
  v_smfmac_f32_16x16x64_bf16 v[76:79], v[20:23], a[104:111], v1
  v_mad_i32_i24 v63, v62, s78, v63
  ds_read_b128 v[12:15], v0 offset:32768
  ds_read_b128 v[16:19], v0 offset:33792
  s_waitcnt lgkmcnt(6)
  s_barrier
  ds_read2st64_b64 v[40:43], v63 offset0:6 offset1:86
  ds_read2st64_b64 v[20:23], v63 offset0:166 offset1:246
  s_waitcnt lgkmcnt(6)
  v_smfmac_f32_16x16x64_bf16 v[76:79], v[24:27], v[4:11], v1
  buffer_store_dwordx4 v[48:51], v0, s[52:55], s100 offen sc1
  s_waitcnt lgkmcnt(4)
  v_smfmac_f32_16x16x64_bf16 v[44:47], v[24:27], v[64:71], v1
  ds_read_b128 v[4:7], v0 offset:28672
  v_max3_f32 v62, v56, v57, v58
  s_waitcnt lgkmcnt(3)
  v_smfmac_f32_16x16x64_bf16 v[44:47], v[28:31], v[12:19], v1
  ds_read_b128 v[64:67], v0 offset:34816
  ds_read_b128 v[68:71], v0 offset:35840
  s_waitcnt lgkmcnt(4)
  v_add_f32 v60, v40, v42
  v_add_f32 v61, v41, v43
  v_max_f32 v62, v62, v59
  s_waitcnt lgkmcnt(3)
  v_add_f32 v60, v60, v20
  v_add_f32 v61, v61, v21
  ds_read_b128 v[8:11], v0 offset:29696
  v_add_f32 v60, v60, v22
  v_add_f32 v61, v61, v23
  v_max3_f32 v62, v60, v61, v62
  ds_read_b128 v[12:15], v0 offset:30720
  ds_read_b128 v[16:19], v0 offset:31744
  v_max_f32_dpp v62, v62, v62 row_ror:8 row_mask:0xf bank_mask:0xf
  v_mov_b32 v63, v62
  s_waitcnt lgkmcnt(3)
  v_smfmac_f32_16x16x64_bf16 v[76:79], v[28:31], v[64:71], v1
  v_permlane16_swap_b32 v62, v63
  v_max_f32 v62, v62, v63
  v_mov_b32 v63, v62
  ds_read_b128 v[64:67], v0 offset:36864
  ds_read_b128 v[68:71], v0 offset:37888
  v_permlane32_swap_b32 v62, v63
  v_max_f32 v62, v62, v63
  s_waitcnt lgkmcnt(4)
  v_smfmac_f32_16x16x64_bf16 v[44:47], v[32:35], v[4:11], v1
  v_mul_f32 v62, s76, v62
  ds_read_b128 v[4:7], v0 offset:38912
  ds_read_b128 v[8:11], v0 offset:39936
  v_fma_f32 v56, v56, s76, -v62
  v_fma_f32 v57, v57, s76, -v62
  v_fma_f32 v58, v58, s76, -v62
  v_fma_f32 v59, v59, s76, -v62
  v_fma_f32 v60, v60, s76, -v62
  v_fma_f32 v61, v61, s76, -v62
  s_waitcnt lgkmcnt(4)
  v_smfmac_f32_16x16x64_bf16 v[76:79], v[32:35], v[12:19], v1
  v_exp_f32 v56, v56
  v_exp_f32 v57, v57
  v_exp_f32 v58, v58
  s_waitcnt lgkmcnt(2)
  v_smfmac_f32_16x16x64_bf16 v[44:47], v[36:39], v[64:71], v1
  v_exp_f32 v59, v59
  s_waitcnt lgkmcnt(0)
  v_smfmac_f32_16x16x64_bf16 v[76:79], v[36:39], v[4:11], v1
  v_exp_f32 v60, v60
  v_exp_f32 v61, v61
  v_cvt_pk_bf16_f32 v56, v56, v57
  v_cvt_pk_bf16_f32 v57, v58, v59
  v_mov_b64 v[20:21], s[82:83]
  v_mov_b64 v[22:23], s[82:83]
  v_cvt_pk_bf16_f32 v60, v60, v61
  v_mov_b32_dpp v58, v56 row_ror:8 row_mask:0xf bank_mask:0xf
  v_mov_b32_dpp v59, v57 row_ror:8 row_mask:0xf bank_mask:0xf
  v_mov_b32_dpp v61, v60 row_ror:8 row_mask:0xf bank_mask:0xf
  v_mov_b64 v[40:41], s[84:85]
  v_mfma_f32_16x16x32_bf16 v[36:39], v[20:23], v[56:59], 0
  v_cvt_pk_bf16_f32 v44, v44, v45
  v_cvt_pk_bf16_f32 v45, v46, v47
  s_waitcnt vmcnt(4)
  v_mfma_f32_16x16x32_bf16 v[72:75], v[72:75], v[56:59], 0
  v_cvt_pk_bf16_f32 v46, v76, v77
  v_cvt_pk_bf16_f32 v47, v78, v79
  s_waitcnt vmcnt(2)
  v_mfma_f32_16x16x32_bf16 v[52:55], v[52:55], v[56:59], 0
  v_and_b32 v8, 0xffffff7f, v0
  v_mfma_f32_16x16x16_bf16 v[36:39], v[40:41], v[60:61], v[36:39]
  v_add_u32 v64, s62, v8
  v_mov_b64 v[16:17], 0
  v_mfma_f32_16x16x16_bf16 v[72:75], v[44:45], v[60:61], v[72:75]
  v_add_u32 v56, s60, v8
  v_mov_b64 v[18:19], 0
  s_add_u32 s74, s57, 1
  v_mov_b32 v50, s74
  s_cmp_ge_u32 s57, 58
  s_cselect_b32 s73, s93, 268435456
  v_mfma_f32_16x16x16_bf16 v[52:55], v[46:47], v[60:61], v[52:55]
  buffer_store_dwordx4 v[44:47], v0, s[52:55], s100 offen offset:1024 sc1
  buffer_store_dword v50, off, s[52:55], s73 offset:8 sc1
  v_rcp_f32 v36, v36
  v_add_u32 v60, s61, v8
  v_cndmask_b32 v68, v8, v56, s[80:81]
  v_mul_f32 v72, v36, v72
  v_mul_f32 v73, v36, v73
  v_mul_f32 v74, v36, v74
  v_mul_f32 v75, v36, v75
  v_cvt_pk_bf16_f32 v72, v72, v73
  v_cvt_pk_bf16_f32 v73, v74, v75
  v_mul_f32 v52, v36, v52
  v_mul_f32 v53, v36, v53
  v_mul_f32 v54, v36, v54
  v_mul_f32 v55, v36, v55
  v_cvt_pk_bf16_f32 v74, v52, v53
  v_cvt_pk_bf16_f32 v75, v54, v55
  ds_write_b128 v0, v[72:75]
  s_cmp_eq_u32 s57, 63
  s_cbranch_scc1 CEND_62
  v_cndmask_b32 v76, v60, v64, s[80:81]
  v_mov_b32_dpp v72, v72 row_ror:8 row_mask:0xf bank_mask:0xc
  v_mov_b32_dpp v73, v73 row_ror:8 row_mask:0xf bank_mask:0xc
  v_mov_b32_dpp v74, v74 row_ror:8 row_mask:0xf bank_mask:0xc
  v_mov_b32_dpp v75, v75 row_ror:8 row_mask:0xf bank_mask:0xc
  v_mov_b64 v[20:21], 0
  v_mov_b64 v[22:23], 0
  v_mov_b64 v[24:25], 0
  v_mov_b64 v[26:27], 0
  v_mov_b64 v[28:29], 0
  v_mov_b64 v[30:31], 0
  v_mov_b64 v[32:33], 0
  v_mov_b64 v[34:35], 0
  v_lshrrev_b32 v9, 1, v0
  v_bfe_u32 v11, v0, 9, 1
  v_and_b32 v10, 0xf8, v9
  v_lshl_add_u32 v10, v11, 2, v10
  s_waitcnt lgkmcnt(0)
  s_barrier
  ds_read_b128 v[56:59], v56
  v_smfmac_f32_16x16x64_bf16 v[16:19], v[72:75], a[112:119], v1
  ds_read_b128 v[60:63], v60
  v_smfmac_f32_16x16x64_bf16 v[20:23], v[72:75], a[120:127], v1
  ds_read_b128 v[64:67], v64
  v_smfmac_f32_16x16x64_bf16 v[24:27], v[72:75], a[176:183], v1
  ds_read_b128 v[68:71], v68
  ds_read_b128 v[76:79], v76
  v_smfmac_f32_16x16x64_bf16 v[28:31], v[72:75], a[184:191], v1
  s_waitcnt lgkmcnt(4)
  v_smfmac_f32_16x16x64_bf16 v[16:19], v[56:59], a[128:135], v1
  v_and_b32 v49, 0x70, v0
  s_waitcnt lgkmcnt(3)
  v_smfmac_f32_16x16x64_bf16 v[16:19], v[60:63], a[144:151], v1
  v_bfe_u32 v50, v0, 7, 3
  s_waitcnt lgkmcnt(2)
  v_smfmac_f32_16x16x64_bf16 v[16:19], v[64:67], a[160:167], v1
  v_lshl_add_u32 v48, v50, 10, v49
  s_waitcnt lgkmcnt(1)
  v_smfmac_f32_16x16x64_bf16 v[32:35], v[68:71], a[240:247], v1
  v_bfe_u32 v49, v0, 4, 2
  s_waitcnt lgkmcnt(0)
  v_smfmac_f32_16x16x64_bf16 v[32:35], v[76:79], a[248:255], v1
  v_cvt_pk_bf16_f32 v16, v16, v17
  v_smfmac_f32_16x16x64_bf16 v[20:23], v[56:59], a[136:143], v1
  v_cvt_pk_bf16_f32 v17, v18, v19
  buffer_store_dwordx2 v[16:17], v9, s[52:55], s66 offen sc1
  s_add_u32 s66, s66, 32768
  v_smfmac_f32_16x16x64_bf16 v[20:23], v[60:63], a[152:159], v1
  v_permlane32_swap_b32 v32, v34
  v_smfmac_f32_16x16x64_bf16 v[20:23], v[64:67], a[168:175], v1
  v_permlane32_swap_b32 v33, v35
  v_smfmac_f32_16x16x64_bf16 v[24:27], v[56:59], a[192:199], v1
  v_add_f32 v32, v32, v34
  v_add_f32 v33, v33, v35
  v_smfmac_f32_16x16x64_bf16 v[24:27], v[60:63], a[208:215], v1
  v_cvt_pk_bf16_f32 v32, v32, v33
  buffer_store_dword v32, v10, s[52:55], s92 offen sc1
  v_cvt_pk_bf16_f32 v20, v20, v21
  v_smfmac_f32_16x16x64_bf16 v[24:27], v[64:67], a[224:231], v1
  v_cvt_pk_bf16_f32 v21, v22, v23
  buffer_store_dwordx2 v[20:21], v9, s[52:55], s101 offen sc1
  s_add_u32 s101, s101, 32768
  v_smfmac_f32_16x16x64_bf16 v[28:31], v[56:59], a[200:207], v1
  v_bfe_u32 v50, v0, 8, 2
  v_smfmac_f32_16x16x64_bf16 v[28:31], v[60:63], a[216:223], v1
  v_cvt_pk_bf16_f32 v24, v24, v25
  v_smfmac_f32_16x16x64_bf16 v[28:31], v[64:67], a[232:239], v1
  v_cvt_pk_bf16_f32 v25, v26, v27
  buffer_store_dwordx2 v[24:25], v9, s[52:55], s66 offen sc1
  s_sub_u32 s66, s66, 32768
  s_nop 4
  v_cvt_pk_bf16_f32 v28, v28, v29
  v_cvt_pk_bf16_f32 v29, v30, v31
  buffer_store_dwordx2 v[28:29], v9, s[52:55], s101 offen sc1
  s_sub_u32 s101, s101, 32768
  v_lshl_add_u32 v49, v50, 2, v49
  v_bfe_u32 v50, v0, 6, 1
  v_lshl_add_u32 v49, v50, s91, v49
  v_lshlrev_b32 v49, 2, v49
  v_bfe_u32 v50, v0, 9, 1
  v_lshrrev_b32 v51, 2, v0
  v_lshl_add_u32 v51, v50, 7, v51
  s_add_u32 s73, s57, 1
  s_and_b32 s73, s73, 3
  s_lshl_b32 s73, s73, 14
  s_add_u32 s63, s58, s73
  s_add_u32 s6, s59, s73
  s_add_u32 s56, s69, s73
  s_xor_b32 s73, s73, 0x8000
  s_add_u32 s77, s69, s73
  s_xor_b32 s67, s67, 524288
  s_xor_b32 s68, s68, 524288
  s_add_u32 s86, s67, 16384
  s_add_u32 s87, s68, 16384
  s_cmp_eq_u32 s75, 0
  s_cbranch_scc1 NR_94
  v_mov_b32 v52, -1
  ds_read_b128 v[56:59], v0 offset:4096
  ds_read_b128 v[60:63], v0 offset:5120
  ds_read_b128 v[64:67], v0 offset:6144
  ds_read_b128 v[68:71], v0 offset:7168
  ds_read_b128 v[16:19], v0 offset:8192
  ds_read_b128 v[20:23], v0 offset:9216
  buffer_store_dword v52, v49, s[52:55], s77 offen sc1
  s_cmp_eq_u32 s5, 1
  s_cbranch_scc1 RL_96
  buffer_load_dwordx4 v[12:15], v48, s[52:55], s67 offen sc1
  buffer_load_dwordx4 v[44:47], v48, s[52:55], s68 offen sc1
  buffer_load_dwordx4 v[4:7], v48, s[52:55], s86 offen sc1
  buffer_load_dwordx4 v[8:11], v48, s[52:55], s87 offen sc1
  v_bfe_u32 v42, v0, 6, 2
  v_lshlrev_b32 v42, 4, v42
  v_lshlrev_b64 v[40:41], v42, s[88:89]
  v_mov_b64 v[42:43], v[40:41]
  s_mov_b64 exec, s[96:97]
  v_mov_b64 v[40:41], 0
  s_not_b64 exec, exec
  v_mov_b64 v[42:43], 0
  s_mov_b64 exec, -1
  ds_read_b64 v[54:55], v0 offset:3456
  s_xor_b32 s66, s66, 524288
  s_xor_b32 s101, s101, 524288
  s_xor_b32 s92, s92, 524288
  s_add_u32 s7, s7, 0x40000
  s_add_u32 s100, s100, 0x40000
  s_sub_i32 s72, s72, 1
  ds_read_b128 v[24:27], v0 offset:10240
  ds_read_b128 v[28:31], v0 offset:11264
  ds_read_b128 v[32:35], v0 offset:16384
  ds_read_b128 v[36:39], v0 offset:17408
  s_waitcnt lgkmcnt(4)
  v_min_u32 v54, v54, v55
  s_nop 0
  v_readfirstlane_b32 s73, v54
  s_max_u32 s71, s71, s73
  s_add_u32 s73, s57, 2
  s_min_u32 s73, s73, 64
FP_101:
  s_cmp_ge_u32 s71, s73
  s_cbranch_scc1 FOK_100
  buffer_load_dwordx2 v[54:55], off, s[52:55], s70 sc1
  s_waitcnt vmcnt(0)
  v_min_u32 v54, v54, v55
  s_nop 0
  v_readfirstlane_b32 s71, v54
  s_sub_i32 s72, s72, 1
  s_cmp_ge_i32 s72, 0
  s_cbranch_scc1 FP_101
FOK_100:
  s_add_u32 s94, s65, s95
  s_add_u32 s94, s94, 524288
  s_add_u32 s73, s57, 3
  s_cmp_ge_u32 s71, s73
  s_cselect_b32 s94, s94, 268435456
  s_xor_b32 s73, s92, 524288
  s_add_u32 s73, s73, s64
  s_sub_u32 s74, s73, 65536
  s_andn2_b32 s74, s74, 768
  s_add_u32 s65, s65, 0x40000
  buffer_load_dwordx4 v[12:15], v48, s[52:55], s67 offen sc1
  buffer_load_dwordx4 v[44:47], v48, s[52:55], s68 offen sc1
  buffer_load_dwordx4 v[4:7], v48, s[52:55], s86 offen sc1
  buffer_load_dwordx4 v[8:11], v48, s[52:55], s87 offen sc1
RQ_97:
  s_sub_i32 s72, s72, 1
  s_waitcnt vmcnt(7)
  v_max3_u32 v50, v12, v13, v14
  v_max3_u32 v50, v14, v15, v50
  v_mfma_f32_16x16x32_bf16 v[52:55], v[40:43], v[12:15], 0
  s_waitcnt vmcnt(6)
  v_max3_u32 v50, v44, v45, v50
  v_max3_u32 v50, v46, v47, v50
  v_mfma_f32_16x16x32_bf16 v[52:55], v[40:43], v[44:47], v[52:55]
  s_waitcnt vmcnt(5)
  v_max3_u32 v50, v4, v5, v50
  v_max3_u32 v50, v6, v7, v50
  v_mfma_f32_16x16x32_bf16 v[52:55], v[40:43], v[4:7], v[52:55]
  s_waitcnt vmcnt(4)
  v_max3_u32 v50, v8, v9, v50
  v_max3_u32 v50, v10, v11, v50
  v_mfma_f32_16x16x32_bf16 v[52:55], v[40:43], v[8:11], v[52:55]
  v_cmp_eq_u32 vcc, -1, v50
  s_cbranch_vccnz RR_99
RO_98:
  s_mov_b64 exec, -1
  s_nop 4
  v_add_f32_dpp v52, v52, v52 row_ror:8 row_mask:0xf bank_mask:0xf
  v_add_f32_dpp v53, v53, v53 row_ror:8 row_mask:0xf bank_mask:0xf
  v_cvt_pk_bf16_f32 v52, v52, v53
  buffer_store_dword v52, v49, s[52:55], s56 offen sc1
  s_branch NJ_95
RL_96:
  ds_read_b64 v[54:55], v0 offset:3456
  s_xor_b32 s66, s66, 524288
  s_xor_b32 s101, s101, 524288
  s_xor_b32 s92, s92, 524288
  s_add_u32 s7, s7, 0x40000
  s_add_u32 s100, s100, 0x40000
  s_sub_i32 s72, s72, 1
  s_waitcnt lgkmcnt(0)
  v_min_u32 v54, v54, v55
  s_nop 0
  v_readfirstlane_b32 s73, v54
  s_max_u32 s71, s71, s73
  s_add_u32 s73, s57, 2
  s_min_u32 s73, s73, 64
FP_106:
  s_cmp_ge_u32 s71, s73
  s_cbranch_scc1 FOK_105
  buffer_load_dwordx2 v[54:55], off, s[52:55], s70 sc1
  s_waitcnt vmcnt(0)
  v_min_u32 v54, v54, v55
  s_nop 0
  v_readfirstlane_b32 s71, v54
  s_sub_i32 s72, s72, 1
  s_cmp_ge_i32 s72, 0
  s_cbranch_scc1 FP_106
FOK_105:
  buffer_load_dwordx4 v[12:15], v48, s[52:55], s67 offen sc1
  buffer_load_dwordx4 v[44:47], v48, s[52:55], s68 offen sc1
  buffer_load_dwordx4 v[4:7], v48, s[52:55], s86 offen sc1
  buffer_load_dwordx4 v[8:11], v48, s[52:55], s87 offen sc1
  v_bfe_u32 v42, v0, 6, 2
  v_lshlrev_b32 v42, 4, v42
  v_lshlrev_b64 v[40:41], v42, s[88:89]
  v_mov_b64 v[42:43], v[40:41]
  s_mov_b64 exec, s[96:97]
  v_mov_b64 v[40:41], 0
  s_not_b64 exec, exec
  v_mov_b64 v[42:43], 0
  s_mov_b64 exec, -1
  ds_read_b128 v[24:27], v0 offset:10240
  ds_read_b128 v[28:31], v0 offset:11264
  ds_read_b128 v[32:35], v0 offset:16384
  ds_read_b128 v[36:39], v0 offset:17408
  s_add_u32 s94, s65, s95
  s_add_u32 s94, s94, 524288
  s_add_u32 s73, s57, 3
  s_cmp_ge_u32 s71, s73
  s_cselect_b32 s94, s94, 268435456
  s_xor_b32 s73, s92, 524288
  s_add_u32 s73, s73, s64
  s_sub_u32 s74, s73, 65536
  s_andn2_b32 s74, s74, 768
  s_add_u32 s65, s65, 0x40000
  buffer_load_dwordx4 v[12:15], v48, s[52:55], s67 offen sc1
  buffer_load_dwordx4 v[44:47], v48, s[52:55], s68 offen sc1
  buffer_load_dwordx4 v[4:7], v48, s[52:55], s86 offen sc1
  buffer_load_dwordx4 v[8:11], v48, s[52:55], s87 offen sc1
RQ_102:
  s_sub_i32 s72, s72, 1
  s_waitcnt vmcnt(7)
  v_max3_u32 v50, v12, v13, v14
  v_max3_u32 v50, v14, v15, v50
  v_mfma_f32_16x16x32_bf16 v[52:55], v[40:43], v[12:15], 0
  s_waitcnt vmcnt(6)
  v_max3_u32 v50, v44, v45, v50
  v_max3_u32 v50, v46, v47, v50
  v_mfma_f32_16x16x32_bf16 v[52:55], v[40:43], v[44:47], v[52:55]
  s_waitcnt vmcnt(5)
  v_max3_u32 v50, v4, v5, v50
  v_max3_u32 v50, v6, v7, v50
  v_mfma_f32_16x16x32_bf16 v[52:55], v[40:43], v[4:7], v[52:55]
  s_waitcnt vmcnt(4)
  v_max3_u32 v50, v8, v9, v50
  v_max3_u32 v50, v10, v11, v50
  v_mfma_f32_16x16x32_bf16 v[52:55], v[40:43], v[8:11], v[52:55]
  v_cmp_eq_u32 vcc, -1, v50
  s_cbranch_vccnz RR_104
RO_103:
  s_mov_b64 exec, -1
  s_nop 4
  v_add_f32_dpp v52, v52, v52 row_ror:8 row_mask:0xf bank_mask:0xf
  v_add_f32_dpp v53, v53, v53 row_ror:8 row_mask:0xf bank_mask:0xf
  v_cvt_pk_bf16_f32 v52, v52, v53
  buffer_store_dword v52, v49, s[52:55], s56 offen sc1
NJ_95:
  s_barrier
  buffer_load_dword v12, v51, s[52:55], s6 offen sc1
  buffer_load_dwordx4 v[4:7], v0, s[52:55], s63 offen sc1
  v_mov_b64 v[40:41], 0
  v_mov_b64 v[42:43], 0
  v_mov_b64 v[52:53], 0
  v_mov_b64 v[54:55], 0
  v_mov_b64 v[48:49], 0
  v_mov_b32 v50, 0
  buffer_load_dwordx4 v[8:11], v0, s[52:55], s63 offen offset:2048 sc1
  s_add_u32 s57, s57, 1
  s_sub_u32 s77, s70, 2432
  s_cmp_ge_u32 s71, 64
  s_cselect_b32 s77, 268435456, s77
  s_waitcnt vmcnt(5)
  v_lshrrev_b32 v14, 2, v0
  v_add_u32 v14, s90, v14
  v_bfe_u32 v15, v0, 8, 2
  v_mul_u32_u24 v15, 40960, v15
  v_and_b32 v13, 0xf0, v0
  v_add_u32 v13, v13, v15
  v_mov_b64 v[44:45], 0
  v_mov_b64 v[46:47], 0
  ds_read_b128 v[72:75], v0 offset:18432
  ds_read_b128 v[76:79], v0 offset:19456
  s_waitcnt lgkmcnt(0)
  buffer_load_dword v12, v51, s[52:55], s6 offen sc1
  buffer_load_dwordx4 v[4:7], v0, s[52:55], s63 offen sc1
  buffer_load_dwordx4 v[8:11], v0, s[52:55], s63 offen offset:2048 sc1
  s_branch MP_89
NR_94:
  ds_read_b64 v[54:55], v0 offset:3456
  s_xor_b32 s66, s66, 524288
  s_xor_b32 s101, s101, 524288
  s_xor_b32 s92, s92, 524288
  s_add_u32 s7, s7, 0x40000
  s_add_u32 s100, s100, 0x40000
  s_sub_i32 s72, s72, 1
  ds_read_b128 v[56:59], v0 offset:4096
  ds_read_b128 v[60:63], v0 offset:5120
  ds_read_b128 v[64:67], v0 offset:6144
  ds_read_b128 v[68:71], v0 offset:7168
  ds_read_b128 v[16:19], v0 offset:8192
  ds_read_b128 v[20:23], v0 offset:9216
  ds_read_b128 v[24:27], v0 offset:10240
  ds_read_b128 v[28:31], v0 offset:11264
  ds_read_b128 v[32:35], v0 offset:16384
  ds_read_b128 v[36:39], v0 offset:17408
  s_waitcnt lgkmcnt(10)
  v_min_u32 v54, v54, v55
  s_nop 0
  v_readfirstlane_b32 s73, v54
  s_max_u32 s71, s71, s73
  s_add_u32 s73, s57, 2
  s_min_u32 s73, s73, 64
FP_108:
  s_cmp_ge_u32 s71, s73
  s_cbranch_scc1 FOK_107
  buffer_load_dwordx2 v[54:55], off, s[52:55], s70 sc1
  s_waitcnt vmcnt(0)
  v_min_u32 v54, v54, v55
  s_nop 0
  v_readfirstlane_b32 s71, v54
  s_sub_i32 s72, s72, 1
  s_cmp_ge_i32 s72, 0
  s_cbranch_scc1 FP_108
FOK_107:
  s_add_u32 s94, s65, s95
  s_add_u32 s94, s94, 524288
  s_add_u32 s73, s57, 3
  s_cmp_ge_u32 s71, s73
  s_cselect_b32 s94, s94, 268435456
  s_xor_b32 s73, s92, 524288
  s_add_u32 s73, s73, s64
  s_sub_u32 s74, s73, 65536
  s_andn2_b32 s74, s74, 768
  s_add_u32 s65, s65, 0x40000
  s_branch NJ_95
MR_90:
  s_mov_b64 vcc, exec
MT_109:
  s_mov_b64 exec, vcc
  buffer_load_dword v12, v51, s[52:55], s6 offen sc1
  buffer_load_dwordx4 v[4:7], v0, s[52:55], s63 offen sc1
  buffer_load_dwordx4 v[8:11], v0, s[52:55], s63 offen offset:2048 sc1
  s_sub_i32 s72, s72, 1
  s_waitcnt vmcnt(3)
  v_max3_u32 v15, v12, v4, v5
  v_max3_u32 v15, v6, v7, v15
  v_max3_u32 v15, v8, v9, v15
  v_max3_u32 v15, v10, v11, v15
  ds_write_b128 v0, v[4:7]
  v_cmp_eq_u32 vcc, -1, v15
  ds_write_b32 v14, v12 offset:3584
  ds_write_b128 v0, v[8:11] offset:1024
  s_cmp_lt_i32 s72, 0
  s_cselect_b64 vcc, 0, vcc
  s_cbranch_vccnz MT_109
  s_mov_b64 exec, -1
  s_waitcnt lgkmcnt(11)
  v_smfmac_f32_16x16x64_bf16 v[40:43], v[4:7], v[56:63], v1
  v_mov_b32 v51, 0
  s_waitcnt lgkmcnt(9)
  v_smfmac_f32_16x16x64_bf16 v[44:47], v[4:7], v[64:71], v1
  s_branch CGO_88
MS_92:
  s_mov_b64 exec, vcc
  s_cmp_lt_i32 s72, 0
  s_cbranch_scc1 CGO_88
  buffer_load_dwordx4 v[8:11], v0, s[52:55], s63 offen offset:2048 sc1
  s_sub_i32 s72, s72, 1
  s_waitcnt vmcnt(1)
  s_branch MQ_91
RR_99:
  s_cmp_lt_i32 s72, 0
  s_cbranch_scc1 RO_98
  s_mov_b64 exec, vcc
  buffer_load_dwordx4 v[12:15], v48, s[52:55], s67 offen sc1
  buffer_load_dwordx4 v[44:47], v48, s[52:55], s68 offen sc1
  buffer_load_dwordx4 v[4:7], v48, s[52:55], s86 offen sc1
  buffer_load_dwordx4 v[8:11], v48, s[52:55], s87 offen sc1
  s_branch RQ_97
RR_104:
  s_cmp_lt_i32 s72, 0
  s_cbranch_scc1 RO_103
  s_mov_b64 exec, vcc
  buffer_load_dwordx4 v[12:15], v48, s[52:55], s67 offen sc1
  buffer_load_dwordx4 v[44:47], v48, s[52:55], s68 offen sc1
  buffer_load_dwordx4 v[4:7], v48, s[52:55], s86 offen sc1
  buffer_load_dwordx4 v[8:11], v48, s[52:55], s87 offen sc1
  s_branch RQ_102
CEND_62:
  s_waitcnt vmcnt(0)
  s_barrier
  s_waitcnt lgkmcnt(4)
  v_mov_b32 v32, 64
  buffer_store_dword v32, off, s[52:55], s93 offset:8 sc1
  s_endpgm
EXIT:
  s_endpgm
.section .rodata,"a"
.p2align 6
.amdhsa_kernel sequential_preLN__memory_aug_recurrent_mem_tr__glu_gated_bilinear__prompt_kernel
  .amdhsa_next_free_vgpr 512
  .amdhsa_next_free_sgpr 102
  .amdhsa_accum_offset 256
  .amdhsa_group_segment_fixed_size 0
  .amdhsa_kernarg_size 112
  .amdhsa_user_sgpr_count 2
  .amdhsa_user_sgpr_kernarg_segment_ptr 1
  .amdhsa_system_sgpr_workgroup_id_x 1
.end_amdhsa_kernel
```
